```python
import torch

def _softmax(x, axis=-1):
    return torch.softmax(x, dim=axis)

def _gelu(x):
    return torch.nn.functional.gelu(x, approximate='tanh')

def _silu(x):
    return torch.nn.functional.silu(x)

def _sigmoid(x):
    return torch.sigmoid(x)

def _layernorm(x, axis=-1, eps=1e-05):
    m = x.mean(dim=axis, keepdim=True)
    v = x.var(dim=axis, keepdim=True, unbiased=False)
    return (x - m) / torch.sqrt(v + eps)

def _scatter_add(tgt, idx, src, axis=0):
    return tgt.clone().index_add_(axis, idx, src)

def _segment_sum(src, seg, n):
    out = torch.zeros((n,) + src.shape[1:], dtype=src.dtype)
    return out.index_add_(0, seg, src)

def _pad(x, pw):
    flat = tuple((v for pair in reversed(pw) for v in pair))
    return torch.nn.functional.pad(x, flat)
kernel_name = 'sequential_preLN__spectral_gfnet__mixer_gmlp__prompt'

def setup_inputs():

    _w = lambda a: (lambda t: t.to(torch.bfloat16) if t.is_floating_point() else t)(torch.as_tensor(a))

    def _A_setup():
        B, S, D = (1, 2048, 640)
        Df = D // 2 + 1
        return {'x': _w((lambda *s: torch.randn(*s, dtype=torch.bfloat16) * 0.05)(B, S, D)), 'w_r': _w((lambda *s: torch.randn(*s, dtype=torch.bfloat16) * 0.4)(S, Df) * 0.02), 'w_i': _w((lambda *s: torch.randn(*s, dtype=torch.bfloat16) * 0.4)(S, Df) * 0.02)}
    _A_in = _A_setup()

    def _B_setup():
        B, S, D, F = (1, 2048, 640, 1728)
        Fh = F // 2
        return {'x': _w((lambda *s: torch.randn(*s, dtype=torch.bfloat16) * 0.05)(B, S, D)), 'w_in': _w((lambda *s: torch.randn(*s, dtype=torch.bfloat16) * 0.4)(D, 2 * Fh)), 'w_sp': _w(0.01 * (lambda *s: torch.randn(*s, dtype=torch.bfloat16) * 0.4)(S, S)), 'b_sp': _w(1.0 + 0.01 * (lambda *s: torch.randn(*s, dtype=torch.bfloat16) * 0.05)(S)), 'w_out': _w((lambda *s: torch.randn(*s, dtype=torch.bfloat16) * 0.05)(Fh, D))}
    _B_in = _B_setup()
    return {'A_x': _A_in['x'], 'A_w_r': _A_in['w_r'], 'A_w_i': _A_in['w_i'], 'B_x': _B_in['x'], 'B_w_in': _B_in['w_in'], 'B_w_sp': _B_in['w_sp'], 'B_b_sp': _B_in['b_sp'], 'B_w_out': _B_in['w_out']}

def reference(A_x, A_w_r, A_w_i, B_x, B_w_in, B_w_sp, B_b_sp, B_w_out):

    def _A_ref(x, w_r, w_i):
        B, S, D = x.shape
        X = (lambda x, axes=(-2, -1): torch.fft.rfft2(x.float(), dim=axes))(x, axes=(-2, -1))
        W = w_r + 1j * w_i
        X = X * W
        y = (lambda x, s, axes=(-2, -1): torch.fft.irfft2(x, s=s, dim=axes).to(torch.bfloat16))(X, (S, D), axes=(-2, -1))
        return y

    def _B_ref(x, w_in, w_sp, b_sp, w_out):
        B, S, D = x.shape
        F = w_in.shape[-1]
        Fh = F // 2
        z = _gelu(torch.einsum('bsd,df->bsf', x, w_in))
        z1 = z[..., :Fh].clone()
        z2 = _layernorm(z[..., Fh:], axis=-1)
        g = torch.einsum('ts,bsf->btf', w_sp, z2) + b_sp[None, :, None]
        return torch.einsum('bsf,fd->bsd', z1 * g, w_out)
    x = A_x
    h = x + _A_ref(_layernorm(x, axis=-1), A_w_r, A_w_i)
    h2 = h + _B_ref(_layernorm(h, axis=-1), B_w_in, B_w_sp, B_b_sp, B_w_out)
    return h2
```

```asm
; @launch kernel=kf_kernel grid=(256,1,1) block=(512,1,1) lds=163840
.amdgcn_target "amdgcn-amd-amdhsa--gfx950"
.text
.globl kf_kernel
.p2align 8
.type kf_kernel,@function
kf_kernel:
  s_cmp_ge_u32 s2, 256
  s_cbranch_scc1 kf_kernel_end1
  s_load_dwordx2 s[4:5], s[0:1], 0
  s_load_dwordx2 s[40:41], s[0:1], 80
  s_load_dwordx4 s[52:55], s[0:1], 8
  s_load_dwordx2 s[62:63], s[0:1], 32
  s_load_dwordx2 s[64:65], s[0:1], 56
  s_load_dwordx2 s[72:73], s[0:1], 40
  s_getpc_b64 s[12:13]
  s_add_u32 s12, s12, tab@rel32@lo+4
  s_addc_u32 s13, s13, tab@rel32@hi+12
  s_mov_b32 s14, 49152
  s_mov_b32 s15, 0x00020000
  s_and_b32 s33, s2, 7
  s_lshl_b32 s3, s33, 5
  s_lshr_b32 s36, s2, 3
  s_add_u32 s3, s3, s36
  v_lshrrev_b32 v1, 6, v0
  v_and_b32 v2, 63, v0
  v_readfirstlane_b32 s34, v1
  v_lshlrev_b32 v3, 4, v2
  s_cmp_ge_u32 s34, 2
  s_cbranch_scc1 kf_kernel_ncp6
  s_getpc_b64 s[68:69]
  s_add_u32 s68, s68, kf_kernel_cs5@rel32@lo+4
  s_addc_u32 s69, s69, kf_kernel_cs5@rel32@hi+12
  s_mov_b32 s70, code_end-kf_kernel_cs5
  s_mov_b32 s71, 0x00020000
  v_lshlrev_b32 v100, 7, v2
  s_lshl_b32 s33, s34, 13
  buffer_load_ubyte v103, v100, s[68:71], s33 offen
kf_kernel_ncp6:
kf_kernel_cs5:
  s_lshl_b32 s38, s34, 10
  s_add_u32 m0, s38, 51712
  s_nop 0
  buffer_load_dwordx4 v3, s[12:15], s38 offen lds
  s_lshl_b32 s35, s34, 8
  s_add_u32 s35, s35, s3
  s_mul_i32 s35, s35, 1280
  v_lshlrev_b32 v58, 3, v2
  v_lshlrev_b32 v59, 2, v2
  v_and_b32 v50, 15, v2
  v_lshrrev_b32 v51, 4, v2
  s_waitcnt lgkmcnt(0)
  s_mov_b32 s6, 0x280000
  s_mov_b32 s7, 0x00020000
  buffer_load_dwordx2 v[4:5], v58, s[4:7], s35 offen
  buffer_load_dwordx2 v[6:7], v58, s[4:7], s35 offen offset:512
  buffer_load_dword v8, v59, s[4:7], s35 offen offset:1024
  s_mov_b32 s8, s40
  s_mov_b32 s9, s41
  s_mov_b32 s10, 0x2a0000
  s_mov_b32 s11, 0x00020000
  s_mul_i32 s32, s34, 14336
  s_add_u32 s32, s32, 31744
  s_min_u32 s32, s32, 129024
  s_add_u32 s32, s32, 20480
  s_cmp_ge_u32 s2, 168
  s_cselect_b32 s100, 3, 8
  s_cselect_b32 s101, 6, 8
  s_cmp_lt_u32 s34, s101
  s_cbranch_scc1 kf_kernel_pa15
  s_sub_u32 s16, s2, 168
  s_mul_i32 s16, s16, 5
  s_add_u32 s16, s16, s34
  s_sub_u32 s16, s16, 3
  s_mov_b32 s24, s32
  v_and_b32 v96, 15, v2
  v_lshrrev_b32 v97, 4, v2
  s_mov_b32 s23, 0x00020000
  s_cmp_ge_u32 s16, 280
  s_cbranch_scc1 kf_kernel_wo17
  s_mul_i32 s26, s16, 4682
  s_lshr_b32 s26, s26, 16
  s_mul_i32 s27, s26, 14
  s_sub_u32 s27, s16, s27
  s_movk_i32 s25, 3456
  s_lshl_b32 s28, s26, 5
  s_mov_b32 s31, 8
  s_mov_b32 s31, 4
  s_mov_b64 s[20:21], s[62:63]
  s_mov_b32 s22, 2211840
  s_branch kf_kernel_j18
kf_kernel_wo17:
  s_sub_u32 s17, s16, 280
  s_mul_i32 s26, s17, 13108
  s_lshr_b32 s26, s26, 16
  s_mul_i32 s27, s26, 5
  s_sub_u32 s27, s17, s27
  s_movk_i32 s25, 1280
  s_lshr_b32 s29, s26, 2
  s_and_b32 s30, s26, 3
  s_mul_i32 s28, s29, 112
  s_lshl_b32 s18, s30, 5
  s_add_u32 s28, s28, s18
  s_mov_b32 s31, 4
  s_mov_b32 s31, 16
  s_mov_b64 s[20:21], s[64:65]
  s_mov_b32 s22, 1105920
kf_kernel_j18:
  v_mul_u32_u24 v98, s25, v97
  v_lshl_add_u32 v98, v96, 4, v98
  s_mul_i32 s18, s28, s25
  s_lshl_b32 s19, s27, 8
  s_add_u32 s18, s18, s19
  v_add_u32 v98, s18, v98
  s_lshl_b32 s19, s25, 2
  s_add_u32 m0, s24, 0
  s_nop 0
  buffer_load_dwordx4 v98, s[20:23], 0 offen nt lds
  v_add_u32 v98, s19, v98
  s_add_u32 m0, s24, 1024
  s_nop 0
  buffer_load_dwordx4 v98, s[20:23], 0 offen nt lds
  v_add_u32 v98, s19, v98
  s_add_u32 m0, s24, 2048
  s_nop 0
  buffer_load_dwordx4 v98, s[20:23], 0 offen nt lds
  v_add_u32 v98, s19, v98
  s_add_u32 m0, s24, 3072
  s_nop 0
  buffer_load_dwordx4 v98, s[20:23], 0 offen nt lds
  v_add_u32 v98, s19, v98
  s_add_u32 m0, s24, 4096
  s_nop 0
  buffer_load_dwordx4 v98, s[20:23], 0 offen nt lds
  v_add_u32 v98, s19, v98
  s_add_u32 m0, s24, 5120
  s_nop 0
  buffer_load_dwordx4 v98, s[20:23], 0 offen nt lds
  v_add_u32 v98, s19, v98
  s_add_u32 m0, s24, 6144
  s_nop 0
  buffer_load_dwordx4 v98, s[20:23], 0 offen nt lds
  v_add_u32 v98, s19, v98
  s_add_u32 m0, s24, 7168
  s_nop 0
  buffer_load_dwordx4 v98, s[20:23], 0 offen nt lds
kf_kernel_pa15:
  s_lshl_b32 s33, s3, 6
  s_add_u32 s33, s33, 32768
  s_load_dwordx16 s[16:31], s[12:13], s33
  s_load_dwordx2 s[80:81], s[0:1], 64
  s_mov_b32 s74, 8388608
  s_mov_b32 s75, 0x00020000
  s_bfe_u32 s46, s2, 0x20001
  s_lshl_b32 s46, s46, 3
  s_bfe_u32 s47, s2, 0x30003
  s_add_u32 s46, s46, s47
  s_lshl_b32 s50, s46, 15
  s_lshr_b32 s46, s34, 2
  s_lshl_b32 s46, s46, 11
  s_and_b32 s47, s34, 3
  s_lshl_b32 s47, s47, 7
  s_add_u32 s50, s50, s46
  s_add_u32 s50, s50, s47
  s_add_u32 s51, s50, 16384
  s_bfe_u32 s46, s2, 0x10006
  s_lshl_b32 s46, s46, 14
  s_add_u32 s50, s50, s46
  s_bfe_u32 s46, s2, 0x10007
  s_lshl_b32 s46, s46, 22
  s_add_u32 s50, s50, s46
  s_mov_b32 s51, s50
  s_mov_b32 s82, s50
  s_add_u32 s51, s50, 4096
  v_and_b32 v124, 112, v3
  v_bfe_u32 v125, v3, 7, 1
  v_lshl_add_u32 v124, v125, 13, v124
  v_lshrrev_b32 v125, 8, v3
  v_lshl_add_u32 v124, v125, 9, v124
  s_mul_i32 s39, s34, 1280
  v_add_u32 v62, s32, v58
  v_add_u32 v63, s32, v59
  v_add_u32 v58, s39, v58
  v_add_u32 v59, s39, v59
  v_lshrrev_b32 v52, 2, v50
  v_and_b32 v53, 3, v50
  v_lshl_add_u32 v54, v51, 3, v52
  v_add_u32 v55, 4, v54
  v_subrev_u32 v56, 20, v54
  v_min_u32 v54, v54, v56
  v_subrev_u32 v56, 20, v55
  v_min_u32 v55, v55, v56
  v_lshlrev_b32 v53, 3, v53
  v_lshl_add_u32 v54, v54, 6, v53
  v_lshl_add_u32 v55, v55, 6, v53
  v_add_u32 v54, s39, v54
  v_add_u32 v55, s39, v55
  s_mul_i32 s42, s34, 2576
  s_add_u32 s42, s42, 10240
  v_mul_u32_u24 v56, 80, v51
  v_add_u32 v57, v56, v50
  v_lshlrev_b32 v57, 3, v57
  v_add_u32 v60, s42, v57
  v_sub_u32 v61, 2080, v57
  v_add_u32 v61, s42, v61
  v_mov_b32 v126, 33264
  v_mov_b32 v127, 0
  ds_write_b32 v126, v127
  s_cmp_lt_u32 s34, s101
  s_cbranch_scc1 kf_kernel_pb21
  s_waitcnt vmcnt(11)
  s_branch kf_kernel_pb21x
kf_kernel_pb21:
  s_waitcnt vmcnt(3)
kf_kernel_pb21x:
  s_barrier
  ds_read_b128 v[64:67], v3 offset:51712
  ds_read_b128 v[68:71], v3 offset:52736
  ds_read_b128 v[72:75], v3 offset:53760
  ds_read_b128 v[76:79], v3 offset:54784
  ds_read_b128 v[80:83], v3 offset:55808
  ds_read_b128 v[84:87], v3 offset:56832
  ds_read_b128 v[88:91], v3 offset:57856
  ds_read_b128 v[92:95], v3 offset:58880
  s_add_u32 m0, s38, 33280
  s_add_u32 s37, s38, 0x2000
  buffer_load_dwordx4 v3, s[12:15], s37 offen lds
  s_min_u32 s39, s34, 4
  s_lshl_b32 s39, s39, 11
  s_add_u32 m0, s39, 41472
  s_add_u32 s37, s39, 0x4000
  buffer_load_dwordx4 v3, s[12:15], s37 offen lds
  buffer_load_dwordx4 v3, s[12:15], s37 offen offset:1024 lds
  s_add_u32 s56, s40, 0x1800000
  s_addc_u32 s57, s41, 0
  s_mov_b32 s58, 0x80000
  s_mov_b32 s59, 0x00020000
  s_lshl_b32 s33, s2, 10
  s_cmp_lt_u32 s2, 128
  s_cselect_b32 s43, s33, 0x7f000000
  s_add_u32 s33, s33, 0x40000
  s_cmp_eq_u32 s34, 1
  s_cselect_b32 s33, s33, 0x7f000000
  s_cselect_b32 s44, -1, 0
  s_cmp_eq_u32 s34, 0
  s_cselect_b32 s33, s43, s33
  v_mov_b32 v120, s44
  v_mov_b32 v121, s44
  v_mov_b32 v122, s44
  v_mov_b32 v123, s44
  buffer_store_dwordx4 v[120:123], v3, s[56:59], s33 offen sc1
  s_getpc_b64 s[68:69]
  s_add_u32 s68, s68, kf_kernel_cs5@rel32@lo+4
  s_addc_u32 s69, s69, kf_kernel_cs5@rel32@hi+12
  s_mov_b32 s70, code_end-kf_kernel_cs5
  s_mov_b32 s71, 0x00020000
  s_cmp_ge_u32 s34, 6
  s_cselect_b32 s70, s70, 0
  s_bfe_u32 s33, s2, 0x30003
  s_lshl_b32 s33, s33, 13
  s_and_b32 s43, s34, 1
  s_lshl_b32 s43, s43, 16
  s_add_u32 s33, s33, s43
  s_add_u32 s33, s33, 16384
  v_lshlrev_b32 v100, 7, v2
  buffer_load_ubyte v122, v100, s[68:71], s33 offen
  s_bitcmp1_b32 s34, 0
  s_cselect_b32 s68, s54, s52
  s_cselect_b32 s69, s55, s53
  s_cmp_ge_u32 s34, 6
  s_cselect_b32 s70, 1314816, 0
  s_mov_b32 s71, 0x00020000
  v_and_b32 v100, 7, v2
  v_lshlrev_b32 v100, 7, v100
  v_min_u32 v100, 671, v100
  v_lshrrev_b32 v102, 3, v2
  v_mul_u32_u24 v102, 5136, v102
  v_add_u32 v100, v100, v102
  s_and_b32 s33, s2, 7
  s_lshr_b32 s37, s2, 3
  s_lshl_b32 s37, s37, 6
  s_add_u32 s33, s33, s37
  s_mul_i32 s33, s33, 642
  buffer_load_ubyte v123, v100, s[68:71], s33 offen
  s_cmp_lt_u32 s34, s101
  s_cbranch_scc1 kf_kernel_pb22
  s_waitcnt vmcnt(14)
  s_branch kf_kernel_pb22x
kf_kernel_pb22:
  s_waitcnt vmcnt(6)
kf_kernel_pb22x:
  ds_write_b64 v62, v[4:5] offset:8192
  ds_write_b64 v62, v[6:7] offset:8704
  ds_write_b32 v63, v8 offset:9216
  v_lshlrev_b32 v10, 16, v4
  v_and_b32 v11, 0xffff0000, v4
  v_lshlrev_b32 v12, 16, v5
  v_and_b32 v13, 0xffff0000, v5
  v_lshlrev_b32 v14, 16, v6
  v_and_b32 v15, 0xffff0000, v6
  v_lshlrev_b32 v16, 16, v7
  v_and_b32 v17, 0xffff0000, v7
  v_lshlrev_b32 v18, 16, v8
  v_and_b32 v19, 0xffff0000, v8
  v_pk_add_f32 v[20:21], v[10:11], v[12:13]
  v_pk_mul_f32 v[22:23], v[10:11], v[10:11]
  v_pk_add_f32 v[24:25], v[14:15], v[16:17]
  v_pk_fma_f32 v[22:23], v[12:13], v[12:13], v[22:23]
  v_pk_add_f32 v[20:21], v[20:21], v[18:19]
  v_pk_fma_f32 v[22:23], v[14:15], v[14:15], v[22:23]
  v_pk_add_f32 v[20:21], v[20:21], v[24:25]
  v_pk_fma_f32 v[22:23], v[16:17], v[16:17], v[22:23]
  v_pk_fma_f32 v[22:23], v[18:19], v[18:19], v[22:23]
  v_add_f32 v20, v20, v21
  v_add_f32 v22, v22, v23
  s_nop 0
  v_add_f32_dpp v20, v20, v20 quad_perm:[1,0,3,2] row_mask:0xf bank_mask:0xf
  v_add_f32_dpp v22, v22, v22 quad_perm:[1,0,3,2] row_mask:0xf bank_mask:0xf
  s_nop 0
  v_add_f32_dpp v20, v20, v20 quad_perm:[2,3,0,1] row_mask:0xf bank_mask:0xf
  v_add_f32_dpp v22, v22, v22 quad_perm:[2,3,0,1] row_mask:0xf bank_mask:0xf
  s_nop 0
  v_add_f32_dpp v20, v20, v20 row_half_mirror row_mask:0xf bank_mask:0xf
  v_add_f32_dpp v22, v22, v22 row_half_mirror row_mask:0xf bank_mask:0xf
  s_nop 0
  v_add_f32_dpp v20, v20, v20 row_mirror row_mask:0xf bank_mask:0xf
  v_add_f32_dpp v22, v22, v22 row_mirror row_mask:0xf bank_mask:0xf
  s_nop 0
  v_add_f32_dpp v20, v20, v20 row_bcast:15 row_mask:0xa bank_mask:0xf
  v_add_f32_dpp v22, v22, v22 row_bcast:15 row_mask:0xa bank_mask:0xf
  s_nop 0
  v_add_f32_dpp v20, v20, v20 row_bcast:31 row_mask:0xc bank_mask:0xf
  v_add_f32_dpp v22, v22, v22 row_bcast:31 row_mask:0xc bank_mask:0xf
  v_readlane_b32 s36, v20, 63
  v_readlane_b32 s37, v22, 63
  v_mov_b32 v24, 0x3acccccd
  v_mul_f32 v20, s36, v24
  v_mul_f32 v25, s37, v24
  v_fma_f32 v25, -v20, v20, v25
  v_max_f32 v25, 0, v25
  v_cvt_pk_bf16_f32 v24, v20, v25
  v_lshlrev_b32 v20, 16, v24
  v_and_b32 v25, 0xffff0000, v24
  v_add_f32 v25, 0x3727c5ac, v25
  v_cvt_pk_bf16_f32 v24, v25, v25
  v_and_b32 v24, 0xffff0000, v24
  v_sqrt_f32 v24, v24
  s_nop 0
  v_cvt_pk_bf16_f32 v24, v24, v24
  v_and_b32 v24, 0xffff0000, v24
  v_rcp_f32 v22, v24
  s_nop 0
  v_mul_f32 v20, v20, v22
  v_pk_fma_f32 v[10:11], v[10:11], v[22:23], v[20:21] op_sel_hi:[1,0,0] neg_lo:[0,0,1] neg_hi:[0,0,1]
  v_pk_fma_f32 v[12:13], v[12:13], v[22:23], v[20:21] op_sel_hi:[1,0,0] neg_lo:[0,0,1] neg_hi:[0,0,1]
  v_pk_fma_f32 v[14:15], v[14:15], v[22:23], v[20:21] op_sel_hi:[1,0,0] neg_lo:[0,0,1] neg_hi:[0,0,1]
  v_pk_fma_f32 v[16:17], v[16:17], v[22:23], v[20:21] op_sel_hi:[1,0,0] neg_lo:[0,0,1] neg_hi:[0,0,1]
  v_pk_fma_f32 v[18:19], v[18:19], v[22:23], v[20:21] op_sel_hi:[1,0,0] neg_lo:[0,0,1] neg_hi:[0,0,1]
  v_cvt_pk_bf16_f32 v4, v10, v11
  v_cvt_pk_bf16_f32 v5, v12, v13
  v_cvt_pk_bf16_f32 v6, v14, v15
  v_cvt_pk_bf16_f32 v7, v16, v17
  v_cvt_pk_bf16_f32 v8, v18, v19
  ds_write_b64 v58, v[4:5]
  ds_write_b64 v58, v[6:7] offset:512
  ds_write_b32 v59, v8 offset:1024
  s_waitcnt lgkmcnt(0)
  ds_read_b64_tr_b16 v[4:5], v54
  ds_read_b64_tr_b16 v[6:7], v55
  ds_read_b64_tr_b16 v[8:9], v54 offset:32
  ds_read_b64_tr_b16 v[10:11], v55 offset:32
  s_waitcnt lgkmcnt(2)
  v_mfma_f32_16x16x32_bf16 v[12:15], v[4:7], v[64:67], 0
  v_mfma_f32_16x16x32_bf16 v[16:19], v[4:7], v[68:71], 0
  s_waitcnt lgkmcnt(0)
  v_mfma_f32_16x16x32_bf16 v[20:23], v[8:11], v[64:67], 0
  v_mfma_f32_16x16x32_bf16 v[24:27], v[8:11], v[68:71], 0
  s_nop 4
  v_pk_mul_f32 v[44:45], v[16:17], v[76:77]
  v_pk_mul_f32 v[46:47], v[18:19], v[78:79]
  v_pk_mul_f32 v[32:33], v[16:17], v[72:73]
  v_pk_mul_f32 v[34:35], v[18:19], v[74:75]
  v_pk_fma_f32 v[28:29], v[12:13], v[72:73], v[44:45] neg_lo:[0,0,1] neg_hi:[0,0,1]
  v_pk_fma_f32 v[30:31], v[14:15], v[74:75], v[46:47] neg_lo:[0,0,1] neg_hi:[0,0,1]
  v_pk_fma_f32 v[32:33], v[12:13], v[76:77], v[32:33]
  v_pk_fma_f32 v[34:35], v[14:15], v[78:79], v[34:35]
  v_pk_mul_f32 v[44:45], v[24:25], v[84:85]
  v_pk_mul_f32 v[46:47], v[26:27], v[86:87]
  v_pk_mul_f32 v[40:41], v[24:25], v[80:81]
  v_pk_mul_f32 v[42:43], v[26:27], v[82:83]
  v_pk_fma_f32 v[36:37], v[20:21], v[80:81], v[44:45] neg_lo:[0,0,1] neg_hi:[0,0,1]
  v_pk_fma_f32 v[38:39], v[22:23], v[82:83], v[46:47] neg_lo:[0,0,1] neg_hi:[0,0,1]
  v_pk_fma_f32 v[40:41], v[20:21], v[84:85], v[40:41]
  v_pk_fma_f32 v[42:43], v[22:23], v[86:87], v[42:43]
  v_cvt_pk_bf16_f32 v4, v28, v29
  v_cvt_pk_bf16_f32 v8, v32, v33
  v_cvt_pk_bf16_f32 v12, -v32, -v33
  v_cvt_pk_bf16_f32 v16, v28, -v29
  v_cvt_pk_bf16_f32 v20, v32, -v33
  v_cvt_pk_bf16_f32 v24, -v32, v33
  v_cvt_pk_bf16_f32 v5, v30, v31
  v_cvt_pk_bf16_f32 v9, v34, v35
  v_cvt_pk_bf16_f32 v13, -v34, -v35
  v_cvt_pk_bf16_f32 v17, v30, -v31
  v_cvt_pk_bf16_f32 v21, v34, -v35
  v_cvt_pk_bf16_f32 v25, -v34, v35
  v_cvt_pk_bf16_f32 v6, v36, v37
  v_cvt_pk_bf16_f32 v10, v40, v41
  v_cvt_pk_bf16_f32 v14, -v40, -v41
  v_cvt_pk_bf16_f32 v18, v36, -v37
  v_cvt_pk_bf16_f32 v22, v40, -v41
  v_cvt_pk_bf16_f32 v26, -v40, v41
  v_cvt_pk_bf16_f32 v7, v38, v39
  v_cvt_pk_bf16_f32 v11, v42, v43
  v_cvt_pk_bf16_f32 v15, -v42, -v43
  v_cvt_pk_bf16_f32 v19, v38, -v39
  v_cvt_pk_bf16_f32 v23, v42, -v43
  v_cvt_pk_bf16_f32 v27, -v42, v43
  v_mfma_f32_16x16x32_bf16 v[28:31], v[88:91], v[4:7], 0
  v_mfma_f32_16x16x32_bf16 v[32:35], v[92:95], v[4:7], 0
  v_mfma_f32_16x16x32_bf16 v[36:39], v[88:91], v[16:19], 0
  v_mfma_f32_16x16x32_bf16 v[40:43], v[92:95], v[16:19], 0
  v_mfma_f32_16x16x32_bf16 v[28:31], v[92:95], v[12:15], v[28:31]
  v_mfma_f32_16x16x32_bf16 v[32:35], v[88:91], v[8:11], v[32:35]
  v_mfma_f32_16x16x32_bf16 v[36:39], v[92:95], v[24:27], v[36:39]
  v_mfma_f32_16x16x32_bf16 v[40:43], v[88:91], v[20:23], v[40:43]
  s_mov_b32 exec_lo, 0x07ff07ff
  s_mov_b32 exec_hi, 0x07ff07ff
  s_nop 3
  ds_write2_b32 v60, v28, v32 offset0:0 offset1:1
  ds_write2_b32 v60, v29, v33 offset0:40 offset1:41
  ds_write2_b32 v60, v30, v34 offset0:80 offset1:81
  ds_write2_b32 v60, v31, v35 offset0:120 offset1:121
  v_xor_b32 v40, 0x80000000, v40
  v_xor_b32 v41, 0x80000000, v41
  v_xor_b32 v42, 0x80000000, v42
  v_xor_b32 v43, 0x80000000, v43
  ds_write2_b32 v61, v36, v40 offset0:120 offset1:121
  ds_write2_b32 v61, v37, v41 offset0:80 offset1:81
  ds_write2_b32 v61, v38, v42 offset0:40 offset1:41
  ds_write2_b32 v61, v39, v43 offset0:0 offset1:1
  s_mov_b64 exec, -1
  s_add_u32 s68, s40, 0x1800000
  s_addc_u32 s69, s41, 0
  s_mov_b32 s70, 0x40000
  s_mov_b32 s71, 0x00020000
  s_waitcnt vmcnt(2)
  s_waitcnt lgkmcnt(0)
  s_barrier
  v_cmp_gt_u32 vcc, 336, v0
  s_and_saveexec_b64 s[44:45], vcc
  s_cbranch_execz kf_kernel_tail12
  v_lshlrev_b32 v1, 3, v0
  v_lshlrev_b32 v2, 2, v0
  ds_read_b64 v[4:5], v1 offset:10240
  ds_read_b64 v[6:7], v1 offset:12816
  ds_read_b64 v[8:9], v1 offset:15392
  ds_read_b64 v[10:11], v1 offset:17968
  ds_read_b64 v[12:13], v1 offset:20544
  ds_read_b64 v[14:15], v1 offset:23120
  ds_read_b64 v[16:17], v1 offset:25696
  ds_read_b64 v[18:19], v1 offset:28272
  v_mov_b32 v40, 0x3f3504f3
  s_mul_i32 s46, s3, 10752
  s_add_u32 s47, s46, 4032
  s_add_u32 s48, s46, 8064
  s_waitcnt lgkmcnt(0)
  s_barrier
  v_pk_add_f32 v[20:21], v[4:5], v[12:13]
  v_pk_add_f32 v[22:23], v[4:5], v[12:13] neg_lo:[0,1] neg_hi:[0,1]
  v_pk_add_f32 v[24:25], v[8:9], v[16:17]
  v_pk_add_f32 v[26:27], v[8:9], v[16:17] neg_lo:[0,1] neg_hi:[0,1]
  v_pk_add_f32 v[28:29], v[6:7], v[14:15]
  v_pk_add_f32 v[30:31], v[6:7], v[14:15] neg_lo:[0,1] neg_hi:[0,1]
  v_pk_add_f32 v[32:33], v[10:11], v[18:19]
  v_pk_add_f32 v[34:35], v[10:11], v[18:19] neg_lo:[0,1] neg_hi:[0,1]
  v_pk_add_f32 v[4:5], v[20:21], v[24:25]
  v_pk_add_f32 v[6:7], v[20:21], v[24:25] neg_lo:[0,1] neg_hi:[0,1]
  v_pk_add_f32 v[8:9], v[28:29], v[32:33]
  v_pk_add_f32 v[10:11], v[28:29], v[32:33] neg_lo:[0,1] neg_hi:[0,1]
  v_pk_add_f32 v[12:13], v[26:27], v[22:23] op_sel:[1,0] op_sel_hi:[0,1] neg_hi:[1,0]
  v_pk_add_f32 v[14:15], v[26:27], v[22:23] op_sel:[1,0] op_sel_hi:[0,1] neg_lo:[1,0]
  v_pk_add_f32 v[16:17], v[34:35], v[30:31] op_sel:[1,0] op_sel_hi:[0,1] neg_hi:[1,0]
  v_pk_add_f32 v[18:19], v[34:35], v[30:31] op_sel:[1,0] op_sel_hi:[0,1] neg_lo:[1,0]
  v_pk_add_f32 v[20:21], v[4:5], v[8:9]
  v_pk_add_f32 v[28:29], v[4:5], v[8:9] neg_lo:[0,1] neg_hi:[0,1]
  v_pk_add_f32 v[24:25], v[10:11], v[6:7] op_sel:[1,0] op_sel_hi:[0,1] neg_hi:[1,0]
  v_pk_add_f32 v[32:33], v[10:11], v[6:7] op_sel:[1,0] op_sel_hi:[0,1] neg_lo:[1,0]
  v_pk_add_f32 v[4:5], v[16:17], v[16:17] op_sel:[0,1] op_sel_hi:[1,0] neg_hi:[0,1]
  v_pk_add_f32 v[6:7], v[18:19], v[18:19] op_sel:[0,1] op_sel_hi:[1,0] neg_lo:[0,1]
  v_pk_fma_f32 v[22:23], v[4:5], v[40:41], v[12:13] op_sel_hi:[1,0,1]
  v_pk_fma_f32 v[30:31], v[4:5], v[40:41], v[12:13] op_sel_hi:[1,0,1] neg_lo:[1,0,0] neg_hi:[1,0,0]
  v_pk_fma_f32 v[26:27], v[6:7], v[40:41], v[14:15] op_sel_hi:[1,0,1] neg_lo:[1,0,0] neg_hi:[1,0,0]
  v_pk_fma_f32 v[34:35], v[6:7], v[40:41], v[14:15] op_sel_hi:[1,0,1]
  v_cvt_pk_bf16_f32 v4, v20, v21
  v_and_b32 v4, -2, v4
  buffer_store_dword v4, v2, s[8:11], s46 offen offset:0 sc1
  v_pk_mul_f32 v[44:45], v[22:23], s[18:19] op_sel_hi:[1,0]
  v_pk_fma_f32 v[22:23], v[22:23], s[18:19], v[44:45] op_sel:[1,1,0] op_sel_hi:[0,1,1] neg_lo:[1,0,0]
  v_cvt_pk_bf16_f32 v5, v22, v23
  v_and_b32 v5, -2, v5
  buffer_store_dword v5, v2, s[8:11], s46 offen offset:1344 sc1
  v_pk_mul_f32 v[42:43], v[24:25], s[20:21] op_sel_hi:[1,0]
  v_pk_fma_f32 v[24:25], v[24:25], s[20:21], v[42:43] op_sel:[1,1,0] op_sel_hi:[0,1,1] neg_lo:[1,0,0]
  v_cvt_pk_bf16_f32 v6, v24, v25
  v_and_b32 v6, -2, v6
  buffer_store_dword v6, v2, s[8:11], s46 offen offset:2688 sc1
  v_pk_mul_f32 v[44:45], v[26:27], s[22:23] op_sel_hi:[1,0]
  v_pk_fma_f32 v[26:27], v[26:27], s[22:23], v[44:45] op_sel:[1,1,0] op_sel_hi:[0,1,1] neg_lo:[1,0,0]
  v_cvt_pk_bf16_f32 v7, v26, v27
  v_and_b32 v7, -2, v7
  buffer_store_dword v7, v2, s[8:11], s47 offen offset:0 sc1
  v_pk_mul_f32 v[42:43], v[28:29], s[24:25] op_sel_hi:[1,0]
  v_pk_fma_f32 v[28:29], v[28:29], s[24:25], v[42:43] op_sel:[1,1,0] op_sel_hi:[0,1,1] neg_lo:[1,0,0]
  v_cvt_pk_bf16_f32 v8, v28, v29
  v_and_b32 v8, -2, v8
  buffer_store_dword v8, v2, s[8:11], s47 offen offset:1344 sc1
  v_pk_mul_f32 v[44:45], v[30:31], s[26:27] op_sel_hi:[1,0]
  v_pk_fma_f32 v[30:31], v[30:31], s[26:27], v[44:45] op_sel:[1,1,0] op_sel_hi:[0,1,1] neg_lo:[1,0,0]
  v_cvt_pk_bf16_f32 v9, v30, v31
  v_and_b32 v9, -2, v9
  buffer_store_dword v9, v2, s[8:11], s47 offen offset:2688 sc1
  v_pk_mul_f32 v[42:43], v[32:33], s[28:29] op_sel_hi:[1,0]
  v_pk_fma_f32 v[32:33], v[32:33], s[28:29], v[42:43] op_sel:[1,1,0] op_sel_hi:[0,1,1] neg_lo:[1,0,0]
  v_cvt_pk_bf16_f32 v10, v32, v33
  v_and_b32 v10, -2, v10
  buffer_store_dword v10, v2, s[8:11], s48 offen offset:0 sc1
  v_pk_mul_f32 v[44:45], v[34:35], s[30:31] op_sel_hi:[1,0]
  v_pk_fma_f32 v[34:35], v[34:35], s[30:31], v[44:45] op_sel:[1,1,0] op_sel_hi:[0,1,1] neg_lo:[1,0,0]
  v_cvt_pk_bf16_f32 v11, v34, v35
  v_and_b32 v11, -2, v11
  buffer_store_dword v11, v2, s[8:11], s48 offen offset:1344 sc1
  s_mov_b64 exec, -1
  s_bfe_u32 s42, s3, 0x30001
  s_lshl_b32 s42, s42, 7
  s_lshr_b32 s43, s3, 4
  s_lshl_b32 s43, s43, 3
  s_add_u32 s42, s42, s43
  s_and_b32 s43, s3, 1
  s_lshl_b32 s43, s43, 2
  s_add_u32 s42, s42, s43
  s_add_u32 s42, s42, 131072
  v_lshlrev_b32 v12, 6, v3
  v_mov_b32 v13, 2814633361
  v_mov_b32 v127, 1
  s_mov_b64 exec, 1
  s_waitcnt vmcnt(0)
  ds_add_rtn_u32 v127, v126, v127
  s_waitcnt lgkmcnt(0)
  v_readfirstlane_b32 s43, v127
  s_mov_b64 exec, 0xff
  s_and_b32 s43, s43, 0xff
  s_cmp_lg_u32 s43, 5
  s_cbranch_scc1 kf_kernel_nf14
  buffer_store_dword v13, v12, s[68:71], s42 offen sc1
kf_kernel_nf14:
  s_mov_b64 exec, -1
  v_and_b32 v2, 63, v0
  s_cmp_ge_u32 s34, s100
  s_cbranch_scc1 kf_kernel_prepb4
  s_mov_b64 exec, 1
  v_mov_b32 v127, 0x100
  ds_add_u32 v126, v127
  s_mov_b64 exec, -1
  s_branch kf_kernel_j111
kf_kernel_tail12:
  s_mov_b64 exec, -1
  s_barrier
  s_cmp_lt_u32 s34, s100
  s_cbranch_scc1 kf_kernel_j111
kf_kernel_prepb4:
  s_cmp_ge_u32 s34, s101
  s_cbranch_scc1 kf_kernel_pb16
  s_sub_u32 s16, s2, 168
  s_mul_i32 s16, s16, 5
  s_add_u32 s16, s16, s34
  s_sub_u32 s16, s16, 3
  s_mov_b32 s24, s32
  v_and_b32 v96, 15, v2
  v_lshrrev_b32 v97, 4, v2
  s_mov_b32 s23, 0x00020000
  s_cmp_ge_u32 s16, 280
  s_cbranch_scc1 kf_kernel_wo23
  s_mul_i32 s26, s16, 4682
  s_lshr_b32 s26, s26, 16
  s_mul_i32 s27, s26, 14
  s_sub_u32 s27, s16, s27
  s_movk_i32 s25, 3456
  s_lshl_b32 s28, s26, 5
  s_mov_b32 s31, 8
  s_mov_b32 s31, 4
  s_mov_b64 s[20:21], s[62:63]
  s_mov_b32 s22, 2211840
  s_branch kf_kernel_j24
kf_kernel_wo23:
  s_sub_u32 s17, s16, 280
  s_mul_i32 s26, s17, 13108
  s_lshr_b32 s26, s26, 16
  s_mul_i32 s27, s26, 5
  s_sub_u32 s27, s17, s27
  s_movk_i32 s25, 1280
  s_lshr_b32 s29, s26, 2
  s_and_b32 s30, s26, 3
  s_mul_i32 s28, s29, 112
  s_lshl_b32 s18, s30, 5
  s_add_u32 s28, s28, s18
  s_mov_b32 s31, 4
  s_mov_b32 s31, 16
  s_mov_b64 s[20:21], s[64:65]
  s_mov_b32 s22, 1105920
kf_kernel_j24:
  v_mul_u32_u24 v98, s25, v97
  v_lshl_add_u32 v98, v96, 4, v98
  s_mul_i32 s18, s28, s25
  s_lshl_b32 s19, s27, 8
  s_add_u32 s18, s18, s19
  v_add_u32 v98, s18, v98
  s_lshl_b32 s19, s25, 2
  s_add_u32 m0, s24, 0
  s_nop 0
  buffer_load_dwordx4 v98, s[20:23], 0 offen nt lds
  v_add_u32 v98, s19, v98
  s_add_u32 m0, s24, 1024
  s_nop 0
  buffer_load_dwordx4 v98, s[20:23], 0 offen nt lds
  v_add_u32 v98, s19, v98
  s_add_u32 m0, s24, 2048
  s_nop 0
  buffer_load_dwordx4 v98, s[20:23], 0 offen nt lds
  v_add_u32 v98, s19, v98
  s_add_u32 m0, s24, 3072
  s_nop 0
  buffer_load_dwordx4 v98, s[20:23], 0 offen nt lds
  v_add_u32 v98, s19, v98
  s_add_u32 m0, s24, 4096
  s_nop 0
  buffer_load_dwordx4 v98, s[20:23], 0 offen nt lds
  v_add_u32 v98, s19, v98
  s_add_u32 m0, s24, 5120
  s_nop 0
  buffer_load_dwordx4 v98, s[20:23], 0 offen nt lds
  v_add_u32 v98, s19, v98
  s_add_u32 m0, s24, 6144
  s_nop 0
  buffer_load_dwordx4 v98, s[20:23], 0 offen nt lds
  v_add_u32 v98, s19, v98
  s_add_u32 m0, s24, 7168
  s_nop 0
  buffer_load_dwordx4 v98, s[20:23], 0 offen nt lds
  s_waitcnt vmcnt(0)
kf_kernel_pb16:
  s_sub_u32 s33, s2, 168
  s_mul_i32 s33, s33, 5
  s_add_u32 s33, s33, s34
  s_sub_u32 s33, s33, 3
  s_mov_b32 s47, s32
  v_and_b32 v4, 15, v2
  v_lshrrev_b32 v5, 4, v2
  s_mov_b32 s23, 0x00020000
  s_cmp_ge_u32 s33, 280
  s_cbranch_scc1 kf_kernel_wo27
  s_mul_i32 s25, s33, 4682
  s_lshr_b32 s25, s25, 16
  s_mul_i32 s52, s25, 14
  s_sub_u32 s52, s33, s52
  s_movk_i32 s24, 3456
  s_lshl_b32 s53, s25, 5
  s_mov_b32 s57, 8
  s_mov_b32 s58, 4
  s_mov_b64 s[20:21], s[62:63]
  s_mov_b32 s22, 2211840
  s_branch kf_kernel_j28
kf_kernel_wo27:
  s_sub_u32 s35, s33, 280
  s_mul_i32 s25, s35, 13108
  s_lshr_b32 s25, s25, 16
  s_mul_i32 s52, s25, 5
  s_sub_u32 s52, s35, s52
  s_movk_i32 s24, 1280
  s_lshr_b32 s54, s25, 2
  s_and_b32 s55, s25, 3
  s_mul_i32 s53, s54, 112
  s_lshl_b32 s42, s55, 5
  s_add_u32 s53, s53, s42
  s_mov_b32 s57, 4
  s_mov_b32 s58, 16
  s_mov_b64 s[20:21], s[64:65]
  s_mov_b32 s22, 1105920
kf_kernel_j28:
  s_add_u32 s16, s40, 0x1900000
  s_addc_u32 s17, s41, 0
  s_mov_b32 s18, 0x418000
  s_mov_b32 s19, 0x00020000
  v_mul_u32_u24 v6, s57, v5
  v_lshrrev_b32 v7, 2, v4
  v_add_u32 v6, v6, v7
  v_and_b32 v7, 3, v4
  v_lshlrev_b32 v7, 3, v7
  v_lshl_add_u32 v6, v6, 8, v7
  v_add_u32 v6, s47, v6
  s_lshl_b32 s42, s58, 8
  v_add_u32 v7, s42, v6
  v_lshlrev_b32 v8, 3, v2
  s_waitcnt vmcnt(63)
  ds_read_b64_tr_b16 v[16:17], v6 offset:0
  ds_read_b64_tr_b16 v[18:19], v7 offset:0
  ds_read_b64_tr_b16 v[20:21], v6 offset:32
  ds_read_b64_tr_b16 v[22:23], v7 offset:32
  ds_read_b64_tr_b16 v[24:25], v6 offset:64
  ds_read_b64_tr_b16 v[26:27], v7 offset:64
  ds_read_b64_tr_b16 v[28:29], v6 offset:96
  ds_read_b64_tr_b16 v[30:31], v7 offset:96
  ds_read_b64_tr_b16 v[32:33], v6 offset:128
  ds_read_b64_tr_b16 v[34:35], v7 offset:128
  ds_read_b64_tr_b16 v[36:37], v6 offset:160
  ds_read_b64_tr_b16 v[38:39], v7 offset:160
  ds_read_b64_tr_b16 v[40:41], v6 offset:192
  ds_read_b64_tr_b16 v[42:43], v7 offset:192
  ds_read_b64_tr_b16 v[44:45], v6 offset:224
  ds_read_b64_tr_b16 v[46:47], v7 offset:224
  s_cmp_ge_u32 s33, 280
  s_cbranch_scc1 kf_kernel_wo229
  s_lshl_b32 s42, s52, 3
  s_add_u32 s42, s42, 0
  s_add_u32 s43, s42, 2
  s_cmp_ge_u32 s42, 54
  s_cselect_b32 s43, s43, s42
  s_cselect_b32 s46, 0, 1
  s_mul_i32 s44, s43, 9363
  s_lshr_b32 s44, s44, 16
  s_mul_i32 s45, s44, 7
  s_sub_u32 s43, s43, s45
  s_and_b32 s44, s44, 7
  s_lshl_b32 s44, s44, 1
  s_lshr_b32 s45, s43, 2
  s_xor_b32 s45, s45, s46
  s_add_u32 s44, s44, s45
  s_mul_i32 s44, s44, 140
  s_lshr_b32 s45, s43, 2
  s_and_b32 s43, s43, 3
  s_add_u32 s43, s43, s44
  s_mul_i32 s44, s45, 20
  s_add_u32 s44, s44, 60
  s_cmp_eq_u32 s46, 0
  s_cselect_b32 s44, s44, 0
  s_add_u32 s43, s43, s44
  s_sub_u32 s44, 4, s45
  s_mul_i32 s44, s44, s25
  s_add_u32 s43, s43, s44
  s_lshl_b32 s43, s43, 10
  s_waitcnt lgkmcnt(14)
  buffer_store_dwordx4 v[16:19], v3, s[16:19], s43 offen sc1
  s_lshl_b32 s42, s52, 3
  s_add_u32 s42, s42, 1
  s_add_u32 s43, s42, 2
  s_cmp_ge_u32 s42, 54
  s_cselect_b32 s43, s43, s42
  s_cselect_b32 s46, 0, 1
  s_mul_i32 s44, s43, 9363
  s_lshr_b32 s44, s44, 16
  s_mul_i32 s45, s44, 7
  s_sub_u32 s43, s43, s45
  s_and_b32 s44, s44, 7
  s_lshl_b32 s44, s44, 1
  s_lshr_b32 s45, s43, 2
  s_xor_b32 s45, s45, s46
  s_add_u32 s44, s44, s45
  s_mul_i32 s44, s44, 140
  s_lshr_b32 s45, s43, 2
  s_and_b32 s43, s43, 3
  s_add_u32 s43, s43, s44
  s_mul_i32 s44, s45, 20
  s_add_u32 s44, s44, 60
  s_cmp_eq_u32 s46, 0
  s_cselect_b32 s44, s44, 0
  s_add_u32 s43, s43, s44
  s_sub_u32 s44, 4, s45
  s_mul_i32 s44, s44, s25
  s_add_u32 s43, s43, s44
  s_lshl_b32 s43, s43, 10
  s_waitcnt lgkmcnt(12)
  buffer_store_dwordx4 v[20:23], v3, s[16:19], s43 offen sc1
  s_lshl_b32 s42, s52, 3
  s_add_u32 s42, s42, 2
  s_add_u32 s43, s42, 2
  s_cmp_ge_u32 s42, 54
  s_cselect_b32 s43, s43, s42
  s_cselect_b32 s46, 0, 1
  s_mul_i32 s44, s43, 9363
  s_lshr_b32 s44, s44, 16
  s_mul_i32 s45, s44, 7
  s_sub_u32 s43, s43, s45
  s_and_b32 s44, s44, 7
  s_lshl_b32 s44, s44, 1
  s_lshr_b32 s45, s43, 2
  s_xor_b32 s45, s45, s46
  s_add_u32 s44, s44, s45
  s_mul_i32 s44, s44, 140
  s_lshr_b32 s45, s43, 2
  s_and_b32 s43, s43, 3
  s_add_u32 s43, s43, s44
  s_mul_i32 s44, s45, 20
  s_add_u32 s44, s44, 60
  s_cmp_eq_u32 s46, 0
  s_cselect_b32 s44, s44, 0
  s_add_u32 s43, s43, s44
  s_sub_u32 s44, 4, s45
  s_mul_i32 s44, s44, s25
  s_add_u32 s43, s43, s44
  s_lshl_b32 s43, s43, 10
  s_waitcnt lgkmcnt(10)
  buffer_store_dwordx4 v[24:27], v3, s[16:19], s43 offen sc1
  s_lshl_b32 s42, s52, 3
  s_add_u32 s42, s42, 3
  s_add_u32 s43, s42, 2
  s_cmp_ge_u32 s42, 54
  s_cselect_b32 s43, s43, s42
  s_cselect_b32 s46, 0, 1
  s_mul_i32 s44, s43, 9363
  s_lshr_b32 s44, s44, 16
  s_mul_i32 s45, s44, 7
  s_sub_u32 s43, s43, s45
  s_and_b32 s44, s44, 7
  s_lshl_b32 s44, s44, 1
  s_lshr_b32 s45, s43, 2
  s_xor_b32 s45, s45, s46
  s_add_u32 s44, s44, s45
  s_mul_i32 s44, s44, 140
  s_lshr_b32 s45, s43, 2
  s_and_b32 s43, s43, 3
  s_add_u32 s43, s43, s44
  s_mul_i32 s44, s45, 20
  s_add_u32 s44, s44, 60
  s_cmp_eq_u32 s46, 0
  s_cselect_b32 s44, s44, 0
  s_add_u32 s43, s43, s44
  s_sub_u32 s44, 4, s45
  s_mul_i32 s44, s44, s25
  s_add_u32 s43, s43, s44
  s_lshl_b32 s43, s43, 10
  s_waitcnt lgkmcnt(8)
  buffer_store_dwordx4 v[28:31], v3, s[16:19], s43 offen sc1
  s_lshl_b32 s42, s52, 3
  s_add_u32 s42, s42, 4
  s_add_u32 s43, s42, 2
  s_cmp_ge_u32 s42, 54
  s_cselect_b32 s43, s43, s42
  s_cselect_b32 s46, 0, 1
  s_mul_i32 s44, s43, 9363
  s_lshr_b32 s44, s44, 16
  s_mul_i32 s45, s44, 7
  s_sub_u32 s43, s43, s45
  s_and_b32 s44, s44, 7
  s_lshl_b32 s44, s44, 1
  s_lshr_b32 s45, s43, 2
  s_xor_b32 s45, s45, s46
  s_add_u32 s44, s44, s45
  s_mul_i32 s44, s44, 140
  s_lshr_b32 s45, s43, 2
  s_and_b32 s43, s43, 3
  s_add_u32 s43, s43, s44
  s_mul_i32 s44, s45, 20
  s_add_u32 s44, s44, 60
  s_cmp_eq_u32 s46, 0
  s_cselect_b32 s44, s44, 0
  s_add_u32 s43, s43, s44
  s_sub_u32 s44, 4, s45
  s_mul_i32 s44, s44, s25
  s_add_u32 s43, s43, s44
  s_lshl_b32 s43, s43, 10
  s_waitcnt lgkmcnt(6)
  buffer_store_dwordx4 v[32:35], v3, s[16:19], s43 offen sc1
  s_lshl_b32 s42, s52, 3
  s_add_u32 s42, s42, 5
  s_add_u32 s43, s42, 2
  s_cmp_ge_u32 s42, 54
  s_cselect_b32 s43, s43, s42
  s_cselect_b32 s46, 0, 1
  s_mul_i32 s44, s43, 9363
  s_lshr_b32 s44, s44, 16
  s_mul_i32 s45, s44, 7
  s_sub_u32 s43, s43, s45
  s_and_b32 s44, s44, 7
  s_lshl_b32 s44, s44, 1
  s_lshr_b32 s45, s43, 2
  s_xor_b32 s45, s45, s46
  s_add_u32 s44, s44, s45
  s_mul_i32 s44, s44, 140
  s_lshr_b32 s45, s43, 2
  s_and_b32 s43, s43, 3
  s_add_u32 s43, s43, s44
  s_mul_i32 s44, s45, 20
  s_add_u32 s44, s44, 60
  s_cmp_eq_u32 s46, 0
  s_cselect_b32 s44, s44, 0
  s_add_u32 s43, s43, s44
  s_sub_u32 s44, 4, s45
  s_mul_i32 s44, s44, s25
  s_add_u32 s43, s43, s44
  s_lshl_b32 s43, s43, 10
  s_waitcnt lgkmcnt(4)
  buffer_store_dwordx4 v[36:39], v3, s[16:19], s43 offen sc1
  s_lshl_b32 s42, s52, 3
  s_add_u32 s42, s42, 6
  s_add_u32 s43, s42, 2
  s_cmp_ge_u32 s42, 54
  s_cselect_b32 s43, s43, s42
  s_cselect_b32 s46, 0, 1
  s_cmp_ge_u32 s42, 110
  s_cselect_b32 s43, 54, s43
  s_cselect_b32 s46, 1, s46
  s_mul_i32 s44, s43, 9363
  s_lshr_b32 s44, s44, 16
  s_mul_i32 s45, s44, 7
  s_sub_u32 s43, s43, s45
  s_and_b32 s44, s44, 7
  s_lshl_b32 s44, s44, 1
  s_lshr_b32 s45, s43, 2
  s_xor_b32 s45, s45, s46
  s_add_u32 s44, s44, s45
  s_mul_i32 s44, s44, 140
  s_lshr_b32 s45, s43, 2
  s_and_b32 s43, s43, 3
  s_add_u32 s43, s43, s44
  s_mul_i32 s44, s45, 20
  s_add_u32 s44, s44, 60
  s_cmp_eq_u32 s46, 0
  s_cselect_b32 s44, s44, 0
  s_add_u32 s43, s43, s44
  s_sub_u32 s44, 4, s45
  s_mul_i32 s44, s44, s25
  s_add_u32 s43, s43, s44
  s_lshl_b32 s43, s43, 10
  s_waitcnt lgkmcnt(2)
  buffer_store_dwordx4 v[40:43], v3, s[16:19], s43 offen sc1
  s_lshl_b32 s42, s52, 3
  s_add_u32 s42, s42, 7
  s_add_u32 s43, s42, 2
  s_cmp_ge_u32 s42, 54
  s_cselect_b32 s43, s43, s42
  s_cselect_b32 s46, 0, 1
  s_cmp_ge_u32 s42, 110
  s_cselect_b32 s43, 55, s43
  s_cselect_b32 s46, 1, s46
  s_mul_i32 s44, s43, 9363
  s_lshr_b32 s44, s44, 16
  s_mul_i32 s45, s44, 7
  s_sub_u32 s43, s43, s45
  s_and_b32 s44, s44, 7
  s_lshl_b32 s44, s44, 1
  s_lshr_b32 s45, s43, 2
  s_xor_b32 s45, s45, s46
  s_add_u32 s44, s44, s45
  s_mul_i32 s44, s44, 140
  s_lshr_b32 s45, s43, 2
  s_and_b32 s43, s43, 3
  s_add_u32 s43, s43, s44
  s_mul_i32 s44, s45, 20
  s_add_u32 s44, s44, 60
  s_cmp_eq_u32 s46, 0
  s_cselect_b32 s44, s44, 0
  s_add_u32 s43, s43, s44
  s_sub_u32 s44, 4, s45
  s_mul_i32 s44, s44, s25
  s_add_u32 s43, s43, s44
  s_lshl_b32 s43, s43, 10
  s_waitcnt lgkmcnt(0)
  buffer_store_dwordx4 v[44:47], v3, s[16:19], s43 offen sc1
  s_branch kf_kernel_pd13
kf_kernel_wo229:
  s_mul_i32 s56, s54, 17920
  s_mul_i32 s42, s55, 5120
  s_add_u32 s56, s56, 3145728
  s_add_u32 s56, s56, s42
  s_cmp_lt_u32 s53, 864
  s_cselect_b32 s59, -1, 0
  s_cmp_lt_u32 s53, 848
  s_cselect_b32 s60, -1, 0
  s_cmp_eq_u32 s55, 3
  s_cbranch_scc1 kf_kernel_sg30
  s_lshl_b32 s42, s52, 3
  s_add_u32 s42, s42, 0
  s_mul_i32 s44, s42, 13108
  s_lshr_b32 s44, s44, 16
  s_mul_i32 s45, s44, 5
  s_sub_u32 s43, s42, s45
  s_mul_i32 s44, s44, 143360
  s_lshl_b32 s43, s43, 10
  s_add_u32 s43, s43, s44
  s_add_u32 s43, s43, s56
  s_waitcnt lgkmcnt(14)
  v_and_b32 v16, s59, v16
  v_and_b32 v17, s59, v17
  v_and_b32 v18, s60, v18
  v_and_b32 v19, s60, v19
  buffer_store_dwordx4 v[16:19], v3, s[16:19], s43 offen sc1
  s_lshl_b32 s42, s52, 3
  s_add_u32 s42, s42, 1
  s_mul_i32 s44, s42, 13108
  s_lshr_b32 s44, s44, 16
  s_mul_i32 s45, s44, 5
  s_sub_u32 s43, s42, s45
  s_mul_i32 s44, s44, 143360
  s_lshl_b32 s43, s43, 10
  s_add_u32 s43, s43, s44
  s_add_u32 s43, s43, s56
  s_waitcnt lgkmcnt(12)
  v_and_b32 v20, s59, v20
  v_and_b32 v21, s59, v21
  v_and_b32 v22, s60, v22
  v_and_b32 v23, s60, v23
  buffer_store_dwordx4 v[20:23], v3, s[16:19], s43 offen sc1
  s_lshl_b32 s42, s52, 3
  s_add_u32 s42, s42, 2
  s_mul_i32 s44, s42, 13108
  s_lshr_b32 s44, s44, 16
  s_mul_i32 s45, s44, 5
  s_sub_u32 s43, s42, s45
  s_mul_i32 s44, s44, 143360
  s_lshl_b32 s43, s43, 10
  s_add_u32 s43, s43, s44
  s_add_u32 s43, s43, s56
  s_waitcnt lgkmcnt(10)
  v_and_b32 v24, s59, v24
  v_and_b32 v25, s59, v25
  v_and_b32 v26, s60, v26
  v_and_b32 v27, s60, v27
  buffer_store_dwordx4 v[24:27], v3, s[16:19], s43 offen sc1
  s_lshl_b32 s42, s52, 3
  s_add_u32 s42, s42, 3
  s_mul_i32 s44, s42, 13108
  s_lshr_b32 s44, s44, 16
  s_mul_i32 s45, s44, 5
  s_sub_u32 s43, s42, s45
  s_mul_i32 s44, s44, 143360
  s_lshl_b32 s43, s43, 10
  s_add_u32 s43, s43, s44
  s_add_u32 s43, s43, s56
  s_waitcnt lgkmcnt(8)
  v_and_b32 v28, s59, v28
  v_and_b32 v29, s59, v29
  v_and_b32 v30, s60, v30
  v_and_b32 v31, s60, v31
  buffer_store_dwordx4 v[28:31], v3, s[16:19], s43 offen sc1
  s_lshl_b32 s42, s52, 3
  s_add_u32 s42, s42, 4
  s_mul_i32 s44, s42, 13108
  s_lshr_b32 s44, s44, 16
  s_mul_i32 s45, s44, 5
  s_sub_u32 s43, s42, s45
  s_mul_i32 s44, s44, 143360
  s_lshl_b32 s43, s43, 10
  s_add_u32 s43, s43, s44
  s_add_u32 s43, s43, s56
  s_waitcnt lgkmcnt(6)
  v_and_b32 v32, s59, v32
  v_and_b32 v33, s59, v33
  v_and_b32 v34, s60, v34
  v_and_b32 v35, s60, v35
  buffer_store_dwordx4 v[32:35], v3, s[16:19], s43 offen sc1
  s_lshl_b32 s42, s52, 3
  s_add_u32 s42, s42, 5
  s_mul_i32 s44, s42, 13108
  s_lshr_b32 s44, s44, 16
  s_mul_i32 s45, s44, 5
  s_sub_u32 s43, s42, s45
  s_mul_i32 s44, s44, 143360
  s_lshl_b32 s43, s43, 10
  s_add_u32 s43, s43, s44
  s_add_u32 s43, s43, s56
  s_waitcnt lgkmcnt(4)
  v_and_b32 v36, s59, v36
  v_and_b32 v37, s59, v37
  v_and_b32 v38, s60, v38
  v_and_b32 v39, s60, v39
  buffer_store_dwordx4 v[36:39], v3, s[16:19], s43 offen sc1
  s_lshl_b32 s42, s52, 3
  s_add_u32 s42, s42, 6
  s_mul_i32 s44, s42, 13108
  s_lshr_b32 s44, s44, 16
  s_mul_i32 s45, s44, 5
  s_sub_u32 s43, s42, s45
  s_mul_i32 s44, s44, 143360
  s_lshl_b32 s43, s43, 10
  s_add_u32 s43, s43, s44
  s_add_u32 s43, s43, s56
  s_waitcnt lgkmcnt(2)
  v_and_b32 v40, s59, v40
  v_and_b32 v41, s59, v41
  v_and_b32 v42, s60, v42
  v_and_b32 v43, s60, v43
  buffer_store_dwordx4 v[40:43], v3, s[16:19], s43 offen sc1
  s_lshl_b32 s42, s52, 3
  s_add_u32 s42, s42, 7
  s_mul_i32 s44, s42, 13108
  s_lshr_b32 s44, s44, 16
  s_mul_i32 s45, s44, 5
  s_sub_u32 s43, s42, s45
  s_mul_i32 s44, s44, 143360
  s_lshl_b32 s43, s43, 10
  s_add_u32 s43, s43, s44
  s_add_u32 s43, s43, s56
  s_waitcnt lgkmcnt(0)
  v_and_b32 v44, s59, v44
  v_and_b32 v45, s59, v45
  v_and_b32 v46, s60, v46
  v_and_b32 v47, s60, v47
  buffer_store_dwordx4 v[44:47], v3, s[16:19], s43 offen sc1
  s_branch kf_kernel_pd13
kf_kernel_sg30:
  s_lshl_b32 s42, s52, 3
  s_add_u32 s42, s42, 0
  s_mul_i32 s44, s42, 13108
  s_lshr_b32 s44, s44, 16
  s_mul_i32 s45, s44, 5
  s_sub_u32 s43, s42, s45
  s_mul_i32 s44, s44, 143360
  s_lshl_b32 s43, s43, 9
  s_add_u32 s43, s43, s44
  s_add_u32 s43, s43, s56
  s_waitcnt lgkmcnt(14)
  v_and_b32 v16, s59, v16
  v_and_b32 v17, s59, v17
  buffer_store_dwordx2 v[16:17], v8, s[16:19], s43 offen sc1
  s_lshl_b32 s42, s52, 3
  s_add_u32 s42, s42, 1
  s_mul_i32 s44, s42, 13108
  s_lshr_b32 s44, s44, 16
  s_mul_i32 s45, s44, 5
  s_sub_u32 s43, s42, s45
  s_mul_i32 s44, s44, 143360
  s_lshl_b32 s43, s43, 9
  s_add_u32 s43, s43, s44
  s_add_u32 s43, s43, s56
  s_waitcnt lgkmcnt(12)
  v_and_b32 v20, s59, v20
  v_and_b32 v21, s59, v21
  buffer_store_dwordx2 v[20:21], v8, s[16:19], s43 offen sc1
  s_lshl_b32 s42, s52, 3
  s_add_u32 s42, s42, 2
  s_mul_i32 s44, s42, 13108
  s_lshr_b32 s44, s44, 16
  s_mul_i32 s45, s44, 5
  s_sub_u32 s43, s42, s45
  s_mul_i32 s44, s44, 143360
  s_lshl_b32 s43, s43, 9
  s_add_u32 s43, s43, s44
  s_add_u32 s43, s43, s56
  s_waitcnt lgkmcnt(10)
  v_and_b32 v24, s59, v24
  v_and_b32 v25, s59, v25
  buffer_store_dwordx2 v[24:25], v8, s[16:19], s43 offen sc1
  s_lshl_b32 s42, s52, 3
  s_add_u32 s42, s42, 3
  s_mul_i32 s44, s42, 13108
  s_lshr_b32 s44, s44, 16
  s_mul_i32 s45, s44, 5
  s_sub_u32 s43, s42, s45
  s_mul_i32 s44, s44, 143360
  s_lshl_b32 s43, s43, 9
  s_add_u32 s43, s43, s44
  s_add_u32 s43, s43, s56
  s_waitcnt lgkmcnt(8)
  v_and_b32 v28, s59, v28
  v_and_b32 v29, s59, v29
  buffer_store_dwordx2 v[28:29], v8, s[16:19], s43 offen sc1
  s_lshl_b32 s42, s52, 3
  s_add_u32 s42, s42, 4
  s_mul_i32 s44, s42, 13108
  s_lshr_b32 s44, s44, 16
  s_mul_i32 s45, s44, 5
  s_sub_u32 s43, s42, s45
  s_mul_i32 s44, s44, 143360
  s_lshl_b32 s43, s43, 9
  s_add_u32 s43, s43, s44
  s_add_u32 s43, s43, s56
  s_waitcnt lgkmcnt(6)
  v_and_b32 v32, s59, v32
  v_and_b32 v33, s59, v33
  buffer_store_dwordx2 v[32:33], v8, s[16:19], s43 offen sc1
  s_lshl_b32 s42, s52, 3
  s_add_u32 s42, s42, 5
  s_mul_i32 s44, s42, 13108
  s_lshr_b32 s44, s44, 16
  s_mul_i32 s45, s44, 5
  s_sub_u32 s43, s42, s45
  s_mul_i32 s44, s44, 143360
  s_lshl_b32 s43, s43, 9
  s_add_u32 s43, s43, s44
  s_add_u32 s43, s43, s56
  s_waitcnt lgkmcnt(4)
  v_and_b32 v36, s59, v36
  v_and_b32 v37, s59, v37
  buffer_store_dwordx2 v[36:37], v8, s[16:19], s43 offen sc1
  s_lshl_b32 s42, s52, 3
  s_add_u32 s42, s42, 6
  s_mul_i32 s44, s42, 13108
  s_lshr_b32 s44, s44, 16
  s_mul_i32 s45, s44, 5
  s_sub_u32 s43, s42, s45
  s_mul_i32 s44, s44, 143360
  s_lshl_b32 s43, s43, 9
  s_add_u32 s43, s43, s44
  s_add_u32 s43, s43, s56
  s_waitcnt lgkmcnt(2)
  v_and_b32 v40, s59, v40
  v_and_b32 v41, s59, v41
  buffer_store_dwordx2 v[40:41], v8, s[16:19], s43 offen sc1
  s_lshl_b32 s42, s52, 3
  s_add_u32 s42, s42, 7
  s_mul_i32 s44, s42, 13108
  s_lshr_b32 s44, s44, 16
  s_mul_i32 s45, s44, 5
  s_sub_u32 s43, s42, s45
  s_mul_i32 s44, s44, 143360
  s_lshl_b32 s43, s43, 9
  s_add_u32 s43, s43, s44
  s_add_u32 s43, s43, s56
  s_waitcnt lgkmcnt(0)
  v_and_b32 v44, s59, v44
  v_and_b32 v45, s59, v45
  buffer_store_dwordx2 v[44:45], v8, s[16:19], s43 offen sc1
  s_branch kf_kernel_pd13
kf_kernel_pd13:
  s_lshl_b32 s42, s33, 2
  s_add_u32 s42, s42, 139264
  v_lshlrev_b32 v12, 7, v3
  v_mov_b32 v13, 2814633361
  s_lshl_b32 s33, s3, 6
  s_add_u32 s33, s33, 32768
  s_load_dwordx16 s[16:31], s[12:13], s33
  s_mov_b64 exec, 0xff
  s_waitcnt vmcnt(0)
  buffer_store_dword v13, v12, s[68:71], s42 offen sc1
  s_mov_b64 exec, -1
  s_mov_b64 exec, 1
  v_mov_b32 v127, 0x100
  ds_add_u32 v126, v127
  s_mov_b64 exec, -1
kf_kernel_j111:
  v_and_b32 v4, 15, v2
  v_lshrrev_b32 v5, 4, v2
  s_and_b32 s33, s2, 7
  s_lshr_b32 s35, s2, 3
  v_lshrrev_b32 v7, 2, v2
  v_and_b32 v8, 3, v2
  v_mul_u32_u24 v6, 172032, v7
  v_lshl_add_u32 v6, v8, 4, v6
  s_lshl_b32 s36, s34, 4
  s_add_u32 s36, s36, s33
  s_mul_i32 s36, s36, 1344
  s_lshl_b32 s37, s35, 6
  s_add_u32 s36, s36, s37
  s_add_u32 s42, s36, 10752
  s_and_b32 s37, s33, 0
  s_lshl_b32 s37, s37, 2
  s_sub_u32 s43, s36, s37
  s_sub_u32 s44, s42, s37
  s_lshl_b32 s45, s33, 10
  s_lshl_b32 s49, s33, 11
  s_add_u32 s49, s49, 139264
  s_lshl_b32 s37, s34, 7
  s_add_u32 s45, s45, s37
  s_add_u32 s45, s45, 131072
  v_and_b32 v9, 31, v2
  v_lshlrev_b32 v9, 2, v9
  s_mov_b32 s60, s40
  s_mov_b32 s61, s41
  s_mov_b32 s62, 0x2a0000
  s_mov_b32 s63, 0x00020000
  s_mov_b32 s8, s40
  s_mov_b32 s9, s41
  s_mov_b32 s10, 0x2a0000
  s_mov_b32 s11, 0x00020000
  s_add_u32 s64, s40, 0x1900000
  s_addc_u32 s65, s41, 0
  s_mov_b32 s66, 0x230000
  s_mov_b32 s67, 0x00020000
  s_bfe_u32 s58, s2, 0x10002
  s_lshl_b32 s58, s58, 3
  s_lshr_b32 s57, s2, 5
  s_add_u32 s58, s58, s57
  s_lshl_b32 s58, s58, 2
  s_and_b32 s57, s2, 3
  s_add_u32 s58, s58, s57
  s_lshl_b32 s58, s58, 2
  s_bfe_u32 s57, s2, 0x20003
  s_add_u32 s58, s58, s57
  s_and_b32 s58, s58, 15
  s_mul_i32 s58, s58, 143360
  s_mov_b32 s56, s32
  s_sub_u32 s57, s32, 20480
  s_add_u32 s57, s57, s58
  s_cmp_ge_u32 s2, 168
  s_cbranch_scc1 kf_kernel_idle9
  v_mul_u32_u24 v10, 4160, v8
  v_lshl_add_u32 v10, v7, 2, v10
  s_lshl_b32 s37, s34, 7
  v_add_u32 v10, s37, v10
  v_lshlrev_b32 v12, 6, v4
  v_lshl_add_u32 v12, v5, 4, v12
  s_mul_i32 s37, s34, 2080
  v_add_u32 v12, s37, v12
  ds_read_b128 v[96:99], v3 offset:33280
  ds_read_b128 v[100:103], v3 offset:34304
  ds_read_b128 v[104:107], v3 offset:35328
  ds_read_b128 v[108:111], v3 offset:36352
  ds_read_b128 v[118:121], v3 offset:37376
  ds_read_b64 v[116:117], v3 offset:38400
  ds_read_b128 v[112:115], v3 offset:40448
  s_sleep 30
  s_barrier
  buffer_load_dword v13, v9, s[68:71], s45 offen sc1
  s_lshl_b32 s39, s34, 4
  s_add_u32 s39, s39, s33
  s_mul_i32 s39, s39, 642
  s_lshl_b32 s37, s35, 5
  s_add_u32 s39, s39, s37
  s_and_b32 s39, s39, -4
  s_add_u32 s37, s39, 5136
  v_mul_u32_u24 v14, 82176, v7
  v_lshl_add_u32 v14, v8, 3, v14
  s_mov_b32 s4, s54
  s_mov_b32 s5, s55
  s_mov_b32 s54, 1314816
  s_mov_b32 s55, 0x00020000
  s_mov_b32 s6, 1314816
  s_mov_b32 s7, 0x00020000
  buffer_load_dwordx3 v[80:82], v14, s[52:55], s39 offen
  buffer_load_dwordx3 v[88:90], v14, s[4:7], s39 offen
  buffer_load_dwordx3 v[84:86], v14, s[52:55], s37 offen
  buffer_load_dwordx3 v[92:94], v14, s[4:7], s37 offen
  s_and_b32 s39, s33, 1
  s_lshl_b32 s39, s39, 4
  s_mov_b32 s47, 0x05040100
  s_mov_b32 s48, 0x07060302
  s_mov_b32 s46, 400000
  s_waitcnt vmcnt(4)
  s_branch kf_kernel_l133
kf_kernel_lp31:
  buffer_load_dword v13, v9, s[68:71], s45 offen sc1
  s_waitcnt vmcnt(0)
kf_kernel_l133:
  v_cmp_ne_u32 vcc, 2814633361, v13
  s_cbranch_vccz kf_kernel_ld32
  s_sub_u32 s46, s46, 1
  s_cmp_lg_u32 s46, 0
  s_cbranch_scc1 kf_kernel_lp31
kf_kernel_ld32:
  buffer_load_dwordx4 v[16:19], v6, s[60:63], s43 offen
  buffer_load_dwordx4 v[20:23], v6, s[60:63], s44 offen
  s_waitcnt vmcnt(2)
  v_alignbit_b32 v64, v81, v80, s39
  v_alignbit_b32 v65, v82, v81, s39
  v_alignbit_b32 v66, v85, v84, s39
  v_alignbit_b32 v67, v86, v85, s39
  v_alignbit_b32 v68, v89, v88, s39
  v_alignbit_b32 v69, v90, v89, s39
  v_alignbit_b32 v70, v93, v92, s39
  v_alignbit_b32 v71, v94, v93, s39
  v_perm_b32 v72, v68, v64, s47
  ds_write_b32 v10, v72 offset:16640
  v_perm_b32 v73, v68, v64, s48
  ds_write_b32 v10, v73 offset:17680
  v_perm_b32 v74, v69, v65, s47
  ds_write_b32 v10, v74 offset:18720
  v_perm_b32 v75, v69, v65, s48
  ds_write_b32 v10, v75 offset:19760
  v_perm_b32 v76, v70, v66, s47
  ds_write_b32 v10, v76 offset:16704
  v_perm_b32 v77, v70, v66, s48
  ds_write_b32 v10, v77 offset:17744
  v_perm_b32 v78, v71, v67, s47
  ds_write_b32 v10, v78 offset:18784
  v_perm_b32 v79, v71, v67, s48
  ds_write_b32 v10, v79 offset:19824
  s_waitcnt vmcnt(1)
  ds_write_b32 v10, v16 offset:0
  ds_write_b32 v10, v17 offset:1040
  ds_write_b32 v10, v18 offset:2080
  ds_write_b32 v10, v19 offset:3120
  s_waitcnt vmcnt(0)
  ds_write_b32 v10, v20 offset:64
  ds_write_b32 v10, v21 offset:1104
  ds_write_b32 v10, v22 offset:2144
  ds_write_b32 v10, v23 offset:3184
  buffer_load_dwordx4 a[0:3], v124, s[72:75], s50 offen
  buffer_load_dwordx4 a[64:67], v124, s[72:75], s51 offen
  s_add_u32 s50, s50, 1048576
  s_add_u32 s51, s51, 1048576
  buffer_load_dwordx4 a[16:19], v124, s[72:75], s50 offen
  buffer_load_dwordx4 a[80:83], v124, s[72:75], s51 offen
  s_add_u32 s50, s50, 1048576
  s_add_u32 s51, s51, 1048576
  buffer_load_dwordx4 a[32:35], v124, s[72:75], s50 offen
  buffer_load_dwordx4 a[96:99], v124, s[72:75], s51 offen
  s_add_u32 s50, s50, 1048576
  s_add_u32 s51, s51, 1048576
  s_waitcnt lgkmcnt(0)
  s_barrier
  buffer_load_dwordx4 a[48:51], v124, s[72:75], s50 offen
  ds_read_b128 v[16:19], v12
  ds_read_b128 v[20:23], v12 offset:1040
  ds_read_b128 v[32:35], v12 offset:16640
  ds_read_b128 v[36:39], v12 offset:17680
  s_waitcnt lgkmcnt(3)
  v_mfma_f32_16x16x32_bf16 v[48:51], v[16:19], v[96:99], 0
  v_mfma_f32_16x16x32_bf16 v[52:55], v[16:19], v[100:103], 0
  s_waitcnt lgkmcnt(2)
  buffer_load_dwordx4 a[112:115], v124, s[72:75], s51 offen
  s_xor_b32 s50, s82, 16384
  s_add_u32 s51, s50, 4096
  v_mfma_f32_16x16x32_bf16 v[56:59], v[20:23], v[96:99], 0
  v_mfma_f32_16x16x32_bf16 v[60:63], v[20:23], v[100:103], 0
  s_waitcnt lgkmcnt(0)
  v_lshlrev_b32 v64, 16, v32
  v_and_b32 v68, 0xffff0000, v32
  v_lshlrev_b32 v65, 16, v33
  v_and_b32 v69, 0xffff0000, v33
  v_lshlrev_b32 v66, 16, v34
  buffer_load_dwordx4 a[4:7], v124, s[72:75], s50 offen
  v_and_b32 v70, 0xffff0000, v34
  v_lshlrev_b32 v67, 16, v35
  v_and_b32 v71, 0xffff0000, v35
  v_lshlrev_b32 v72, 16, v36
  v_and_b32 v76, 0xffff0000, v36
  v_lshlrev_b32 v73, 16, v37
  buffer_load_dwordx4 a[68:71], v124, s[72:75], s51 offen
  s_add_u32 s50, s50, 1048576
  s_add_u32 s51, s51, 1048576
  v_and_b32 v77, 0xffff0000, v37
  v_lshlrev_b32 v74, 16, v38
  v_and_b32 v78, 0xffff0000, v38
  v_lshlrev_b32 v75, 16, v39
  v_and_b32 v79, 0xffff0000, v39
  v_pk_mul_f32 v[88:89], v[52:53], v[108:109]
  v_pk_mul_f32 v[90:91], v[54:55], v[110:111]
  buffer_load_dwordx4 a[20:23], v124, s[72:75], s50 offen
  v_pk_mul_f32 v[84:85], v[52:53], v[104:105]
  v_pk_mul_f32 v[86:87], v[54:55], v[106:107]
  v_pk_fma_f32 v[80:81], v[48:49], v[104:105], v[88:89] neg_lo:[0,0,1] neg_hi:[0,0,1]
  v_pk_fma_f32 v[82:83], v[50:51], v[106:107], v[90:91] neg_lo:[0,0,1] neg_hi:[0,0,1]
  v_pk_fma_f32 v[84:85], v[48:49], v[108:109], v[84:85]
  v_pk_fma_f32 v[86:87], v[50:51], v[110:111], v[86:87]
  buffer_load_dwordx4 a[84:87], v124, s[72:75], s51 offen
  s_add_u32 s50, s50, 1048576
  s_add_u32 s51, s51, 1048576
  v_cvt_pk_bf16_f32 v16, v80, v81
  v_cvt_pk_bf16_f32 v17, v82, v83
  v_cvt_pk_bf16_f32 v18, v84, v85
  v_cvt_pk_bf16_f32 v19, v86, v87
  s_nop 1
  v_mfma_f32_16x16x32_bf16 v[48:51], v[118:121], v[16:19], 0
  v_mfma_f32_16x16x32_bf16 v[52:55], v[116:119], v[16:19], 0
  v_pk_mul_f32 v[88:89], v[60:61], v[108:109]
  buffer_load_dwordx4 a[36:39], v124, s[72:75], s50 offen
  v_pk_mul_f32 v[90:91], v[62:63], v[110:111]
  v_pk_mul_f32 v[84:85], v[60:61], v[104:105]
  v_pk_mul_f32 v[86:87], v[62:63], v[106:107]
  v_pk_fma_f32 v[80:81], v[56:57], v[104:105], v[88:89] neg_lo:[0,0,1] neg_hi:[0,0,1]
  v_pk_fma_f32 v[82:83], v[58:59], v[106:107], v[90:91] neg_lo:[0,0,1] neg_hi:[0,0,1]
  v_pk_fma_f32 v[84:85], v[56:57], v[108:109], v[84:85]
  buffer_load_dwordx4 a[100:103], v124, s[72:75], s51 offen
  s_add_u32 s50, s50, 1048576
  s_add_u32 s51, s51, 1048576
  v_pk_fma_f32 v[86:87], v[58:59], v[110:111], v[86:87]
  v_cvt_pk_bf16_f32 v20, v80, v81
  v_cvt_pk_bf16_f32 v21, v82, v83
  v_cvt_pk_bf16_f32 v22, v84, v85
  v_cvt_pk_bf16_f32 v23, v86, v87
  s_nop 1
  v_mfma_f32_16x16x32_bf16 v[56:59], v[118:121], v[20:23], 0
  v_mfma_f32_16x16x32_bf16 v[60:63], v[116:119], v[20:23], 0
  s_cmp_lt_u32 s34, 7
  s_cbranch_scc1 kf_kernel_o734
  buffer_load_dwordx4 v[24:27], v3, s[68:71], s49 offen sc1
  buffer_load_dwordx4 v[28:31], v3, s[68:71], s49 offen offset:736 sc1
kf_kernel_o734:
  buffer_load_dwordx4 a[52:55], v124, s[72:75], s50 offen
  v_pk_mul_f32 v[88:89], v[52:53], v[68:69]
  v_pk_mul_f32 v[90:91], v[54:55], v[70:71]
  v_pk_mul_f32 v[84:85], v[52:53], v[64:65]
  v_pk_mul_f32 v[86:87], v[54:55], v[66:67]
  buffer_load_dwordx4 a[116:119], v124, s[72:75], s51 offen
  s_xor_b32 s50, s82, 4194304
  s_add_u32 s51, s50, 4096
  v_pk_fma_f32 v[80:81], v[48:49], v[64:65], v[88:89] neg_lo:[0,0,1] neg_hi:[0,0,1]
  v_pk_fma_f32 v[82:83], v[50:51], v[66:67], v[90:91] neg_lo:[0,0,1] neg_hi:[0,0,1]
  v_pk_fma_f32 v[84:85], v[48:49], v[68:69], v[84:85]
  v_pk_fma_f32 v[86:87], v[50:51], v[70:71], v[86:87]
  buffer_load_dwordx4 a[8:11], v124, s[72:75], s50 offen
  v_cvt_pk_bf16_f32 v16, v80, v81
  v_cvt_pk_bf16_f32 v17, v82, v83
  v_cvt_pk_bf16_f32 v18, v84, v85
  v_cvt_pk_bf16_f32 v19, v86, v87
  buffer_load_dwordx4 a[72:75], v124, s[72:75], s51 offen
  s_add_u32 s50, s50, 1048576
  s_add_u32 s51, s51, 1048576
  v_mfma_f32_16x16x32_bf16 v[48:51], v[16:19], v[114:117], 0
  v_mfma_f32_16x16x32_bf16 v[52:55], v[16:19], v[112:115], 0
  v_pk_mul_f32 v[88:89], v[60:61], v[76:77]
  v_pk_mul_f32 v[90:91], v[62:63], v[78:79]
  buffer_load_dwordx4 a[24:27], v124, s[72:75], s50 offen
  v_pk_mul_f32 v[84:85], v[60:61], v[72:73]
  v_pk_mul_f32 v[86:87], v[62:63], v[74:75]
  v_pk_fma_f32 v[80:81], v[56:57], v[72:73], v[88:89] neg_lo:[0,0,1] neg_hi:[0,0,1]
  v_pk_fma_f32 v[82:83], v[58:59], v[74:75], v[90:91] neg_lo:[0,0,1] neg_hi:[0,0,1]
  buffer_load_dwordx4 a[88:91], v124, s[72:75], s51 offen
  s_add_u32 s50, s50, 1048576
  s_add_u32 s51, s51, 1048576
  v_pk_fma_f32 v[84:85], v[56:57], v[76:77], v[84:85]
  v_pk_fma_f32 v[86:87], v[58:59], v[78:79], v[86:87]
  v_cvt_pk_bf16_f32 v20, v80, v81
  v_cvt_pk_bf16_f32 v21, v82, v83
  buffer_load_dwordx4 a[40:43], v124, s[72:75], s50 offen
  v_cvt_pk_bf16_f32 v22, v84, v85
  v_cvt_pk_bf16_f32 v23, v86, v87
  s_nop 1
  v_mfma_f32_16x16x32_bf16 v[56:59], v[20:23], v[114:117], 0
  v_mfma_f32_16x16x32_bf16 v[60:63], v[20:23], v[112:115], 0
  buffer_load_dwordx4 a[104:107], v124, s[72:75], s51 offen
  s_add_u32 s50, s50, 1048576
  s_add_u32 s51, s51, 1048576
  v_pk_mul_f32 v[88:89], v[52:53], v[108:109]
  v_pk_mul_f32 v[90:91], v[54:55], v[110:111]
  v_pk_mul_f32 v[84:85], v[52:53], v[104:105]
  v_pk_mul_f32 v[86:87], v[54:55], v[106:107]
  buffer_load_dwordx4 a[56:59], v124, s[72:75], s50 offen
  v_pk_fma_f32 v[80:81], v[48:49], v[104:105], v[88:89]
  v_pk_fma_f32 v[82:83], v[50:51], v[106:107], v[90:91]
  v_pk_fma_f32 v[84:85], v[48:49], v[108:109], v[84:85] neg_lo:[1,0,0] neg_hi:[1,0,0]
  v_pk_fma_f32 v[86:87], v[50:51], v[110:111], v[86:87] neg_lo:[1,0,0] neg_hi:[1,0,0]
  buffer_load_dwordx4 a[120:123], v124, s[72:75], s51 offen
  s_xor_b32 s50, s82, 4210688
  s_add_u32 s51, s50, 4096
  v_cvt_pk_bf16_f32 v16, v80, v81
  v_cvt_pk_bf16_f32 v17, v82, v83
  v_cvt_pk_bf16_f32 v18, v84, v85
  v_cvt_pk_bf16_f32 v19, v86, v87
  buffer_load_dwordx4 a[12:15], v124, s[72:75], s50 offen
  s_nop 0
  v_mfma_f32_16x16x32_bf16 v[48:51], v[114:117], v[16:19], 0
  v_mfma_f32_16x16x32_bf16 v[52:55], v[112:115], v[16:19], 0
  v_pk_mul_f32 v[88:89], v[60:61], v[108:109]
  v_pk_mul_f32 v[90:91], v[62:63], v[110:111]
  buffer_load_dwordx4 a[76:79], v124, s[72:75], s51 offen
  s_add_u32 s50, s50, 1048576
  s_add_u32 s51, s51, 1048576
  v_pk_mul_f32 v[84:85], v[60:61], v[104:105]
  v_pk_mul_f32 v[86:87], v[62:63], v[106:107]
  v_pk_fma_f32 v[80:81], v[56:57], v[104:105], v[88:89]
  v_pk_fma_f32 v[82:83], v[58:59], v[106:107], v[90:91]
  buffer_load_dwordx4 a[28:31], v124, s[72:75], s50 offen
  v_pk_fma_f32 v[84:85], v[56:57], v[108:109], v[84:85] neg_lo:[1,0,0] neg_hi:[1,0,0]
  v_pk_fma_f32 v[86:87], v[58:59], v[110:111], v[86:87] neg_lo:[1,0,0] neg_hi:[1,0,0]
  v_cvt_pk_bf16_f32 v20, v80, v81
  v_cvt_pk_bf16_f32 v21, v82, v83
  buffer_load_dwordx4 a[92:95], v124, s[72:75], s51 offen
  s_add_u32 s50, s50, 1048576
  s_add_u32 s51, s51, 1048576
  v_cvt_pk_bf16_f32 v22, v84, v85
  v_cvt_pk_bf16_f32 v23, v86, v87
  s_nop 1
  v_mfma_f32_16x16x32_bf16 v[56:59], v[114:117], v[20:23], 0
  v_mfma_f32_16x16x32_bf16 v[60:63], v[112:115], v[20:23], 0
  v_cvt_pk_bf16_f32 v16, v48, v52
  v_cvt_pk_bf16_f32 v17, v49, v53
  v_cvt_pk_bf16_f32 v18, v50, v54
  v_cvt_pk_bf16_f32 v19, v51, v55
  v_or_b32 v16, 1, v16
  v_or_b32 v17, 1, v17
  v_or_b32 v18, 1, v18
  v_or_b32 v19, 1, v19
  ds_write_b128 v12, v[16:19] offset:0
  v_cvt_pk_bf16_f32 v20, v56, v60
  v_cvt_pk_bf16_f32 v21, v57, v61
  v_cvt_pk_bf16_f32 v22, v58, v62
  v_cvt_pk_bf16_f32 v23, v59, v63
  v_or_b32 v20, 1, v20
  v_or_b32 v21, 1, v21
  v_or_b32 v22, 1, v22
  v_or_b32 v23, 1, v23
  ds_write_b128 v12, v[20:23] offset:1040
  s_waitcnt lgkmcnt(0)
  s_barrier
  ds_read_b32 v16, v10 offset:0
  ds_read_b32 v17, v10 offset:1040
  ds_read_b32 v18, v10 offset:2080
  ds_read_b32 v19, v10 offset:3120
  ds_read_b32 v20, v10 offset:64
  ds_read_b32 v21, v10 offset:1104
  ds_read_b32 v22, v10 offset:2144
  ds_read_b32 v23, v10 offset:3184
  ds_read_b128 v[64:67], v3 offset:41472
  ds_read_b128 v[68:71], v3 offset:42496
  ds_read_b128 v[72:75], v3 offset:43520
  ds_read_b128 v[76:79], v3 offset:44544
  ds_read_b128 v[80:83], v3 offset:45568
  ds_read_b128 v[84:87], v3 offset:46592
  ds_read_b128 v[88:91], v3 offset:47616
  ds_read_b128 v[92:95], v3 offset:48640
  ds_read_b128 v[96:99], v3 offset:49664
  s_waitcnt lgkmcnt(13)
  buffer_store_dwordx4 v[16:19], v6, s[8:11], s36 offen sc1
  s_waitcnt lgkmcnt(9)
  buffer_store_dwordx4 v[20:23], v6, s[8:11], s42 offen sc1
  s_barrier
  s_cmp_lt_u32 s34, 7
  s_cbranch_scc1 kf_kernel_o735
  s_mov_b32 s43, 400000
  s_waitcnt vmcnt(16)
  s_branch kf_kernel_l138
kf_kernel_lp36:
  s_sleep 4
  buffer_load_dwordx4 v[24:27], v3, s[68:71], s49 offen sc1
  buffer_load_dwordx4 v[28:31], v3, s[68:71], s49 offen offset:736 sc1
  s_waitcnt vmcnt(0)
kf_kernel_l138:
  v_min3_u32 v13, v24, v25, v26
  v_max3_u32 v14, v24, v25, v26
  v_min3_u32 v13, v13, v27, v28
  v_max3_u32 v14, v14, v27, v28
  v_min3_u32 v13, v13, v29, v30
  v_max3_u32 v14, v14, v29, v30
  v_min_u32 v13, v13, v31
  v_max_u32 v14, v14, v31
  v_xor_b32 v13, 2814633361, v13
  v_xor_b32 v14, 2814633361, v14
  v_or_b32 v24, v13, v14
  v_cmp_ne_u32 vcc, 0, v24
  s_cbranch_vccz kf_kernel_ld37
  s_sub_u32 s43, s43, 1
  s_cmp_lg_u32 s43, 0
  s_cbranch_scc1 kf_kernel_lp36
kf_kernel_ld37:
kf_kernel_o735:
  buffer_load_dwordx4 a[44:47], v124, s[72:75], s50 offen
  buffer_load_dwordx4 a[108:111], v124, s[72:75], s51 offen
  s_add_u32 s50, s50, 1048576
  s_add_u32 s51, s51, 1048576
  buffer_load_dwordx4 a[60:63], v124, s[72:75], s50 offen
  buffer_load_dwordx4 a[124:127], v124, s[72:75], s51 offen
  s_branch kf_kernel_join10
kf_kernel_idle9:
  s_cmp_ge_u32 s34, 3
  s_cbranch_scc1 kf_kernel_ld40x
  s_sub_u32 s43, s35, 21
  s_and_b32 s44, s33, 1
  s_mul_i32 s44, s44, 11
  s_add_u32 s43, s43, s44
  s_mul_i32 s44, s34, 22
  s_add_u32 s44, s44, s43
  s_lshr_b32 s46, s33, 1
  s_lshl_b32 s46, s46, 18
  v_lshlrev_b32 v10, 7, v2
  s_mov_b32 s43, 400000
kf_kernel_lp39:
  ds_read_b32 v11, v126
  s_waitcnt lgkmcnt(0)
  v_cmp_gt_u32 vcc, 0x800, v11
  s_cbranch_vccz kf_kernel_ld40
  s_sleep 1
  s_sub_u32 s43, s43, 1
  s_cmp_lg_u32 s43, 0
  s_cbranch_scc1 kf_kernel_lp39
kf_kernel_ld40:
  s_and_b32 s47, s44, 31
  s_lshl_b32 s47, s47, 13
  s_lshr_b32 s48, s44, 5
  s_lshl_b32 s48, s48, 20
  s_add_u32 s47, s47, s48
  s_add_u32 s47, s47, s46
  buffer_load_ubyte v11, v10, s[72:75], s47 offen
  s_add_u32 s44, s44, 66
  s_and_b32 s47, s44, 31
  s_lshl_b32 s47, s47, 13
  s_lshr_b32 s48, s44, 5
  s_lshl_b32 s48, s48, 20
  s_add_u32 s47, s47, s48
  s_add_u32 s47, s47, s46
  buffer_load_ubyte v11, v10, s[72:75], s47 offen
  s_add_u32 s44, s44, 66
  s_and_b32 s47, s44, 31
  s_lshl_b32 s47, s47, 13
  s_lshr_b32 s48, s44, 5
  s_lshl_b32 s48, s48, 20
  s_add_u32 s47, s47, s48
  s_add_u32 s47, s47, s46
  buffer_load_ubyte v11, v10, s[72:75], s47 offen
  s_add_u32 s44, s44, 66
  s_and_b32 s47, s44, 31
  s_lshl_b32 s47, s47, 13
  s_lshr_b32 s48, s44, 5
  s_lshl_b32 s48, s48, 20
  s_add_u32 s47, s47, s48
  s_add_u32 s47, s47, s46
  buffer_load_ubyte v11, v10, s[72:75], s47 offen
  s_add_u32 s44, s44, 66
kf_kernel_ld40x:
  s_barrier
  buffer_load_dwordx4 a[0:3], v124, s[72:75], s50 offen
  buffer_load_dwordx4 a[64:67], v124, s[72:75], s51 offen
  s_add_u32 s50, s50, 1048576
  s_add_u32 s51, s51, 1048576
  buffer_load_dwordx4 a[16:19], v124, s[72:75], s50 offen
  buffer_load_dwordx4 a[80:83], v124, s[72:75], s51 offen
  s_add_u32 s50, s50, 1048576
  s_add_u32 s51, s51, 1048576
  buffer_load_dwordx4 a[32:35], v124, s[72:75], s50 offen
  buffer_load_dwordx4 a[96:99], v124, s[72:75], s51 offen
  s_add_u32 s50, s50, 1048576
  s_add_u32 s51, s51, 1048576
  buffer_load_dwordx4 a[48:51], v124, s[72:75], s50 offen
  buffer_load_dwordx4 a[112:115], v124, s[72:75], s51 offen
  s_xor_b32 s50, s82, 16384
  s_add_u32 s51, s50, 4096
  buffer_load_dwordx4 a[4:7], v124, s[72:75], s50 offen
  buffer_load_dwordx4 a[68:71], v124, s[72:75], s51 offen
  s_add_u32 s50, s50, 1048576
  s_add_u32 s51, s51, 1048576
  buffer_load_dwordx4 a[20:23], v124, s[72:75], s50 offen
  buffer_load_dwordx4 a[84:87], v124, s[72:75], s51 offen
  s_add_u32 s50, s50, 1048576
  s_add_u32 s51, s51, 1048576
  buffer_load_dwordx4 a[36:39], v124, s[72:75], s50 offen
  buffer_load_dwordx4 a[100:103], v124, s[72:75], s51 offen
  s_add_u32 s50, s50, 1048576
  s_add_u32 s51, s51, 1048576
  buffer_load_dwordx4 a[52:55], v124, s[72:75], s50 offen
  buffer_load_dwordx4 a[116:119], v124, s[72:75], s51 offen
  s_xor_b32 s50, s82, 4194304
  s_add_u32 s51, s50, 4096
  buffer_load_dwordx4 a[8:11], v124, s[72:75], s50 offen
  buffer_load_dwordx4 a[72:75], v124, s[72:75], s51 offen
  s_add_u32 s50, s50, 1048576
  s_add_u32 s51, s51, 1048576
  s_cmp_lt_u32 s34, 7
  s_cbranch_scc1 kf_kernel_o741
  buffer_load_dwordx4 v[24:27], v3, s[68:71], s49 offen sc1
  buffer_load_dwordx4 v[28:31], v3, s[68:71], s49 offen offset:736 sc1
kf_kernel_o741:
  buffer_load_dwordx4 a[24:27], v124, s[72:75], s50 offen
  buffer_load_dwordx4 a[88:91], v124, s[72:75], s51 offen
  s_add_u32 s50, s50, 1048576
  s_add_u32 s51, s51, 1048576
  buffer_load_dwordx4 a[40:43], v124, s[72:75], s50 offen
  buffer_load_dwordx4 a[104:107], v124, s[72:75], s51 offen
  s_add_u32 s50, s50, 1048576
  s_add_u32 s51, s51, 1048576
  buffer_load_dwordx4 a[56:59], v124, s[72:75], s50 offen
  buffer_load_dwordx4 a[120:123], v124, s[72:75], s51 offen
  s_xor_b32 s50, s82, 4210688
  s_add_u32 s51, s50, 4096
  buffer_load_dwordx4 a[12:15], v124, s[72:75], s50 offen
  buffer_load_dwordx4 a[76:79], v124, s[72:75], s51 offen
  s_add_u32 s50, s50, 1048576
  s_add_u32 s51, s51, 1048576
  buffer_load_dwordx4 a[28:31], v124, s[72:75], s50 offen
  buffer_load_dwordx4 a[92:95], v124, s[72:75], s51 offen
  s_add_u32 s50, s50, 1048576
  s_add_u32 s51, s51, 1048576
  ds_read_b128 v[64:67], v3 offset:41472
  ds_read_b128 v[68:71], v3 offset:42496
  ds_read_b128 v[72:75], v3 offset:43520
  ds_read_b128 v[76:79], v3 offset:44544
  ds_read_b128 v[80:83], v3 offset:45568
  ds_read_b128 v[84:87], v3 offset:46592
  ds_read_b128 v[88:91], v3 offset:47616
  ds_read_b128 v[92:95], v3 offset:48640
  ds_read_b128 v[96:99], v3 offset:49664
  s_cmp_lt_u32 s34, 7
  s_cbranch_scc1 kf_kernel_o742
  s_mov_b32 s43, 400000
  s_waitcnt vmcnt(10)
  s_branch kf_kernel_l145
kf_kernel_lp43:
  s_sleep 4
  buffer_load_dwordx4 v[24:27], v3, s[68:71], s49 offen sc1
  buffer_load_dwordx4 v[28:31], v3, s[68:71], s49 offen offset:736 sc1
  s_waitcnt vmcnt(0)
kf_kernel_l145:
  v_min3_u32 v13, v24, v25, v26
  v_max3_u32 v14, v24, v25, v26
  v_min3_u32 v13, v13, v27, v28
  v_max3_u32 v14, v14, v27, v28
  v_min3_u32 v13, v13, v29, v30
  v_max3_u32 v14, v14, v29, v30
  v_min_u32 v13, v13, v31
  v_max_u32 v14, v14, v31
  v_xor_b32 v13, 2814633361, v13
  v_xor_b32 v14, 2814633361, v14
  v_or_b32 v24, v13, v14
  v_cmp_ne_u32 vcc, 0, v24
  s_cbranch_vccz kf_kernel_ld44
  s_sub_u32 s43, s43, 1
  s_cmp_lg_u32 s43, 0
  s_cbranch_scc1 kf_kernel_lp43
kf_kernel_ld44:
kf_kernel_o742:
  buffer_load_dwordx4 a[44:47], v124, s[72:75], s50 offen
  buffer_load_dwordx4 a[108:111], v124, s[72:75], s51 offen
  s_add_u32 s50, s50, 1048576
  s_add_u32 s51, s51, 1048576
  buffer_load_dwordx4 a[60:63], v124, s[72:75], s50 offen
  buffer_load_dwordx4 a[124:127], v124, s[72:75], s51 offen
kf_kernel_join10:
  v_and_b32 v44, 0x370, v3
  v_xor_b32 v45, 64, v44
  ds_read_b128 v[100:103], v44 offset:50688
  ds_read_b128 v[104:107], v45 offset:50688
  s_mul_i32 s46, s3, 10752
  s_add_u32 s47, s46, 4032
  s_add_u32 s48, s46, 8064
  v_lshlrev_b32 v60, 2, v0
  s_lshl_b32 s35, s34, 8
  s_add_u32 s35, s35, s3
  s_mul_i32 s35, s35, 1280
  v_and_b32 v50, 15, v2
  v_lshrrev_b32 v51, 4, v2
  v_lshlrev_b32 v52, 6, v50
  v_lshl_add_u32 v52, v51, 4, v52
  v_and_b32 v53, 0xf0, v52
  v_bfe_u32 v54, v50, 2, 1
  v_lshl_add_u32 v53, v54, 3, v53
  v_lshrrev_b32 v54, 3, v50
  v_lshl_add_u32 v53, v54, 2, v53
  v_add_u32 v53, 1024, v53
  s_lshl_b32 s42, s34, 12
  s_min_u32 s42, s42, 27648
  s_add_u32 m0, s42, 20480
  s_add_u32 s42, s42, s58
  s_waitcnt lgkmcnt(0)
  s_barrier
  buffer_load_dwordx4 v3, s[64:67], s42 offen offset:0 lds
  buffer_load_dwordx4 v3, s[64:67], s42 offen offset:1024 lds
  buffer_load_dwordx4 v3, s[64:67], s42 offen offset:2048 lds
  buffer_load_dwordx4 v3, s[64:67], s42 offen offset:3072 lds
  v_add_u32 v54, s32, v52
  v_add_u32 v55, s32, v53
  ds_read_b128 v[44:47], v54 offset:8192
  ds_read_b32 v48, v55 offset:8192
  s_mul_i32 s59, s34, 1600
  v_add_u32 v120, s59, v53
  s_mul_i32 s59, s34, 1600
  v_add_u32 v112, s59, v52
  v_and_b32 v113, 3, v2
  v_mul_u32_u24 v113, 1600, v113
  v_lshrrev_b32 v114, 2, v2
  v_lshl_add_u32 v113, v114, 4, v113
  s_cmp_ge_u32 s34, 5
  s_cselect_b32 s59, 5120, 0
  s_lshl_b32 s60, s34, 8
  s_add_u32 s59, s59, s60
  v_add_u32 v113, s59, v113
  s_mul_i32 s59, s3, 10240
  s_lshl_b32 s60, s34, 10
  s_add_u32 s59, s59, s60
  s_add_u32 s49, s59, 8192
  s_cmp_lt_u32 s34, 2
  s_cselect_b32 s49, s49, 0x7f000000
  s_mov_b32 s52, s80
  s_mov_b32 s53, s81
  s_mov_b32 s54, 0x280000
  s_mov_b32 s55, 0x00020000
  s_add_u32 s60, s40, 0x900000
  s_addc_u32 s61, s41, 0
  s_mov_b32 s62, 0x300000
  s_mov_b32 s63, 0x00020000
  v_mul_u32_u24 v55, 3277, v0
  v_lshrrev_b32 v55, 16, v55
  v_mul_u32_u24 v56, 20, v55
  v_sub_u32 v56, v0, v56
  v_mul_u32_u24 v57, 144, v56
  v_lshl_add_u32 v57, v55, 2, v57
  v_mov_b32 v58, 1584
  v_cmp_ge_u32 vcc, 10, v56
  s_nop 1
  v_cndmask_b32 v57, v58, v57, vcc
  v_sub_u32 v59, 20, v56
  v_mul_u32_u24 v59, 144, v59
  v_sub_u32 v61, 31, v55
  v_lshl_add_u32 v59, v61, 2, v59
  v_cmp_le_u32 vcc, 10, v56
  s_nop 1
  v_cndmask_b32 v59, v58, v59, vcc
  v_sub_u32 v61, 32, v55
  v_lshlrev_b32 v61, 2, v61
  v_cmp_eq_u32 vcc, 0, v56
  s_nop 1
  v_cndmask_b32 v59, v59, v61, vcc
  v_cmp_eq_u32 vcc, 0, v0
  s_nop 1
  v_cndmask_b32 v59, v59, v58, vcc
  v_cmp_eq_u32 vcc, 320, v0
  s_nop 1
  v_cndmask_b32 v59, v59, v58, vcc
  v_mov_b32 v40, 0x3f3504f3
  v_min_u32 v62, 10, v50
  v_mul_u32_u24 v62, 144, v62
  v_lshl_add_u32 v62, v51, 4, v62
  s_mul_i32 s42, s34, 1600
  v_add_u32 v62, s42, v62
  v_and_b32 v63, 1, v2
  v_lshlrev_b32 v63, 31, v63
  v_or_b32 v63, 1.0, v63
  s_waitcnt lgkmcnt(0)
  v_lshlrev_b32 v108, 16, v44
  v_and_b32 v109, 0xffff0000, v44
  v_lshlrev_b32 v110, 16, v45
  v_and_b32 v111, 0xffff0000, v45
  v_lshlrev_b32 v114, 16, v46
  v_and_b32 v115, 0xffff0000, v46
  v_lshlrev_b32 v116, 16, v47
  v_and_b32 v117, 0xffff0000, v47
  v_lshlrev_b32 v118, 16, v48
  v_and_b32 v119, 0xffff0000, v48
  v_cmp_gt_u32 vcc, 321, v0
  s_nop 1
  v_cndmask_b32 v57, v58, v57, vcc
  v_cndmask_b32 v59, v58, v59, vcc
  s_mov_b64 exec, vcc
  s_mov_b32 s43, 400000
  s_cmp_lt_u32 s34, 6
  s_cbranch_scc1 kf_kernel_l052
  s_waitcnt vmcnt(0)
  s_branch kf_kernel_ld48
kf_kernel_l052:
kf_kernel_lp47:
  buffer_load_dword v4, v60, s[8:11], s46 offen offset:0 sc1
  buffer_load_dword v5, v60, s[8:11], s46 offen offset:1344 sc1
  buffer_load_dword v6, v60, s[8:11], s46 offen offset:2688 sc1
  buffer_load_dword v7, v60, s[8:11], s47 offen offset:0 sc1
  buffer_load_dword v8, v60, s[8:11], s47 offen offset:1344 sc1
  buffer_load_dword v9, v60, s[8:11], s47 offen offset:2688 sc1
  buffer_load_dword v10, v60, s[8:11], s48 offen offset:0 sc1
  buffer_load_dword v11, v60, s[8:11], s48 offen offset:1344 sc1
  s_waitcnt vmcnt(0)
  v_and_b32 v12, v4, v5
  v_and_b32 v13, v6, v7
  v_and_b32 v14, v8, v9
  v_and_b32 v15, v10, v11
  v_and_b32 v12, v12, v13
  v_and_b32 v14, v14, v15
  v_and_b32 v12, 1, v12
  v_and_b32 v12, v12, v14
  v_cmp_eq_u32 vcc, 0, v12
  s_cbranch_vccz kf_kernel_ld48
  s_sub_u32 s43, s43, 1
  s_cmp_lg_u32 s43, 0
  s_cbranch_scc1 kf_kernel_lp47
kf_kernel_ld48:
  s_mov_b64 exec, -1
  s_waitcnt lgkmcnt(0)
  s_add_u32 m0, s56, 0
  s_nop 0
  buffer_load_dwordx4 v3, s[64:67], s57 offen offset:0 lds
  v_lshlrev_b32 v20, 16, v4
  v_and_b32 v21, 0xffff0000, v4
  v_lshlrev_b32 v22, 16, v5
  v_and_b32 v23, 0xffff0000, v5
  v_lshlrev_b32 v24, 16, v6
  v_and_b32 v25, 0xffff0000, v6
  v_lshlrev_b32 v26, 16, v7
  v_and_b32 v27, 0xffff0000, v7
  v_lshlrev_b32 v28, 16, v8
  v_and_b32 v29, 0xffff0000, v8
  v_lshlrev_b32 v30, 16, v9
  v_and_b32 v31, 0xffff0000, v9
  v_lshlrev_b32 v32, 16, v10
  v_and_b32 v33, 0xffff0000, v10
  s_add_u32 m0, s56, 0
  s_nop 0
  buffer_load_dwordx4 v3, s[64:67], s57 offen offset:1024 lds
  v_lshlrev_b32 v34, 16, v11
  v_and_b32 v35, 0xffff0000, v11
  v_mov_b32 v4, v20
  v_mov_b32 v5, v21
  v_pk_mul_f32 v[44:45], v[22:23], s[18:19] op_sel_hi:[1,0]
  v_pk_fma_f32 v[6:7], v[22:23], s[18:19], v[44:45] op_sel:[1,1,0] op_sel_hi:[0,1,1] neg_hi:[1,0,0]
  v_pk_mul_f32 v[42:43], v[24:25], s[20:21] op_sel_hi:[1,0]
  v_pk_fma_f32 v[8:9], v[24:25], s[20:21], v[42:43] op_sel:[1,1,0] op_sel_hi:[0,1,1] neg_hi:[1,0,0]
  v_pk_mul_f32 v[44:45], v[26:27], s[22:23] op_sel_hi:[1,0]
  v_pk_fma_f32 v[10:11], v[26:27], s[22:23], v[44:45] op_sel:[1,1,0] op_sel_hi:[0,1,1] neg_hi:[1,0,0]
  v_pk_mul_f32 v[42:43], v[28:29], s[24:25] op_sel_hi:[1,0]
  v_pk_fma_f32 v[12:13], v[28:29], s[24:25], v[42:43] op_sel:[1,1,0] op_sel_hi:[0,1,1] neg_hi:[1,0,0]
  v_pk_mul_f32 v[44:45], v[30:31], s[26:27] op_sel_hi:[1,0]
  v_pk_fma_f32 v[14:15], v[30:31], s[26:27], v[44:45] op_sel:[1,1,0] op_sel_hi:[0,1,1] neg_hi:[1,0,0]
  s_add_u32 m0, s56, 0
  s_nop 0
  buffer_load_dwordx4 v3, s[64:67], s57 offen offset:2048 lds
  v_pk_mul_f32 v[42:43], v[32:33], s[28:29] op_sel_hi:[1,0]
  v_pk_fma_f32 v[16:17], v[32:33], s[28:29], v[42:43] op_sel:[1,1,0] op_sel_hi:[0,1,1] neg_hi:[1,0,0]
  v_pk_mul_f32 v[44:45], v[34:35], s[30:31] op_sel_hi:[1,0]
  v_pk_fma_f32 v[18:19], v[34:35], s[30:31], v[44:45] op_sel:[1,1,0] op_sel_hi:[0,1,1] neg_hi:[1,0,0]
  v_pk_add_f32 v[20:21], v[4:5], v[12:13]
  v_pk_add_f32 v[22:23], v[4:5], v[12:13] neg_lo:[0,1] neg_hi:[0,1]
  v_pk_add_f32 v[24:25], v[8:9], v[16:17]
  v_pk_add_f32 v[26:27], v[8:9], v[16:17] neg_lo:[0,1] neg_hi:[0,1]
  v_pk_add_f32 v[28:29], v[6:7], v[14:15]
  v_pk_add_f32 v[30:31], v[6:7], v[14:15] neg_lo:[0,1] neg_hi:[0,1]
  v_pk_add_f32 v[32:33], v[10:11], v[18:19]
  v_pk_add_f32 v[34:35], v[10:11], v[18:19] neg_lo:[0,1] neg_hi:[0,1]
  v_pk_add_f32 v[4:5], v[20:21], v[24:25]
  v_pk_add_f32 v[6:7], v[20:21], v[24:25] neg_lo:[0,1] neg_hi:[0,1]
  s_add_u32 m0, s56, 0
  s_nop 0
  buffer_load_dwordx4 v3, s[64:67], s57 offen offset:3072 lds
  v_pk_add_f32 v[8:9], v[28:29], v[32:33]
  v_pk_add_f32 v[10:11], v[28:29], v[32:33] neg_lo:[0,1] neg_hi:[0,1]
  v_pk_add_f32 v[12:13], v[26:27], v[22:23] op_sel:[1,0] op_sel_hi:[0,1] neg_lo:[1,0]
  v_pk_add_f32 v[14:15], v[26:27], v[22:23] op_sel:[1,0] op_sel_hi:[0,1] neg_hi:[1,0]
  v_pk_add_f32 v[16:17], v[34:35], v[30:31] op_sel:[1,0] op_sel_hi:[0,1] neg_lo:[1,0]
  v_pk_add_f32 v[18:19], v[34:35], v[30:31] op_sel:[1,0] op_sel_hi:[0,1] neg_hi:[1,0]
  v_pk_add_f32 v[20:21], v[4:5], v[8:9]
  v_pk_add_f32 v[28:29], v[4:5], v[8:9] neg_lo:[0,1] neg_hi:[0,1]
  v_pk_add_f32 v[24:25], v[10:11], v[6:7] op_sel:[1,0] op_sel_hi:[0,1] neg_lo:[1,0]
  v_pk_add_f32 v[32:33], v[10:11], v[6:7] op_sel:[1,0] op_sel_hi:[0,1] neg_hi:[1,0]
  v_pk_add_f32 v[4:5], v[16:17], v[16:17] op_sel:[0,1] op_sel_hi:[1,0] neg_lo:[0,1]
  v_pk_add_f32 v[6:7], v[18:19], v[18:19] op_sel:[0,1] op_sel_hi:[1,0] neg_hi:[0,1]
  v_pk_fma_f32 v[22:23], v[4:5], v[40:41], v[12:13] op_sel_hi:[1,0,1]
  v_pk_fma_f32 v[30:31], v[4:5], v[40:41], v[12:13] op_sel_hi:[1,0,1] neg_lo:[1,0,0] neg_hi:[1,0,0]
  v_pk_fma_f32 v[26:27], v[6:7], v[40:41], v[14:15] op_sel_hi:[1,0,1] neg_lo:[1,0,0] neg_hi:[1,0,0]
  s_add_u32 m0, s56, 4096
  s_add_u32 s57, s57, 4096
  buffer_load_dwordx4 v3, s[64:67], s57 offen offset:0 lds
  v_pk_fma_f32 v[34:35], v[6:7], v[40:41], v[14:15] op_sel_hi:[1,0,1]
  v_cvt_pk_bf16_f32 v4, v20, v21
  v_cvt_pk_bf16_f32 v5, v20, -v21
  ds_write_b32 v57, v4 offset:0
  ds_write_b32 v59, v5 offset:0
  v_cvt_pk_bf16_f32 v6, v22, v23
  v_cvt_pk_bf16_f32 v7, v22, -v23
  ds_write_b32 v57, v6 offset:1600
  ds_write_b32 v59, v7 offset:1600
  v_cvt_pk_bf16_f32 v8, v24, v25
  v_cvt_pk_bf16_f32 v9, v24, -v25
  ds_write_b32 v57, v8 offset:3200
  ds_write_b32 v59, v9 offset:3200
  v_cvt_pk_bf16_f32 v10, v26, v27
  s_add_u32 m0, s56, 4096
  s_nop 0
  buffer_load_dwordx4 v3, s[64:67], s57 offen offset:1024 lds
  v_cvt_pk_bf16_f32 v11, v26, -v27
  ds_write_b32 v57, v10 offset:4800
  ds_write_b32 v59, v11 offset:4800
  v_cvt_pk_bf16_f32 v12, v28, v29
  v_cvt_pk_bf16_f32 v13, v28, -v29
  ds_write_b32 v57, v12 offset:6400
  ds_write_b32 v59, v13 offset:6400
  v_cvt_pk_bf16_f32 v14, v30, v31
  v_cvt_pk_bf16_f32 v15, v30, -v31
  ds_write_b32 v57, v14 offset:8000
  ds_write_b32 v59, v15 offset:8000
  v_cvt_pk_bf16_f32 v16, v32, v33
  v_cvt_pk_bf16_f32 v17, v32, -v33
  ds_write_b32 v57, v16 offset:9600
  s_add_u32 m0, s56, 4096
  s_nop 0
  buffer_load_dwordx4 v3, s[64:67], s57 offen offset:2048 lds
  ds_write_b32 v59, v17 offset:9600
  v_cvt_pk_bf16_f32 v18, v34, v35
  v_cvt_pk_bf16_f32 v19, v34, -v35
  ds_write_b32 v57, v18 offset:11200
  ds_write_b32 v59, v19 offset:11200
kf_kernel_skip46:
  s_mov_b64 exec, -1
  s_waitcnt lgkmcnt(0)
  s_barrier
  ds_read_b128 v[4:7], v62
  ds_read_b128 v[8:11], v62 offset:64
  s_waitcnt lgkmcnt(1)
  v_mfma_f32_16x16x32_bf16 v[12:15], v[4:7], v[64:67], 0
  v_mfma_f32_16x16x32_bf16 v[16:19], v[4:7], v[68:71], 0
  v_mfma_f32_16x16x32_bf16 v[20:23], v[4:7], v[72:75], 0
  v_mfma_f32_16x16x32_bf16 v[24:27], v[4:7], v[76:79], 0
  s_waitcnt lgkmcnt(0)
  v_mfma_f32_16x16x32_bf16 v[28:31], v[8:11], v[64:67], 0
  v_mfma_f32_16x16x32_bf16 v[32:35], v[8:11], v[68:71], 0
  v_mfma_f32_16x16x32_bf16 v[36:39], v[8:11], v[72:75], 0
  v_mfma_f32_16x16x32_bf16 v[40:43], v[8:11], v[76:79], 0
  s_add_u32 m0, s56, 4096
  s_nop 0
  buffer_load_dwordx4 v3, s[64:67], s57 offen offset:3072 lds
  s_nop 1
  v_pk_fma_f32 v[12:13], v[62:63], v[28:29], v[12:13] op_sel:[1,0,0] op_sel_hi:[1,1,1]
  v_pk_fma_f32 v[14:15], v[62:63], v[30:31], v[14:15] op_sel:[1,0,0] op_sel_hi:[1,1,1]
  v_pk_fma_f32 v[16:17], v[62:63], v[32:33], v[16:17] op_sel:[1,0,0] op_sel_hi:[1,1,1]
  v_pk_fma_f32 v[18:19], v[62:63], v[34:35], v[18:19] op_sel:[1,0,0] op_sel_hi:[1,1,1]
  v_pk_fma_f32 v[20:21], v[62:63], v[36:37], v[20:21] op_sel:[1,0,0] op_sel_hi:[1,1,1]
  v_pk_fma_f32 v[22:23], v[62:63], v[38:39], v[22:23] op_sel:[1,0,0] op_sel_hi:[1,1,1]
  v_pk_fma_f32 v[24:25], v[62:63], v[40:41], v[24:25] op_sel:[1,0,0] op_sel_hi:[1,1,1]
  v_pk_fma_f32 v[26:27], v[62:63], v[42:43], v[26:27] op_sel:[1,0,0] op_sel_hi:[1,1,1]
  v_pk_mul_f32 v[36:37], v[16:17], v[84:85]
  v_pk_mul_f32 v[38:39], v[18:19], v[86:87]
  v_pk_mul_f32 v[32:33], v[16:17], v[80:81]
  v_pk_mul_f32 v[34:35], v[18:19], v[82:83]
  v_pk_fma_f32 v[28:29], v[12:13], v[80:81], v[36:37] neg_lo:[0,0,1] neg_hi:[0,0,1]
  v_pk_fma_f32 v[30:31], v[14:15], v[82:83], v[38:39] neg_lo:[0,0,1] neg_hi:[0,0,1]
  s_add_u32 m0, s56, 8192
  s_add_u32 s57, s57, 4096
  buffer_load_dwordx4 v3, s[64:67], s57 offen offset:0 lds
  v_pk_fma_f32 v[32:33], v[12:13], v[84:85], v[32:33]
  v_pk_fma_f32 v[34:35], v[14:15], v[86:87], v[34:35]
  v_cvt_pk_bf16_f32 v4, v28, v29
  v_cvt_pk_bf16_f32 v5, v30, v31
  v_cvt_pk_bf16_f32 v6, v32, v33
  v_cvt_pk_bf16_f32 v7, v34, v35
  v_pk_mul_f32 v[36:37], v[24:25], v[92:93]
  v_pk_mul_f32 v[38:39], v[26:27], v[94:95]
  v_pk_mul_f32 v[32:33], v[24:25], v[88:89]
  v_pk_mul_f32 v[34:35], v[26:27], v[90:91]
  v_pk_fma_f32 v[28:29], v[20:21], v[88:89], v[36:37] neg_lo:[0,0,1] neg_hi:[0,0,1]
  v_pk_fma_f32 v[30:31], v[22:23], v[90:91], v[38:39] neg_lo:[0,0,1] neg_hi:[0,0,1]
  v_pk_fma_f32 v[32:33], v[20:21], v[92:93], v[32:33]
  v_pk_fma_f32 v[34:35], v[22:23], v[94:95], v[34:35]
  s_add_u32 m0, s56, 8192
  s_nop 0
  buffer_load_dwordx4 v3, s[64:67], s57 offen offset:1024 lds
  v_cvt_pk_bf16_f32 v8, v28, v29
  v_cvt_pk_bf16_f32 v9, v30, v31
  v_cvt_pk_bf16_f32 v10, v32, v33
  v_cvt_pk_bf16_f32 v11, v34, v35
  v_mfma_f32_16x16x32_bf16 v[20:23], v[4:7], v[100:103], 0
  v_mfma_f32_16x16x32_bf16 v[12:15], v[4:7], v[96:99], 0
  v_mfma_f32_16x16x32_bf16 v[20:23], v[8:11], v[104:107], v[20:23]
  v_mfma_f32_16x16x32_bf16 v[16:19], v[8:11], v[96:99], 0
  s_nop 5
  v_pk_add_f32 v[12:13], v[12:13], v[108:109]
  v_pk_add_f32 v[14:15], v[14:15], v[110:111]
  v_mov_b32_dpp v20, v22 quad_perm:[0,1,2,3] row_mask:0xf bank_mask:0xc
  v_mov_b32_dpp v21, v23 quad_perm:[0,1,2,3] row_mask:0xf bank_mask:0xc
  v_pk_add_f32 v[28:29], v[12:13], v[14:15]
  v_pk_mul_f32 v[30:31], v[12:13], v[12:13]
  s_add_u32 m0, s56, 8192
  s_nop 0
  buffer_load_dwordx4 v3, s[64:67], s57 offen offset:2048 lds
  v_pk_add_f32 v[16:17], v[16:17], v[114:115]
  v_pk_add_f32 v[18:19], v[18:19], v[116:117]
  v_pk_add_f32 v[20:21], v[20:21], v[118:119]
  v_pk_fma_f32 v[30:31], v[14:15], v[14:15], v[30:31]
  v_pk_add_f32 v[32:33], v[16:17], v[18:19]
  v_pk_mul_f32 v[34:35], v[16:17], v[16:17]
  v_pk_add_f32 v[28:29], v[28:29], v[20:21]
  v_pk_fma_f32 v[30:31], v[20:21], v[20:21], v[30:31]
  v_pk_fma_f32 v[34:35], v[18:19], v[18:19], v[34:35]
  v_pk_add_f32 v[28:29], v[28:29], v[32:33]
  v_pk_add_f32 v[30:31], v[30:31], v[34:35]
  v_add_f32 v28, v28, v29
  v_add_f32 v30, v30, v31
  v_cvt_pk_bf16_f32 v4, v12, v13
  v_add_f32_dpp v28, v28, v28 quad_perm:[1,0,3,2] row_mask:0xf bank_mask:0xf
  s_add_u32 m0, s56, 8192
  s_nop 0
  buffer_load_dwordx4 v3, s[64:67], s57 offen offset:3072 lds
  v_add_f32_dpp v30, v30, v30 quad_perm:[1,0,3,2] row_mask:0xf bank_mask:0xf
  v_cvt_pk_bf16_f32 v5, v14, v15
  v_add_f32_dpp v28, v28, v28 quad_perm:[2,3,0,1] row_mask:0xf bank_mask:0xf
  v_add_f32_dpp v30, v30, v30 quad_perm:[2,3,0,1] row_mask:0xf bank_mask:0xf
  v_cvt_pk_bf16_f32 v6, v16, v17
  v_add_f32_dpp v28, v28, v28 row_half_mirror row_mask:0xf bank_mask:0xf
  v_add_f32_dpp v30, v30, v30 row_half_mirror row_mask:0xf bank_mask:0xf
  v_cvt_pk_bf16_f32 v7, v18, v19
  v_add_f32_dpp v28, v28, v28 row_mirror row_mask:0xf bank_mask:0xf
  v_add_f32_dpp v30, v30, v30 row_mirror row_mask:0xf bank_mask:0xf
  v_cvt_pk_bf16_f32 v8, v20, v21
  v_add_f32_dpp v28, v28, v28 row_bcast:15 row_mask:0xa bank_mask:0xf
  v_add_f32_dpp v30, v30, v30 row_bcast:15 row_mask:0xa bank_mask:0xf
  s_nop 0
  v_add_f32_dpp v28, v28, v28 row_bcast:31 row_mask:0xc bank_mask:0xf
  s_add_u32 m0, s56, 12288
  s_add_u32 s57, s57, 4096
  buffer_load_dwordx4 v3, s[64:67], s57 offen offset:0 lds
  v_add_f32_dpp v30, v30, v30 row_bcast:31 row_mask:0xc bank_mask:0xf
  v_readlane_b32 s36, v28, 63
  v_readlane_b32 s37, v30, 63
  v_mov_b32 v32, 0x3acccccd
  v_mul_f32 v28, s36, v32
  v_mul_f32 v33, s37, v32
  v_fma_f32 v33, -v28, v28, v33
  v_max_f32 v33, 0, v33
  v_cvt_pk_bf16_f32 v32, v28, v33
  v_lshlrev_b32 v28, 16, v32
  v_and_b32 v33, 0xffff0000, v32
  v_add_f32 v33, 0x3727c5ac, v33
  v_cvt_pk_bf16_f32 v32, v33, v33
  v_and_b32 v32, 0xffff0000, v32
  s_add_u32 m0, s56, 12288
  s_nop 0
  buffer_load_dwordx4 v3, s[64:67], s57 offen offset:1024 lds
  v_sqrt_f32 v32, v32
  s_nop 0
  v_cvt_pk_bf16_f32 v32, v32, v32
  v_and_b32 v32, 0xffff0000, v32
  v_rcp_f32 v30, v32
  s_nop 0
  v_mul_f32 v28, v28, v30
  v_pk_fma_f32 v[12:13], v[12:13], v[30:31], v[28:29] op_sel_hi:[1,0,0] neg_lo:[0,0,1] neg_hi:[0,0,1]
  v_pk_fma_f32 v[14:15], v[14:15], v[30:31], v[28:29] op_sel_hi:[1,0,0] neg_lo:[0,0,1] neg_hi:[0,0,1]
  v_pk_fma_f32 v[16:17], v[16:17], v[30:31], v[28:29] op_sel_hi:[1,0,0] neg_lo:[0,0,1] neg_hi:[0,0,1]
  v_pk_fma_f32 v[18:19], v[18:19], v[30:31], v[28:29] op_sel_hi:[1,0,0] neg_lo:[0,0,1] neg_hi:[0,0,1]
  v_pk_fma_f32 v[20:21], v[20:21], v[30:31], v[28:29] op_sel_hi:[1,0,0] neg_lo:[0,0,1] neg_hi:[0,0,1]
  v_cvt_pk_bf16_f32 v40, v12, v13
  v_cvt_pk_bf16_f32 v41, v14, v15
  v_cvt_pk_bf16_f32 v42, v16, v17
  v_cvt_pk_bf16_f32 v43, v18, v19
  v_cvt_pk_bf16_f32 v44, v20, v21
  ds_write_b128 v112, v[40:43]
  ds_write_b32 v120, v44
  s_waitcnt lgkmcnt(0)
  s_barrier
  ds_read_b128 v[40:43], v113
  ds_read_b128 v[44:47], v113 offset:7168
  s_waitcnt lgkmcnt(1)
  buffer_store_dwordx4 v[40:43], v3, s[60:63], s59 offen sc1
  s_waitcnt lgkmcnt(0)
  buffer_store_dwordx4 v[44:47], v3, s[60:63], s49 offen sc1
  v_mov_b32 v114, v124
  buffer_store_dwordx4 v[4:7], v52, s[52:55], s35 offen sc1
  buffer_store_dword v8, v53, s[52:55], s35 offen sc1
  s_lshl_b32 s49, s3, 7
  s_bfe_u32 s3, s2, 0x10002
  s_lshl_b32 s3, s3, 3
  s_lshr_b32 s35, s2, 5
  s_add_u32 s3, s3, s35
  s_lshl_b32 s3, s3, 2
  s_and_b32 s35, s2, 3
  s_add_u32 s3, s3, s35
  s_lshl_b32 s3, s3, 2
  s_bfe_u32 s35, s2, 0x20003
  s_add_u32 s3, s3, s35
  s_lshr_b32 s35, s3, 4
  s_bfe_u32 s36, s3, 0x30001
  s_and_b32 s37, s3, 1
  s_and_b32 s38, s34, 3
  s_lshl_b32 s39, s35, 2
  s_add_u32 s39, s39, s38
  s_lshr_b32 s46, s34, 2
  v_and_b32 v2, 63, v0
  v_and_b32 v6, 15, v2
  v_lshrrev_b32 v7, 4, v2
  s_add_u32 s8, s40, 0x900000
  s_addc_u32 s9, s41, 0
  s_mov_b32 s10, 0x300000
  s_mov_b32 s11, 0x00020000
  v_lshrrev_b32 v8, 2, v6
  v_and_b32 v10, 3, v6
  v_mul_u32_u24 v1, 10240, v8
  v_lshl_add_u32 v1, v7, 6, v1
  v_lshl_add_u32 v1, v10, 4, v1
  s_and_b32 s44, s39, -2
  s_add_u32 s44, s44, s46
  s_mul_i32 s44, s44, 40960
  s_and_b32 s45, s38, 1
  s_mul_i32 s45, s45, 5120
  s_add_u32 s44, s44, s45
  s_add_u32 s45, s44, 4096
  v_add_u32 v4, 57344, v3
  v_add_u32 v5, 114688, v3
  v_and_b32 v9, 1, v6
  v_lshl_add_u32 v9, v8, 1, v9
  v_lshlrev_b32 v9, 2, v9
  v_lshl_add_u32 v9, v7, 6, v9
  v_lshlrev_b32 v8, 8, v8
  v_lshl_add_u32 v8, v7, 6, v8
  v_lshl_add_u32 v8, v10, 4, v8
  v_lshl_add_u32 v2, v8, 16, v9
  v_mov_b32 v6, 0xc0135761
  v_mov_b32 v7, 0xc0135761
  s_mov_b32 s62, 0xbdd2d3e8
  s_mov_b32 s63, 0xbdd2d3e8
  s_add_u32 s12, s40, 0xc00000
  s_addc_u32 s13, s41, 0
  s_mov_b32 s14, 0x400000
  s_mov_b32 s15, 0x00020000
  s_add_u32 s16, s40, 0x1000000
  s_addc_u32 s17, s41, 0
  s_mov_b32 s18, 0x380000
  s_mov_b32 s19, 0x00020000
  s_add_u32 s20, s40, 0x1840000
  s_addc_u32 s21, s41, 0
  s_mov_b32 s22, 0x40000
  s_mov_b32 s23, 0x00020000
  s_and_b32 s47, s3, 15
  s_lshl_b32 s53, s47, 8
  s_lshl_b32 s47, s47, 4
  s_add_u32 s47, s47, s35
  s_lshl_b32 s47, s47, 7
  s_add_u32 s47, s47, 32768
  s_lshl_b32 s52, s39, 12
  s_add_u32 s53, s53, s52
  s_lshl_b32 s42, s46, 5
  s_add_u32 s53, s53, s42
  s_lshl_b32 s54, s36, 3
  s_lshr_b32 s42, s39, 4
  s_add_u32 s54, s54, s42
  s_and_b32 s42, s39, 1
  s_lshl_b32 s42, s42, 2
  s_add_u32 s54, s54, s42
  s_mul_i32 s54, s54, 56
  s_bfe_u32 s42, s39, 0x30001
  s_add_u32 s54, s54, s42
  s_lshl_b32 s42, s37, 5
  s_add_u32 s54, s54, s42
  s_lshl_b32 s42, s46, 4
  s_add_u32 s54, s54, s42
  s_lshl_b32 s54, s54, 10
  s_add_u32 s56, s54, 8192
  s_and_b32 s42, s37, s46
  s_cmp_eq_u32 s42, 1
  s_cselect_b32 s56, 0x7f000000, s56
  s_lshr_b32 s55, s39, 1
  s_lshl_b32 s55, s55, 3
  s_add_u32 s55, s55, s36
  s_lshl_b32 s55, s55, 1
  s_and_b32 s42, s39, 1
  s_add_u32 s55, s55, s42
  s_lshl_b32 s55, s55, 1
  s_add_u32 s55, s55, s46
  s_lshl_b32 s55, s55, 12
  s_cmp_eq_u32 s36, 7
  s_cselect_b32 s48, 0, -1
  s_cselect_b32 s59, 0xffff, -1
  s_lshl_b32 s58, s38, 12
  s_lshl_b32 s57, s46, 3
  s_add_u32 s57, s57, s58
  s_lshl_b32 s42, s46, 11
  s_add_u32 s58, s58, s42
  s_lshl_b32 s42, s35, 11
  s_waitcnt vmcnt(2)
  s_barrier
  v_mov_b32 v14, 20000
  v_mov_b32 v15, 0
  ds_write_b32 v14, v15
  s_cmp_ge_u32 s34, 4
  s_cbranch_scc1 kf_kernel_w454
  s_and_b32 s43, s34, 3
  s_mul_i32 s43, s43, 4160
  v_lshrrev_b32 v12, 1, v3
  v_add_u32 v12, s43, v12
  v_bfe_u32 v13, v3, 4, 3
  v_mul_u32_u24 v13, 512, v13
  v_add_u32 v13, v12, v13
  ds_write_b64 v12, a[0:1] offset:0
  ds_write_b64 v12, a[16:17] offset:520
  ds_write_b64 v12, a[32:33] offset:1040
  ds_write_b64 v12, a[48:49] offset:1560
  ds_write_b64 v12, a[64:65] offset:2080
  ds_write_b64 v12, a[80:81] offset:2600
  ds_write_b64 v12, a[96:97] offset:3120
  ds_write_b64 v12, a[112:113] offset:3640
  ds_read_b64 a[0:1], v13 offset:0
  ds_read_b64 a[16:17], v13 offset:8
  ds_read_b64 a[32:33], v13 offset:16
  ds_read_b64 a[48:49], v13 offset:24
  ds_read_b64 a[64:65], v13 offset:32
  ds_read_b64 a[80:81], v13 offset:40
  ds_read_b64 a[96:97], v13 offset:48
  ds_read_b64 a[112:113], v13 offset:56
  ds_write_b64 v12, a[2:3] offset:0
  ds_write_b64 v12, a[18:19] offset:520
  ds_write_b64 v12, a[34:35] offset:1040
  ds_write_b64 v12, a[50:51] offset:1560
  ds_write_b64 v12, a[66:67] offset:2080
  ds_write_b64 v12, a[82:83] offset:2600
  ds_write_b64 v12, a[98:99] offset:3120
  ds_write_b64 v12, a[114:115] offset:3640
  ds_read_b64 a[2:3], v13 offset:0
  ds_read_b64 a[18:19], v13 offset:8
  ds_read_b64 a[34:35], v13 offset:16
  ds_read_b64 a[50:51], v13 offset:24
  ds_read_b64 a[66:67], v13 offset:32
  ds_read_b64 a[82:83], v13 offset:40
  ds_read_b64 a[98:99], v13 offset:48
  ds_read_b64 a[114:115], v13 offset:56
  ds_write_b64 v12, a[4:5] offset:0
  ds_write_b64 v12, a[20:21] offset:520
  ds_write_b64 v12, a[36:37] offset:1040
  ds_write_b64 v12, a[52:53] offset:1560
  ds_write_b64 v12, a[68:69] offset:2080
  ds_write_b64 v12, a[84:85] offset:2600
  ds_write_b64 v12, a[100:101] offset:3120
  ds_write_b64 v12, a[116:117] offset:3640
  ds_read_b64 a[4:5], v13 offset:0
  ds_read_b64 a[20:21], v13 offset:8
  ds_read_b64 a[36:37], v13 offset:16
  ds_read_b64 a[52:53], v13 offset:24
  ds_read_b64 a[68:69], v13 offset:32
  ds_read_b64 a[84:85], v13 offset:40
  ds_read_b64 a[100:101], v13 offset:48
  ds_read_b64 a[116:117], v13 offset:56
  ds_write_b64 v12, a[6:7] offset:0
  ds_write_b64 v12, a[22:23] offset:520
  ds_write_b64 v12, a[38:39] offset:1040
  ds_write_b64 v12, a[54:55] offset:1560
  ds_write_b64 v12, a[70:71] offset:2080
  ds_write_b64 v12, a[86:87] offset:2600
  ds_write_b64 v12, a[102:103] offset:3120
  ds_write_b64 v12, a[118:119] offset:3640
  ds_read_b64 a[6:7], v13 offset:0
  ds_read_b64 a[22:23], v13 offset:8
  ds_read_b64 a[38:39], v13 offset:16
  ds_read_b64 a[54:55], v13 offset:24
  ds_read_b64 a[70:71], v13 offset:32
  ds_read_b64 a[86:87], v13 offset:40
  ds_read_b64 a[102:103], v13 offset:48
  ds_read_b64 a[118:119], v13 offset:56
  s_waitcnt lgkmcnt(0)
  s_barrier
  s_cmp_lg_u32 s34, 0
  s_cbranch_scc1 kf_kernel_wj55
  v_lshrrev_b32 v10, 4, v3
  v_lshlrev_b32 v10, 7, v10
  s_mov_b64 exec, 0xffff
  s_mov_b32 s43, 400000
kf_kernel_lp57:
  buffer_load_dword v9, v10, s[68:71], s42 offen sc1
  s_waitcnt vmcnt(0)
  v_cmp_eq_u32 vcc, 0, v9
  s_cbranch_vccz kf_kernel_ld58
  s_sub_u32 s43, s43, 1
  s_cmp_lg_u32 s43, 0
  s_cbranch_scc1 kf_kernel_lp57
kf_kernel_ld58:
  s_mov_b64 exec, -1
  s_branch kf_kernel_wj55
kf_kernel_w454:
  s_cmp_lg_u32 s34, 4
  s_cbranch_scc1 kf_kernel_w556
  v_lshrrev_b32 v10, 4, v3
  v_lshlrev_b32 v10, 7, v10
  s_mov_b64 exec, 1
  v_mov_b32 v8, 1
  buffer_store_dword v8, v10, s[68:71], s49 offen sc1
  s_mov_b64 exec, -1
kf_kernel_w556:
  s_barrier
  s_and_b32 s43, s34, 3
  s_mul_i32 s43, s43, 4160
  v_lshrrev_b32 v12, 1, v3
  v_add_u32 v12, s43, v12
  v_bfe_u32 v13, v3, 4, 3
  v_mul_u32_u24 v13, 512, v13
  v_add_u32 v13, v12, v13
  ds_write_b64 v12, a[0:1] offset:0
  ds_write_b64 v12, a[16:17] offset:520
  ds_write_b64 v12, a[32:33] offset:1040
  ds_write_b64 v12, a[48:49] offset:1560
  ds_write_b64 v12, a[64:65] offset:2080
  ds_write_b64 v12, a[80:81] offset:2600
  ds_write_b64 v12, a[96:97] offset:3120
  ds_write_b64 v12, a[112:113] offset:3640
  ds_read_b64 a[0:1], v13 offset:0
  ds_read_b64 a[16:17], v13 offset:8
  ds_read_b64 a[32:33], v13 offset:16
  ds_read_b64 a[48:49], v13 offset:24
  ds_read_b64 a[64:65], v13 offset:32
  ds_read_b64 a[80:81], v13 offset:40
  ds_read_b64 a[96:97], v13 offset:48
  ds_read_b64 a[112:113], v13 offset:56
  ds_write_b64 v12, a[2:3] offset:0
  ds_write_b64 v12, a[18:19] offset:520
  ds_write_b64 v12, a[34:35] offset:1040
  ds_write_b64 v12, a[50:51] offset:1560
  ds_write_b64 v12, a[66:67] offset:2080
  ds_write_b64 v12, a[82:83] offset:2600
  ds_write_b64 v12, a[98:99] offset:3120
  ds_write_b64 v12, a[114:115] offset:3640
  ds_read_b64 a[2:3], v13 offset:0
  ds_read_b64 a[18:19], v13 offset:8
  ds_read_b64 a[34:35], v13 offset:16
  ds_read_b64 a[50:51], v13 offset:24
  ds_read_b64 a[66:67], v13 offset:32
  ds_read_b64 a[82:83], v13 offset:40
  ds_read_b64 a[98:99], v13 offset:48
  ds_read_b64 a[114:115], v13 offset:56
  ds_write_b64 v12, a[4:5] offset:0
  ds_write_b64 v12, a[20:21] offset:520
  ds_write_b64 v12, a[36:37] offset:1040
  ds_write_b64 v12, a[52:53] offset:1560
  ds_write_b64 v12, a[68:69] offset:2080
  ds_write_b64 v12, a[84:85] offset:2600
  ds_write_b64 v12, a[100:101] offset:3120
  ds_write_b64 v12, a[116:117] offset:3640
  ds_read_b64 a[4:5], v13 offset:0
  ds_read_b64 a[20:21], v13 offset:8
  ds_read_b64 a[36:37], v13 offset:16
  ds_read_b64 a[52:53], v13 offset:24
  ds_read_b64 a[68:69], v13 offset:32
  ds_read_b64 a[84:85], v13 offset:40
  ds_read_b64 a[100:101], v13 offset:48
  ds_read_b64 a[116:117], v13 offset:56
  ds_write_b64 v12, a[6:7] offset:0
  ds_write_b64 v12, a[22:23] offset:520
  ds_write_b64 v12, a[38:39] offset:1040
  ds_write_b64 v12, a[54:55] offset:1560
  ds_write_b64 v12, a[70:71] offset:2080
  ds_write_b64 v12, a[86:87] offset:2600
  ds_write_b64 v12, a[102:103] offset:3120
  ds_write_b64 v12, a[118:119] offset:3640
  ds_read_b64 a[6:7], v13 offset:0
  ds_read_b64 a[22:23], v13 offset:8
  ds_read_b64 a[38:39], v13 offset:16
  ds_read_b64 a[54:55], v13 offset:24
  ds_read_b64 a[70:71], v13 offset:32
  ds_read_b64 a[86:87], v13 offset:40
  ds_read_b64 a[102:103], v13 offset:48
  ds_read_b64 a[118:119], v13 offset:56
  s_branch kf_kernel_wj55
kf_kernel_w459:
  s_cmp_lg_u32 s34, 4
  s_cbranch_scc1 kf_kernel_wj55
  v_lshrrev_b32 v10, 4, v3
  v_lshlrev_b32 v10, 7, v10
  s_mov_b64 exec, 1
  v_mov_b32 v8, 1
  buffer_store_dword v8, v10, s[68:71], s49 offen sc1
  s_mov_b64 exec, 0xffff
  s_mov_b32 s43, 400000
kf_kernel_lp61:
  buffer_load_dword v9, v10, s[68:71], s42 offen sc1
  s_waitcnt vmcnt(0)
  v_cmp_eq_u32 vcc, 0, v9
  s_cbranch_vccz kf_kernel_ld62
  s_sub_u32 s43, s43, 1
  s_cmp_lg_u32 s43, 0
  s_cbranch_scc1 kf_kernel_lp61
kf_kernel_ld62:
  s_mov_b64 exec, -1
kf_kernel_wj55:
  s_waitcnt lgkmcnt(0)
  s_barrier
  buffer_load_dwordx4 v[32:35], v1, s[8:11], s44 offen offset:0
  buffer_load_dwordx4 v[36:39], v1, s[8:11], s44 offen offset:256
  buffer_load_dwordx4 v[40:43], v1, s[8:11], s44 offen offset:512
  buffer_load_dwordx4 v[44:47], v1, s[8:11], s44 offen offset:768
  buffer_load_dwordx4 v[48:51], v1, s[8:11], s44 offen offset:1024
  buffer_load_dwordx4 v[52:55], v1, s[8:11], s44 offen offset:1280
  buffer_load_dwordx4 v[56:59], v1, s[8:11], s44 offen offset:1536
  buffer_load_dwordx4 v[60:63], v1, s[8:11], s44 offen offset:1792
  s_cmp_eq_u32 s37, 1
  s_cbranch_scc1 kf_kernel_h153
  ds_read_b128 v[8:11], v4 offset:24576
  ds_read_b128 v[12:15], v4 offset:25600
  ds_read_b128 v[16:19], v4 offset:26624
  ds_read_b128 v[20:23], v4 offset:27648
  ds_read_b128 v[24:27], v4 offset:28672
  s_waitcnt vmcnt(7)
  s_waitcnt lgkmcnt(4)
  v_mfma_f32_16x16x32_bf16 v[112:115], v[32:35], v[8:11], 0
  ds_read_b128 v[28:31], v4 offset:29696
  buffer_load_dwordx4 v[64:67], v1, s[8:11], s44 offen offset:2048
  s_waitcnt lgkmcnt(4)
  v_mfma_f32_16x16x32_bf16 v[116:119], v[32:35], v[12:15], 0
  ds_read_b128 v[8:11], v4 offset:30720
  s_waitcnt lgkmcnt(4)
  v_mfma_f32_16x16x32_bf16 v[120:123], v[32:35], v[16:19], 0
  ds_read_b128 v[12:15], v4 offset:31744
  s_waitcnt lgkmcnt(4)
  v_mfma_f32_16x16x32_bf16 v[124:127], v[32:35], v[20:23], 0
  ds_read_b128 v[16:19], v4 offset:32768
  s_waitcnt vmcnt(7)
  s_waitcnt lgkmcnt(4)
  v_mfma_f32_16x16x32_bf16 v[112:115], v[36:39], v[24:27], v[112:115]
  ds_read_b128 v[20:23], v4 offset:33792
  buffer_load_dwordx4 v[68:71], v1, s[8:11], s44 offen offset:2304
  s_waitcnt lgkmcnt(4)
  v_mfma_f32_16x16x32_bf16 v[116:119], v[36:39], v[28:31], v[116:119]
  ds_read_b128 v[24:27], v4 offset:34816
  s_waitcnt lgkmcnt(4)
  v_mfma_f32_16x16x32_bf16 v[120:123], v[36:39], v[8:11], v[120:123]
  ds_read_b128 v[28:31], v4 offset:35840
  s_waitcnt lgkmcnt(4)
  v_mfma_f32_16x16x32_bf16 v[124:127], v[36:39], v[12:15], v[124:127]
  ds_read_b128 v[8:11], v4 offset:36864
  s_waitcnt vmcnt(7)
  s_waitcnt lgkmcnt(4)
  v_mfma_f32_16x16x32_bf16 v[112:115], v[40:43], v[16:19], v[112:115]
  ds_read_b128 v[12:15], v4 offset:37888
  buffer_load_dwordx4 v[72:75], v1, s[8:11], s44 offen offset:2560
  s_waitcnt lgkmcnt(4)
  v_mfma_f32_16x16x32_bf16 v[116:119], v[40:43], v[20:23], v[116:119]
  ds_read_b128 v[16:19], v4 offset:38912
  s_waitcnt lgkmcnt(4)
  v_mfma_f32_16x16x32_bf16 v[120:123], v[40:43], v[24:27], v[120:123]
  ds_read_b128 v[20:23], v4 offset:39936
  s_waitcnt lgkmcnt(4)
  v_mfma_f32_16x16x32_bf16 v[124:127], v[40:43], v[28:31], v[124:127]
  ds_read_b128 v[24:27], v4 offset:40960
  s_waitcnt vmcnt(7)
  s_waitcnt lgkmcnt(4)
  v_mfma_f32_16x16x32_bf16 v[112:115], v[44:47], v[8:11], v[112:115]
  ds_read_b128 v[28:31], v4 offset:41984
  buffer_load_dwordx4 v[76:79], v1, s[8:11], s44 offen offset:2816
  s_waitcnt lgkmcnt(4)
  v_mfma_f32_16x16x32_bf16 v[116:119], v[44:47], v[12:15], v[116:119]
  ds_read_b128 v[8:11], v4 offset:43008
  s_waitcnt lgkmcnt(4)
  v_mfma_f32_16x16x32_bf16 v[120:123], v[44:47], v[16:19], v[120:123]
  ds_read_b128 v[12:15], v4 offset:44032
  s_waitcnt lgkmcnt(4)
  v_mfma_f32_16x16x32_bf16 v[124:127], v[44:47], v[20:23], v[124:127]
  ds_read_b128 v[16:19], v4 offset:45056
  s_waitcnt vmcnt(7)
  s_waitcnt lgkmcnt(4)
  v_mfma_f32_16x16x32_bf16 v[112:115], v[48:51], v[24:27], v[112:115]
  ds_read_b128 v[20:23], v4 offset:46080
  buffer_load_dwordx4 v[80:83], v1, s[8:11], s44 offen offset:3072
  s_waitcnt lgkmcnt(4)
  v_mfma_f32_16x16x32_bf16 v[116:119], v[48:51], v[28:31], v[116:119]
  ds_read_b128 v[24:27], v4 offset:47104
  s_waitcnt lgkmcnt(4)
  v_mfma_f32_16x16x32_bf16 v[120:123], v[48:51], v[8:11], v[120:123]
  ds_read_b128 v[28:31], v4 offset:48128
  s_waitcnt lgkmcnt(4)
  v_mfma_f32_16x16x32_bf16 v[124:127], v[48:51], v[12:15], v[124:127]
  ds_read_b128 v[8:11], v4 offset:49152
  s_waitcnt vmcnt(7)
  s_waitcnt lgkmcnt(4)
  v_mfma_f32_16x16x32_bf16 v[112:115], v[52:55], v[16:19], v[112:115]
  ds_read_b128 v[12:15], v4 offset:50176
  buffer_load_dwordx4 v[84:87], v1, s[8:11], s44 offen offset:3328
  s_waitcnt lgkmcnt(4)
  v_mfma_f32_16x16x32_bf16 v[116:119], v[52:55], v[20:23], v[116:119]
  ds_read_b128 v[16:19], v4 offset:51200
  s_waitcnt lgkmcnt(4)
  v_mfma_f32_16x16x32_bf16 v[120:123], v[52:55], v[24:27], v[120:123]
  ds_read_b128 v[20:23], v4 offset:52224
  s_waitcnt lgkmcnt(4)
  v_mfma_f32_16x16x32_bf16 v[124:127], v[52:55], v[28:31], v[124:127]
  ds_read_b128 v[24:27], v4 offset:53248
  s_waitcnt vmcnt(7)
  s_waitcnt lgkmcnt(4)
  v_mfma_f32_16x16x32_bf16 v[112:115], v[56:59], v[8:11], v[112:115]
  ds_read_b128 v[28:31], v4 offset:54272
  buffer_load_dwordx4 v[88:91], v1, s[8:11], s44 offen offset:3584
  s_waitcnt lgkmcnt(4)
  v_mfma_f32_16x16x32_bf16 v[116:119], v[56:59], v[12:15], v[116:119]
  ds_read_b128 v[8:11], v4 offset:55296
  s_waitcnt lgkmcnt(4)
  v_mfma_f32_16x16x32_bf16 v[120:123], v[56:59], v[16:19], v[120:123]
  ds_read_b128 v[12:15], v4 offset:56320
  s_waitcnt lgkmcnt(4)
  v_mfma_f32_16x16x32_bf16 v[124:127], v[56:59], v[20:23], v[124:127]
  ds_read_b128 v[16:19], v5 offset:0
  s_waitcnt vmcnt(7)
  s_waitcnt lgkmcnt(4)
  v_mfma_f32_16x16x32_bf16 v[112:115], v[60:63], v[24:27], v[112:115]
  ds_read_b128 v[20:23], v5 offset:1024
  buffer_load_dwordx4 v[92:95], v1, s[8:11], s44 offen offset:3840
  s_waitcnt lgkmcnt(4)
  v_mfma_f32_16x16x32_bf16 v[116:119], v[60:63], v[28:31], v[116:119]
  ds_read_b128 v[24:27], v5 offset:2048
  s_waitcnt lgkmcnt(4)
  v_mfma_f32_16x16x32_bf16 v[120:123], v[60:63], v[8:11], v[120:123]
  ds_read_b128 v[28:31], v5 offset:3072
  s_waitcnt lgkmcnt(4)
  v_mfma_f32_16x16x32_bf16 v[124:127], v[60:63], v[12:15], v[124:127]
  ds_read_b128 v[8:11], v5 offset:4096
  s_waitcnt vmcnt(7)
  s_waitcnt lgkmcnt(4)
  v_mfma_f32_16x16x32_bf16 v[112:115], v[64:67], v[16:19], v[112:115]
  ds_read_b128 v[12:15], v5 offset:5120
  buffer_load_dwordx4 v[96:99], v1, s[8:11], s45 offen offset:0
  s_waitcnt lgkmcnt(4)
  v_mfma_f32_16x16x32_bf16 v[116:119], v[64:67], v[20:23], v[116:119]
  ds_read_b128 v[16:19], v5 offset:6144
  s_waitcnt lgkmcnt(4)
  v_mfma_f32_16x16x32_bf16 v[120:123], v[64:67], v[24:27], v[120:123]
  ds_read_b128 v[20:23], v5 offset:7168
  s_waitcnt lgkmcnt(4)
  v_mfma_f32_16x16x32_bf16 v[124:127], v[64:67], v[28:31], v[124:127]
  ds_read_b128 v[24:27], v5 offset:8192
  s_waitcnt vmcnt(7)
  s_waitcnt lgkmcnt(4)
  v_mfma_f32_16x16x32_bf16 v[112:115], v[68:71], v[8:11], v[112:115]
  ds_read_b128 v[28:31], v5 offset:9216
  buffer_load_dwordx4 v[100:103], v1, s[8:11], s45 offen offset:256
  s_waitcnt lgkmcnt(4)
  v_mfma_f32_16x16x32_bf16 v[116:119], v[68:71], v[12:15], v[116:119]
  ds_read_b128 v[8:11], v5 offset:10240
  s_waitcnt lgkmcnt(4)
  v_mfma_f32_16x16x32_bf16 v[120:123], v[68:71], v[16:19], v[120:123]
  ds_read_b128 v[12:15], v5 offset:11264
  s_waitcnt lgkmcnt(4)
  v_mfma_f32_16x16x32_bf16 v[124:127], v[68:71], v[20:23], v[124:127]
  ds_read_b128 v[16:19], v5 offset:12288
  s_waitcnt vmcnt(7)
  s_waitcnt lgkmcnt(4)
  v_mfma_f32_16x16x32_bf16 v[112:115], v[72:75], v[24:27], v[112:115]
  ds_read_b128 v[20:23], v5 offset:13312
  buffer_load_dwordx4 v[104:107], v1, s[8:11], s45 offen offset:512
  s_waitcnt lgkmcnt(4)
  v_mfma_f32_16x16x32_bf16 v[116:119], v[72:75], v[28:31], v[116:119]
  ds_read_b128 v[24:27], v5 offset:14336
  s_waitcnt lgkmcnt(4)
  v_mfma_f32_16x16x32_bf16 v[120:123], v[72:75], v[8:11], v[120:123]
  ds_read_b128 v[28:31], v5 offset:15360
  s_waitcnt lgkmcnt(4)
  v_mfma_f32_16x16x32_bf16 v[124:127], v[72:75], v[12:15], v[124:127]
  ds_read_b128 v[8:11], v5 offset:16384
  s_waitcnt vmcnt(7)
  s_waitcnt lgkmcnt(4)
  v_mfma_f32_16x16x32_bf16 v[112:115], v[76:79], v[16:19], v[112:115]
  ds_read_b128 v[12:15], v5 offset:17408
  buffer_load_dwordx4 v[108:111], v1, s[8:11], s45 offen offset:768
  s_waitcnt lgkmcnt(4)
  v_mfma_f32_16x16x32_bf16 v[116:119], v[76:79], v[20:23], v[116:119]
  ds_read_b128 v[16:19], v5 offset:18432
  s_waitcnt lgkmcnt(4)
  v_mfma_f32_16x16x32_bf16 v[120:123], v[76:79], v[24:27], v[120:123]
  ds_read_b128 v[20:23], v5 offset:19456
  s_waitcnt lgkmcnt(4)
  v_mfma_f32_16x16x32_bf16 v[124:127], v[76:79], v[28:31], v[124:127]
  ds_read_b128 v[24:27], v5 offset:20480
  s_waitcnt vmcnt(7)
  s_waitcnt lgkmcnt(4)
  v_mfma_f32_16x16x32_bf16 v[112:115], v[80:83], v[8:11], v[112:115]
  ds_read_b128 v[28:31], v5 offset:21504
  s_waitcnt lgkmcnt(4)
  v_mfma_f32_16x16x32_bf16 v[116:119], v[80:83], v[12:15], v[116:119]
  ds_read_b128 v[8:11], v5 offset:22528
  s_waitcnt lgkmcnt(4)
  v_mfma_f32_16x16x32_bf16 v[120:123], v[80:83], v[16:19], v[120:123]
  ds_read_b128 v[12:15], v5 offset:23552
  s_waitcnt lgkmcnt(4)
  v_mfma_f32_16x16x32_bf16 v[124:127], v[80:83], v[20:23], v[124:127]
  ds_read_b128 v[16:19], v5 offset:24576
  s_waitcnt vmcnt(6)
  s_waitcnt lgkmcnt(4)
  v_mfma_f32_16x16x32_bf16 v[112:115], v[84:87], v[24:27], v[112:115]
  ds_read_b128 v[20:23], v5 offset:25600
  s_waitcnt lgkmcnt(4)
  v_mfma_f32_16x16x32_bf16 v[116:119], v[84:87], v[28:31], v[116:119]
  ds_read_b128 v[24:27], v5 offset:26624
  s_waitcnt lgkmcnt(4)
  v_mfma_f32_16x16x32_bf16 v[120:123], v[84:87], v[8:11], v[120:123]
  ds_read_b128 v[28:31], v5 offset:27648
  s_waitcnt lgkmcnt(4)
  v_mfma_f32_16x16x32_bf16 v[124:127], v[84:87], v[12:15], v[124:127]
  ds_read_b128 v[8:11], v5 offset:28672
  s_waitcnt vmcnt(5)
  s_waitcnt lgkmcnt(4)
  v_mfma_f32_16x16x32_bf16 v[112:115], v[88:91], v[16:19], v[112:115]
  ds_read_b128 v[12:15], v5 offset:29696
  s_waitcnt lgkmcnt(4)
  v_mfma_f32_16x16x32_bf16 v[116:119], v[88:91], v[20:23], v[116:119]
  ds_read_b128 v[16:19], v5 offset:30720
  s_waitcnt lgkmcnt(4)
  v_mfma_f32_16x16x32_bf16 v[120:123], v[88:91], v[24:27], v[120:123]
  ds_read_b128 v[20:23], v5 offset:31744
  s_waitcnt lgkmcnt(4)
  v_mfma_f32_16x16x32_bf16 v[124:127], v[88:91], v[28:31], v[124:127]
  ds_read_b128 v[24:27], v5 offset:32768
  s_waitcnt vmcnt(4)
  s_waitcnt lgkmcnt(4)
  v_mfma_f32_16x16x32_bf16 v[112:115], v[92:95], v[8:11], v[112:115]
  ds_read_b128 v[28:31], v5 offset:33792
  s_waitcnt lgkmcnt(4)
  v_mfma_f32_16x16x32_bf16 v[116:119], v[92:95], v[12:15], v[116:119]
  ds_read_b128 v[8:11], v5 offset:34816
  s_waitcnt lgkmcnt(4)
  v_mfma_f32_16x16x32_bf16 v[120:123], v[92:95], v[16:19], v[120:123]
  ds_read_b128 v[12:15], v5 offset:35840
  s_waitcnt lgkmcnt(4)
  v_mfma_f32_16x16x32_bf16 v[124:127], v[92:95], v[20:23], v[124:127]
  ds_read_b128 v[16:19], v5 offset:36864
  s_waitcnt vmcnt(3)
  s_waitcnt lgkmcnt(4)
  v_mfma_f32_16x16x32_bf16 v[112:115], v[96:99], v[24:27], v[112:115]
  ds_read_b128 v[20:23], v5 offset:37888
  s_waitcnt lgkmcnt(4)
  v_mfma_f32_16x16x32_bf16 v[116:119], v[96:99], v[28:31], v[116:119]
  ds_read_b128 v[24:27], v5 offset:38912
  s_waitcnt lgkmcnt(4)
  v_mfma_f32_16x16x32_bf16 v[120:123], v[96:99], v[8:11], v[120:123]
  ds_read_b128 v[28:31], v5 offset:39936
  s_waitcnt lgkmcnt(4)
  v_mfma_f32_16x16x32_bf16 v[124:127], v[96:99], v[12:15], v[124:127]
  ds_read_b128 v[8:11], v5 offset:40960
  s_waitcnt vmcnt(2)
  s_waitcnt lgkmcnt(4)
  v_mfma_f32_16x16x32_bf16 v[112:115], v[100:103], v[16:19], v[112:115]
  ds_read_b128 v[12:15], v5 offset:41984
  s_waitcnt lgkmcnt(4)
  v_mfma_f32_16x16x32_bf16 v[116:119], v[100:103], v[20:23], v[116:119]
  ds_read_b128 v[16:19], v5 offset:43008
  s_waitcnt lgkmcnt(4)
  v_mfma_f32_16x16x32_bf16 v[120:123], v[100:103], v[24:27], v[120:123]
  ds_read_b128 v[20:23], v5 offset:44032
  s_waitcnt lgkmcnt(4)
  v_mfma_f32_16x16x32_bf16 v[124:127], v[100:103], v[28:31], v[124:127]
  ds_read_b128 v[24:27], v5 offset:45056
  s_waitcnt vmcnt(1)
  s_waitcnt lgkmcnt(4)
  v_mfma_f32_16x16x32_bf16 v[112:115], v[104:107], v[8:11], v[112:115]
  ds_read_b128 v[28:31], v5 offset:46080
  s_waitcnt lgkmcnt(4)
  v_mfma_f32_16x16x32_bf16 v[116:119], v[104:107], v[12:15], v[116:119]
  ds_read_b128 v[8:11], v5 offset:47104
  s_waitcnt lgkmcnt(4)
  v_mfma_f32_16x16x32_bf16 v[120:123], v[104:107], v[16:19], v[120:123]
  ds_read_b128 v[12:15], v5 offset:48128
  s_waitcnt lgkmcnt(4)
  v_mfma_f32_16x16x32_bf16 v[124:127], v[104:107], v[20:23], v[124:127]
  s_waitcnt vmcnt(0)
  s_waitcnt lgkmcnt(3)
  v_mfma_f32_16x16x32_bf16 v[112:115], v[108:111], v[24:27], v[112:115]
  s_waitcnt lgkmcnt(2)
  v_mfma_f32_16x16x32_bf16 v[116:119], v[108:111], v[28:31], v[116:119]
  s_waitcnt lgkmcnt(1)
  v_mfma_f32_16x16x32_bf16 v[120:123], v[108:111], v[8:11], v[120:123]
  s_waitcnt lgkmcnt(0)
  v_mfma_f32_16x16x32_bf16 v[124:127], v[108:111], v[12:15], v[124:127]
  v_add_u32 v1, s57, v3
  s_nop 0
  v_permlane32_swap_b32 v112, v114
  v_permlane32_swap_b32 v113, v115
  v_permlane32_swap_b32 v116, v118
  v_permlane32_swap_b32 v117, v119
  v_permlane16_swap_b32 v112, v113
  v_permlane16_swap_b32 v114, v115
  v_permlane16_swap_b32 v116, v117
  v_permlane16_swap_b32 v118, v119
  v_pk_mul_f32 v[12:13], v[112:113], v[112:113]
  v_pk_mul_f32 v[14:15], v[114:115], v[114:115]
  v_pk_mul_f32 v[16:17], v[116:117], v[116:117]
  v_pk_mul_f32 v[18:19], v[118:119], v[118:119]
  v_pk_fma_f32 v[12:13], v[12:13], s[62:63], v[6:7]
  v_pk_fma_f32 v[14:15], v[14:15], s[62:63], v[6:7]
  v_pk_fma_f32 v[16:17], v[16:17], s[62:63], v[6:7]
  v_pk_fma_f32 v[18:19], v[18:19], s[62:63], v[6:7]
  v_pk_mul_f32 v[12:13], v[12:13], v[112:113]
  v_pk_mul_f32 v[14:15], v[14:15], v[114:115]
  v_pk_mul_f32 v[16:17], v[16:17], v[116:117]
  v_pk_mul_f32 v[18:19], v[18:19], v[118:119]
  v_exp_f32 v12, v12
  v_exp_f32 v13, v13
  v_exp_f32 v14, v14
  v_exp_f32 v15, v15
  v_exp_f32 v16, v16
  v_exp_f32 v17, v17
  v_exp_f32 v18, v18
  v_exp_f32 v19, v19
  v_pk_add_f32 v[12:13], v[12:13], 1.0 op_sel_hi:[1,0]
  v_pk_add_f32 v[14:15], v[14:15], 1.0 op_sel_hi:[1,0]
  v_pk_add_f32 v[16:17], v[16:17], 1.0 op_sel_hi:[1,0]
  v_pk_add_f32 v[18:19], v[18:19], 1.0 op_sel_hi:[1,0]
  v_rcp_f32 v12, v12
  v_rcp_f32 v13, v13
  v_rcp_f32 v14, v14
  v_rcp_f32 v15, v15
  v_rcp_f32 v16, v16
  v_rcp_f32 v17, v17
  v_rcp_f32 v18, v18
  v_rcp_f32 v19, v19
  v_pk_mul_f32 v[12:13], v[12:13], v[112:113]
  v_pk_mul_f32 v[14:15], v[14:15], v[114:115]
  v_pk_mul_f32 v[16:17], v[16:17], v[116:117]
  v_pk_mul_f32 v[18:19], v[18:19], v[118:119]
  v_cvt_pk_bf16_f32 v24, v12, v13
  v_cvt_pk_bf16_f32 v25, v14, v15
  v_cvt_pk_bf16_f32 v26, v16, v17
  v_cvt_pk_bf16_f32 v27, v18, v19
  ds_write_b64 v1, v[24:25] offset:0
  ds_write_b64 v1, v[26:27] offset:1024
  v_pk_mul_f32 v[8:9], v[12:13], v[12:13]
  v_pk_mul_f32 v[10:11], v[14:15], v[14:15]
  v_pk_add_f32 v[20:21], v[12:13], v[16:17]
  v_pk_fma_f32 v[8:9], v[16:17], v[16:17], v[8:9]
  v_pk_add_f32 v[22:23], v[14:15], v[18:19]
  v_pk_fma_f32 v[10:11], v[18:19], v[18:19], v[10:11]
  v_permlane32_swap_b32 v120, v122
  v_permlane32_swap_b32 v121, v123
  v_permlane32_swap_b32 v124, v126
  v_permlane32_swap_b32 v125, v127
  v_permlane16_swap_b32 v120, v121
  v_permlane16_swap_b32 v122, v123
  v_permlane16_swap_b32 v124, v125
  v_permlane16_swap_b32 v126, v127
  v_pk_mul_f32 v[12:13], v[120:121], v[120:121]
  v_pk_mul_f32 v[14:15], v[122:123], v[122:123]
  v_pk_mul_f32 v[16:17], v[124:125], v[124:125]
  v_pk_mul_f32 v[18:19], v[126:127], v[126:127]
  v_pk_fma_f32 v[12:13], v[12:13], s[62:63], v[6:7]
  v_pk_fma_f32 v[14:15], v[14:15], s[62:63], v[6:7]
  v_pk_fma_f32 v[16:17], v[16:17], s[62:63], v[6:7]
  v_pk_fma_f32 v[18:19], v[18:19], s[62:63], v[6:7]
  v_pk_mul_f32 v[12:13], v[12:13], v[120:121]
  v_pk_mul_f32 v[14:15], v[14:15], v[122:123]
  v_pk_mul_f32 v[16:17], v[16:17], v[124:125]
  v_pk_mul_f32 v[18:19], v[18:19], v[126:127]
  v_exp_f32 v12, v12
  v_exp_f32 v13, v13
  v_exp_f32 v14, v14
  v_exp_f32 v15, v15
  v_exp_f32 v16, v16
  v_exp_f32 v17, v17
  v_exp_f32 v18, v18
  v_exp_f32 v19, v19
  v_pk_add_f32 v[12:13], v[12:13], 1.0 op_sel_hi:[1,0]
  v_pk_add_f32 v[14:15], v[14:15], 1.0 op_sel_hi:[1,0]
  v_pk_add_f32 v[16:17], v[16:17], 1.0 op_sel_hi:[1,0]
  v_pk_add_f32 v[18:19], v[18:19], 1.0 op_sel_hi:[1,0]
  v_rcp_f32 v12, v12
  v_rcp_f32 v13, v13
  v_rcp_f32 v14, v14
  v_rcp_f32 v15, v15
  v_rcp_f32 v16, v16
  v_rcp_f32 v17, v17
  v_rcp_f32 v18, v18
  v_rcp_f32 v19, v19
  v_pk_mul_f32 v[12:13], v[12:13], v[120:121]
  v_pk_mul_f32 v[14:15], v[14:15], v[122:123]
  v_pk_mul_f32 v[16:17], v[16:17], v[124:125]
  v_pk_mul_f32 v[18:19], v[18:19], v[126:127]
  v_cvt_pk_bf16_f32 v28, v12, v13
  v_cvt_pk_bf16_f32 v29, v14, v15
  v_cvt_pk_bf16_f32 v30, v16, v17
  v_cvt_pk_bf16_f32 v31, v18, v19
  ds_write_b64 v1, v[28:29] offset:2048
  ds_write_b64 v1, v[30:31] offset:3072
  v_pk_add_f32 v[20:21], v[20:21], v[12:13]
  v_pk_fma_f32 v[8:9], v[12:13], v[12:13], v[8:9]
  v_pk_add_f32 v[22:23], v[22:23], v[14:15]
  v_pk_fma_f32 v[10:11], v[14:15], v[14:15], v[10:11]
  v_pk_add_f32 v[20:21], v[20:21], v[16:17]
  v_pk_fma_f32 v[8:9], v[16:17], v[16:17], v[8:9]
  v_pk_add_f32 v[22:23], v[22:23], v[18:19]
  v_pk_fma_f32 v[10:11], v[18:19], v[18:19], v[10:11]
  v_add_f32_dpp v20, v20, v20 row_ror:8 row_mask:0xf bank_mask:0x3
  v_add_f32_dpp v8, v8, v8 row_ror:8 row_mask:0xf bank_mask:0x3
  v_add_f32_dpp v21, v21, v21 row_ror:8 row_mask:0xf bank_mask:0x3
  v_add_f32_dpp v9, v9, v9 row_ror:8 row_mask:0xf bank_mask:0x3
  v_add_f32_dpp v20, v22, v22 row_ror:8 row_mask:0xf bank_mask:0xc
  v_add_f32_dpp v8, v10, v10 row_ror:8 row_mask:0xf bank_mask:0xc
  v_add_f32_dpp v21, v23, v23 row_ror:8 row_mask:0xf bank_mask:0xc
  v_add_f32_dpp v9, v11, v11 row_ror:8 row_mask:0xf bank_mask:0xc
  v_add_f32_dpp v20, v20, v20 row_half_mirror row_mask:0xf bank_mask:0x5
  v_add_f32_dpp v8, v8, v8 row_half_mirror row_mask:0xf bank_mask:0x5
  v_and_b32 v12, 0xffff, v2
  v_add_f32_dpp v20, v21, v21 row_half_mirror row_mask:0xf bank_mask:0xa
  v_add_f32_dpp v8, v9, v9 row_half_mirror row_mask:0xf bank_mask:0xa
  v_lshrrev_b32 v1, 16, v2
  s_mov_b32 vcc_lo, 0xaaaaaaaa
  s_mov_b32 vcc_hi, 0xaaaaaaaa
  v_add_f32_dpp v20, v20, v20 quad_perm:[1,0,3,2] row_mask:0xf bank_mask:0xf
  v_add_f32_dpp v8, v8, v8 quad_perm:[1,0,3,2] row_mask:0xf bank_mask:0xf
  s_nop 0
  v_add_f32_dpp v20, v20, v20 quad_perm:[2,3,0,1] row_mask:0xf bank_mask:0xf
  v_add_f32_dpp v8, v8, v8 quad_perm:[2,3,0,1] row_mask:0xf bank_mask:0xf
  v_cndmask_b32 v13, v20, v8, vcc
  buffer_store_dword v13, v12, s[20:23], s53 offen sc1
  v_add_u32 v2, s58, v3
  s_lshl_b32 s49, s34, 2
  s_add_u32 s49, s49, s47
  s_add_u32 s49, s49, 65536
  s_waitcnt lgkmcnt(0)
  s_barrier
  s_add_u32 s28, s40, 0x1c00000
  s_addc_u32 s29, s41, 0
  s_mov_b32 s30, 0x118000
  s_mov_b32 s31, 0x00020000
  s_and_b32 s60, s2, 1
  s_lshl_b32 s60, s60, 2
  s_lshr_b32 s61, s2, 6
  s_add_u32 s60, s60, s61
  s_lshl_b32 s60, s60, 3
  s_add_u32 s61, s60, s38
  s_add_u32 s60, s60, s34
  s_mul_i32 s60, s60, 17920
  s_mul_i32 s61, s61, 17920
  s_add_u32 s61, s61, 9216
  s_mul_i32 s42, s38, 6144
  s_add_u32 m0, s42, 139264
  s_cmp_lt_u32 s34, 4
  s_cbranch_scc1 kf_kernel_ro63
  s_and_b32 s43, s34, 3
  s_mul_i32 s43, s43, 4160
  s_add_u32 s43, s43, 102400
  v_lshrrev_b32 v14, 1, v3
  v_add_u32 v14, s43, v14
  v_bfe_u32 v15, v3, 4, 3
  v_mul_u32_u24 v15, 512, v15
  v_add_u32 v15, v14, v15
  ds_write_b64 v14, a[8:9] offset:0
  ds_write_b64 v14, a[24:25] offset:520
  ds_write_b64 v14, a[40:41] offset:1040
  ds_write_b64 v14, a[56:57] offset:1560
  ds_write_b64 v14, a[72:73] offset:2080
  ds_write_b64 v14, a[88:89] offset:2600
  ds_write_b64 v14, a[104:105] offset:3120
  ds_write_b64 v14, a[120:121] offset:3640
  ds_read_b64 a[8:9], v15 offset:0
  ds_read_b64 a[24:25], v15 offset:8
  ds_read_b64 a[40:41], v15 offset:16
  ds_read_b64 a[56:57], v15 offset:24
  ds_read_b64 a[72:73], v15 offset:32
  ds_read_b64 a[88:89], v15 offset:40
  ds_read_b64 a[104:105], v15 offset:48
  ds_read_b64 a[120:121], v15 offset:56
  ds_write_b64 v14, a[10:11] offset:0
  ds_write_b64 v14, a[26:27] offset:520
  ds_write_b64 v14, a[42:43] offset:1040
  ds_write_b64 v14, a[58:59] offset:1560
  ds_write_b64 v14, a[74:75] offset:2080
  ds_write_b64 v14, a[90:91] offset:2600
  ds_write_b64 v14, a[106:107] offset:3120
  ds_write_b64 v14, a[122:123] offset:3640
  ds_read_b64 a[10:11], v15 offset:0
  ds_read_b64 a[26:27], v15 offset:8
  ds_read_b64 a[42:43], v15 offset:16
  ds_read_b64 a[58:59], v15 offset:24
  ds_read_b64 a[74:75], v15 offset:32
  ds_read_b64 a[90:91], v15 offset:40
  ds_read_b64 a[106:107], v15 offset:48
  ds_read_b64 a[122:123], v15 offset:56
  buffer_load_dwordx4 v[112:115], v1, s[20:23], s52 offen offset:0 sc1
  buffer_load_dwordx4 v[116:119], v1, s[20:23], s52 offen offset:1024 sc1
  buffer_load_dwordx4 v[120:123], v1, s[20:23], s52 offen offset:2048 sc1
  buffer_load_dwordx4 v[124:127], v1, s[20:23], s52 offen offset:3072 sc1
  s_setprio 3
  s_mov_b32 s43, 400000
  s_branch kf_kernel_l166
kf_kernel_lp64:
  s_sleep 6
  buffer_load_dwordx4 v[112:115], v1, s[20:23], s52 offen offset:0 sc1
  buffer_load_dwordx4 v[116:119], v1, s[20:23], s52 offen offset:1024 sc1
  buffer_load_dwordx4 v[120:123], v1, s[20:23], s52 offen offset:2048 sc1
  buffer_load_dwordx4 v[124:127], v1, s[20:23], s52 offen offset:3072 sc1
kf_kernel_l166:
  s_waitcnt vmcnt(2)
  v_max3_u32 v24, v112, v113, v114
  v_max3_u32 v25, v115, v116, v117
  v_max3_u32 v24, v24, v118, v119
  v_add_f32 v28, v112, v116
  v_add_f32 v29, v113, v117
  v_add_f32 v30, v114, v118
  v_add_f32 v31, v115, v119
  s_waitcnt vmcnt(0)
  v_max3_u32 v25, v25, v120, v121
  v_max3_u32 v24, v24, v122, v123
  v_max3_u32 v25, v25, v124, v125
  v_max3_u32 v24, v24, v126, v127
  v_max_u32 v24, v24, v25
  v_cmp_eq_u32 vcc, -1, v24
  v_add_f32 v16, v120, v124
  v_add_f32 v17, v121, v125
  v_add_f32 v18, v122, v126
  v_add_f32 v19, v123, v127
  s_cbranch_vccz kf_kernel_ld65
  s_sub_u32 s43, s43, 1
  s_cmp_lg_u32 s43, 0
  s_cbranch_scc1 kf_kernel_lp64
kf_kernel_ld65:
  ds_read_b128 v[120:123], v2 offset:0
  ds_read_b128 v[124:127], v2 offset:1024
  v_add_f32 v28, v28, v16
  v_add_f32 v29, v29, v17
  v_add_f32 v30, v30, v18
  v_add_f32 v31, v31, v19
  v_add_f32_dpp v28, v28, v28 row_ror:4 row_mask:0xf bank_mask:0xf
  v_add_f32_dpp v29, v29, v29 row_ror:4 row_mask:0xf bank_mask:0xf
  v_add_f32_dpp v30, v30, v30 row_ror:4 row_mask:0xf bank_mask:0xf
  v_add_f32_dpp v31, v31, v31 row_ror:4 row_mask:0xf bank_mask:0xf
  v_add_f32_dpp v28, v28, v28 row_ror:8 row_mask:0xf bank_mask:0xf
  v_add_f32_dpp v29, v29, v29 row_ror:8 row_mask:0xf bank_mask:0xf
  v_add_f32_dpp v30, v30, v30 row_ror:8 row_mask:0xf bank_mask:0xf
  v_add_f32_dpp v31, v31, v31 row_ror:8 row_mask:0xf bank_mask:0xf
  v_mul_f32 v28, 0x3a97b426, v28
  v_mul_f32 v29, 0x3a97b426, v29
  v_mul_f32 v30, 0x3a97b426, v30
  v_mul_f32 v31, 0x3a97b426, v31
  v_fma_f32 v29, -v28, v28, v29
  v_fma_f32 v31, -v30, v30, v31
  v_max_f32 v29, 0, v29
  v_max_f32 v31, 0, v31
  v_cvt_pk_bf16_f32 v12, v28, v30
  v_cvt_pk_bf16_f32 v13, v29, v31
  v_lshlrev_b32 v8, 16, v12
  v_and_b32 v9, 0xffff0000, v12
  v_lshlrev_b32 v10, 16, v13
  v_and_b32 v11, 0xffff0000, v13
  v_add_f32 v10, 0x3727c5ac, v10
  v_add_f32 v11, 0x3727c5ac, v11
  v_cvt_pk_bf16_f32 v13, v10, v11
  v_lshlrev_b32 v10, 16, v13
  v_and_b32 v11, 0xffff0000, v13
  v_sqrt_f32 v10, v10
  v_sqrt_f32 v11, v11
  v_mov_b32_dpp v16, v8 quad_perm:[0,0,0,0] row_mask:0xf bank_mask:0xf
  v_mov_b32_dpp v17, v9 quad_perm:[0,0,0,0] row_mask:0xf bank_mask:0xf
  v_mov_b32_dpp v18, v8 quad_perm:[1,1,1,1] row_mask:0xf bank_mask:0xf
  v_mov_b32_dpp v19, v9 quad_perm:[1,1,1,1] row_mask:0xf bank_mask:0xf
  v_mov_b32_dpp v20, v8 quad_perm:[2,2,2,2] row_mask:0xf bank_mask:0xf
  v_mov_b32_dpp v21, v9 quad_perm:[2,2,2,2] row_mask:0xf bank_mask:0xf
  v_mov_b32_dpp v22, v8 quad_perm:[3,3,3,3] row_mask:0xf bank_mask:0xf
  v_mov_b32_dpp v23, v9 quad_perm:[3,3,3,3] row_mask:0xf bank_mask:0xf
  v_cvt_pk_bf16_f32 v13, v10, v11
  v_lshlrev_b32 v10, 16, v13
  v_and_b32 v11, 0xffff0000, v13
  v_rcp_f32 v10, v10
  v_rcp_f32 v11, v11
  s_waitcnt lgkmcnt(1)
  v_lshlrev_b32 v112, 16, v120
  v_and_b32 v113, 0xffff0000, v120
  v_lshlrev_b32 v114, 16, v121
  v_and_b32 v115, 0xffff0000, v121
  v_lshlrev_b32 v116, 16, v122
  v_and_b32 v117, 0xffff0000, v122
  v_lshlrev_b32 v118, 16, v123
  v_and_b32 v119, 0xffff0000, v123
  v_pk_add_f32 v[112:113], v[112:113], v[16:17] neg_lo:[0,1] neg_hi:[0,1]
  v_pk_add_f32 v[114:115], v[114:115], v[18:19] neg_lo:[0,1] neg_hi:[0,1]
  v_pk_add_f32 v[116:117], v[116:117], v[20:21] neg_lo:[0,1] neg_hi:[0,1]
  v_pk_add_f32 v[118:119], v[118:119], v[22:23] neg_lo:[0,1] neg_hi:[0,1]
  v_mov_b32_dpp v24, v10 quad_perm:[0,0,0,0] row_mask:0xf bank_mask:0xf
  v_mov_b32_dpp v25, v11 quad_perm:[0,0,0,0] row_mask:0xf bank_mask:0xf
  v_mov_b32_dpp v26, v10 quad_perm:[1,1,1,1] row_mask:0xf bank_mask:0xf
  v_mov_b32_dpp v27, v11 quad_perm:[1,1,1,1] row_mask:0xf bank_mask:0xf
  v_mov_b32_dpp v28, v10 quad_perm:[2,2,2,2] row_mask:0xf bank_mask:0xf
  v_mov_b32_dpp v29, v11 quad_perm:[2,2,2,2] row_mask:0xf bank_mask:0xf
  v_mov_b32_dpp v30, v10 quad_perm:[3,3,3,3] row_mask:0xf bank_mask:0xf
  v_mov_b32_dpp v31, v11 quad_perm:[3,3,3,3] row_mask:0xf bank_mask:0xf
  v_pk_mul_f32 v[112:113], v[112:113], v[24:25]
  v_pk_mul_f32 v[114:115], v[114:115], v[26:27]
  v_pk_mul_f32 v[116:117], v[116:117], v[28:29]
  v_pk_mul_f32 v[118:119], v[118:119], v[30:31]
  v_cvt_pk_bf16_f32 v120, v112, v113
  v_cvt_pk_bf16_f32 v121, v114, v115
  v_cvt_pk_bf16_f32 v122, v116, v117
  v_cvt_pk_bf16_f32 v123, v118, v119
  buffer_store_dwordx4 v[120:123], v3, s[16:19], s54 offen sc1
  s_waitcnt lgkmcnt(0)
  v_lshlrev_b32 v112, 16, v124
  v_and_b32 v113, 0xffff0000, v124
  v_lshlrev_b32 v114, 16, v125
  v_and_b32 v115, 0xffff0000, v125
  v_lshlrev_b32 v116, 16, v126
  v_and_b32 v117, 0xffff0000, v126
  v_lshlrev_b32 v118, 16, v127
  v_and_b32 v119, 0xffff0000, v127
  v_pk_add_f32 v[112:113], v[112:113], v[16:17] neg_lo:[0,1] neg_hi:[0,1]
  v_pk_add_f32 v[114:115], v[114:115], v[18:19] neg_lo:[0,1] neg_hi:[0,1]
  v_pk_add_f32 v[116:117], v[116:117], v[20:21] neg_lo:[0,1] neg_hi:[0,1]
  v_pk_add_f32 v[118:119], v[118:119], v[22:23] neg_lo:[0,1] neg_hi:[0,1]
  v_pk_mul_f32 v[112:113], v[112:113], v[24:25]
  v_pk_mul_f32 v[114:115], v[114:115], v[26:27]
  v_pk_mul_f32 v[116:117], v[116:117], v[28:29]
  v_pk_mul_f32 v[118:119], v[118:119], v[30:31]
  v_cvt_pk_bf16_f32 v124, v112, v113
  v_cvt_pk_bf16_f32 v125, v114, v115
  v_cvt_pk_bf16_f32 v126, v116, v117
  v_cvt_pk_bf16_f32 v127, v118, v119
  buffer_store_dwordx4 v[124:127], v3, s[16:19], s56 offen sc1
  s_setprio 1
kf_kernel_ro63:
  ds_read_b128 v[16:19], v3 offset:20480
  ds_read_b128 v[24:27], v3 offset:21504
  ds_read_b128 v[28:31], v3 offset:22528
  ds_read_b128 v[8:11], v3 offset:23552
  ds_read_b128 v[20:23], v3 offset:24576
  ds_read_b128 v[12:15], v3 offset:25600
  s_waitcnt lgkmcnt(5)
  v_mfma_f32_16x16x32_bf16 v[112:115], v[16:19], v[32:35], 0
  s_waitcnt lgkmcnt(4)
  v_mfma_f32_16x16x32_bf16 v[116:119], v[24:27], v[32:35], 0
  ds_read_b128 v[16:19], v3 offset:26624
  s_waitcnt lgkmcnt(4)
  v_mfma_f32_16x16x32_bf16 v[120:123], v[28:31], v[32:35], 0
  ds_read_b128 v[24:27], v3 offset:27648
  s_waitcnt lgkmcnt(4)
  v_mfma_f32_16x16x32_bf16 v[112:115], v[8:11], v[36:39], v[112:115]
  ds_read_b128 v[28:31], v3 offset:28672
  s_waitcnt lgkmcnt(4)
  v_mfma_f32_16x16x32_bf16 v[116:119], v[20:23], v[36:39], v[116:119]
  ds_read_b128 v[8:11], v3 offset:29696
  s_waitcnt lgkmcnt(4)
  v_mfma_f32_16x16x32_bf16 v[120:123], v[12:15], v[36:39], v[120:123]
  ds_read_b128 v[20:23], v3 offset:30720
  s_waitcnt lgkmcnt(4)
  v_mfma_f32_16x16x32_bf16 v[112:115], v[16:19], v[40:43], v[112:115]
  ds_read_b128 v[12:15], v3 offset:31744
  s_waitcnt lgkmcnt(4)
  v_mfma_f32_16x16x32_bf16 v[116:119], v[24:27], v[40:43], v[116:119]
  ds_read_b128 v[16:19], v3 offset:32768
  s_waitcnt lgkmcnt(4)
  v_mfma_f32_16x16x32_bf16 v[120:123], v[28:31], v[40:43], v[120:123]
  ds_read_b128 v[24:27], v3 offset:33792
  s_waitcnt lgkmcnt(4)
  v_mfma_f32_16x16x32_bf16 v[112:115], v[8:11], v[44:47], v[112:115]
  ds_read_b128 v[28:31], v3 offset:34816
  s_waitcnt lgkmcnt(4)
  v_mfma_f32_16x16x32_bf16 v[116:119], v[20:23], v[44:47], v[116:119]
  ds_read_b128 v[8:11], v3 offset:35840
  s_waitcnt lgkmcnt(4)
  v_mfma_f32_16x16x32_bf16 v[120:123], v[12:15], v[44:47], v[120:123]
  ds_read_b128 v[20:23], v3 offset:36864
  s_waitcnt lgkmcnt(4)
  v_mfma_f32_16x16x32_bf16 v[112:115], v[16:19], v[48:51], v[112:115]
  ds_read_b128 v[12:15], v3 offset:37888
  s_waitcnt lgkmcnt(4)
  v_mfma_f32_16x16x32_bf16 v[116:119], v[24:27], v[48:51], v[116:119]
  ds_read_b128 v[16:19], v3 offset:38912
  s_waitcnt lgkmcnt(4)
  v_mfma_f32_16x16x32_bf16 v[120:123], v[28:31], v[48:51], v[120:123]
  ds_read_b128 v[24:27], v3 offset:39936
  s_waitcnt lgkmcnt(4)
  v_mfma_f32_16x16x32_bf16 v[112:115], v[8:11], v[52:55], v[112:115]
  ds_read_b128 v[28:31], v3 offset:40960
  s_waitcnt lgkmcnt(4)
  v_mfma_f32_16x16x32_bf16 v[116:119], v[20:23], v[52:55], v[116:119]
  ds_read_b128 v[8:11], v3 offset:41984
  s_waitcnt lgkmcnt(4)
  v_mfma_f32_16x16x32_bf16 v[120:123], v[12:15], v[52:55], v[120:123]
  ds_read_b128 v[20:23], v3 offset:43008
  s_waitcnt lgkmcnt(4)
  v_mfma_f32_16x16x32_bf16 v[112:115], v[16:19], v[56:59], v[112:115]
  ds_read_b128 v[12:15], v3 offset:44032
  s_waitcnt lgkmcnt(4)
  v_mfma_f32_16x16x32_bf16 v[116:119], v[24:27], v[56:59], v[116:119]
  ds_read_b128 v[16:19], v3 offset:45056
  s_waitcnt lgkmcnt(4)
  v_mfma_f32_16x16x32_bf16 v[120:123], v[28:31], v[56:59], v[120:123]
  ds_read_b128 v[24:27], v3 offset:46080
  s_waitcnt lgkmcnt(4)
  v_mfma_f32_16x16x32_bf16 v[112:115], v[8:11], v[60:63], v[112:115]
  ds_read_b128 v[28:31], v3 offset:47104
  s_waitcnt lgkmcnt(4)
  v_mfma_f32_16x16x32_bf16 v[116:119], v[20:23], v[60:63], v[116:119]
  ds_read_b128 v[8:11], v3 offset:48128
  s_waitcnt lgkmcnt(4)
  v_mfma_f32_16x16x32_bf16 v[120:123], v[12:15], v[60:63], v[120:123]
  ds_read_b128 v[20:23], v3 offset:49152
  s_waitcnt lgkmcnt(4)
  v_mfma_f32_16x16x32_bf16 v[112:115], v[16:19], v[64:67], v[112:115]
  ds_read_b128 v[12:15], v3 offset:50176
  ds_read_b128 v[60:63], v3 offset:51200
  s_waitcnt lgkmcnt(5)
  v_mfma_f32_16x16x32_bf16 v[116:119], v[24:27], v[64:67], v[116:119]
  ds_read_b128 v[16:19], v3 offset:52224
  s_waitcnt lgkmcnt(5)
  v_mfma_f32_16x16x32_bf16 v[120:123], v[28:31], v[64:67], v[120:123]
  ds_read_b128 v[24:27], v3 offset:53248
  s_waitcnt lgkmcnt(5)
  v_mfma_f32_16x16x32_bf16 v[112:115], v[8:11], v[68:71], v[112:115]
  ds_read_b128 v[28:31], v3 offset:54272
  s_waitcnt lgkmcnt(5)
  v_mfma_f32_16x16x32_bf16 v[116:119], v[20:23], v[68:71], v[116:119]
  ds_read_b128 v[64:67], v3 offset:55296
  s_waitcnt lgkmcnt(5)
  v_mfma_f32_16x16x32_bf16 v[120:123], v[12:15], v[68:71], v[120:123]
  ds_read_b128 v[8:11], v3 offset:56320
  s_waitcnt lgkmcnt(5)
  v_mfma_f32_16x16x32_bf16 v[112:115], v[60:63], v[72:75], v[112:115]
  ds_read_b128 v[20:23], v4 offset:0
  s_waitcnt lgkmcnt(5)
  v_mfma_f32_16x16x32_bf16 v[116:119], v[16:19], v[72:75], v[116:119]
  ds_read_b128 v[12:15], v4 offset:1024
  s_waitcnt lgkmcnt(5)
  v_mfma_f32_16x16x32_bf16 v[120:123], v[24:27], v[72:75], v[120:123]
  ds_read_b128 v[68:71], v4 offset:2048
  s_waitcnt lgkmcnt(5)
  v_mfma_f32_16x16x32_bf16 v[112:115], v[28:31], v[76:79], v[112:115]
  ds_read_b128 v[60:63], v4 offset:3072
  s_waitcnt lgkmcnt(5)
  v_mfma_f32_16x16x32_bf16 v[116:119], v[64:67], v[76:79], v[116:119]
  ds_read_b128 v[16:19], v4 offset:4096
  s_waitcnt lgkmcnt(5)
  v_mfma_f32_16x16x32_bf16 v[120:123], v[8:11], v[76:79], v[120:123]
  ds_read_b128 v[24:27], v4 offset:5120
  s_waitcnt lgkmcnt(5)
  v_mfma_f32_16x16x32_bf16 v[112:115], v[20:23], v[80:83], v[112:115]
  ds_read_b128 v[72:75], v4 offset:6144
  s_cmp_lt_u32 s34, 4
  s_cbranch_scc1 kf_kernel_ro67
  s_waitcnt vmcnt(0)
kf_kernel_ro67:
  v_mov_b32 v56, 20000
  v_mov_b32 v57, s46
  s_mov_b64 exec, 1
  ds_add_rtn_u32 v57, v56, v57
  s_mov_b64 exec, -1
  s_waitcnt lgkmcnt(6)
  v_mfma_f32_16x16x32_bf16 v[116:119], v[12:15], v[80:83], v[116:119]
  ds_read_b128 v[28:31], v4 offset:7168
  s_waitcnt lgkmcnt(6)
  v_mfma_f32_16x16x32_bf16 v[120:123], v[68:71], v[80:83], v[120:123]
  ds_read_b128 v[64:67], v4 offset:8192
  s_waitcnt lgkmcnt(6)
  v_mfma_f32_16x16x32_bf16 v[112:115], v[60:63], v[84:87], v[112:115]
  ds_read_b128 v[8:11], v4 offset:9216
  s_waitcnt lgkmcnt(6)
  v_mfma_f32_16x16x32_bf16 v[116:119], v[16:19], v[84:87], v[116:119]
  ds_read_b128 v[76:79], v4 offset:10240
  s_waitcnt lgkmcnt(6)
  v_mfma_f32_16x16x32_bf16 v[120:123], v[24:27], v[84:87], v[120:123]
  ds_read_b128 v[20:23], v4 offset:11264
  s_waitcnt lgkmcnt(6)
  v_mfma_f32_16x16x32_bf16 v[112:115], v[72:75], v[88:91], v[112:115]
  ds_read_b128 v[12:15], v4 offset:12288
  s_waitcnt lgkmcnt(6)
  s_cmp_lt_u32 s34, 4
  s_cbranch_scc1 kf_kernel_ro68
  v_readfirstlane_b32 s42, v57
  s_cmp_lg_u32 s42, 7
  s_cbranch_scc1 kf_kernel_nf69
  s_mov_b64 exec, 1
  v_mov_b32 v0, 1
  buffer_store_dword v0, off, s[68:71], s47 sc1
  s_mov_b64 exec, -1
kf_kernel_nf69:
  buffer_load_dwordx4 v[40:43], v3, s[28:31], s60 offen offset:0
  buffer_load_dwordx4 v[44:47], v3, s[28:31], s60 offen offset:1024
  buffer_load_dwordx4 v[48:51], v3, s[28:31], s60 offen offset:2048
  buffer_load_dwordx4 v[52:55], v3, s[28:31], s60 offen offset:3072
  buffer_load_dwordx4 v3, s[28:31], s61 offen offset:0 lds
  buffer_load_dwordx4 v3, s[28:31], s61 offen offset:1024 lds
  buffer_load_dwordx4 v3, s[28:31], s61 offen offset:2048 lds
  buffer_load_dwordx4 v3, s[28:31], s61 offen offset:3072 lds
  s_add_u32 m0, m0, 4096
  s_add_u32 s61, s61, 4096
  buffer_load_dwordx4 v3, s[28:31], s61 offen offset:0 lds
  buffer_load_dwordx4 v3, s[28:31], s61 offen offset:1024 lds
kf_kernel_ro68:
  s_waitcnt lgkmcnt(5)
  v_mfma_f32_16x16x32_bf16 v[116:119], v[28:31], v[88:91], v[116:119]
  ds_read_b128 v[68:71], v4 offset:13312
  s_waitcnt lgkmcnt(5)
  v_mfma_f32_16x16x32_bf16 v[120:123], v[64:67], v[88:91], v[120:123]
  ds_read_b128 v[80:83], v4 offset:14336
  s_waitcnt lgkmcnt(5)
  v_mfma_f32_16x16x32_bf16 v[112:115], v[8:11], v[92:95], v[112:115]
  ds_read_b128 v[60:63], v4 offset:15360
  s_waitcnt lgkmcnt(5)
  v_mfma_f32_16x16x32_bf16 v[116:119], v[76:79], v[92:95], v[116:119]
  ds_read_b128 v[16:19], v4 offset:16384
  s_waitcnt lgkmcnt(5)
  v_mfma_f32_16x16x32_bf16 v[120:123], v[20:23], v[92:95], v[120:123]
  ds_read_b128 v[24:27], v4 offset:17408
  s_waitcnt lgkmcnt(5)
  v_mfma_f32_16x16x32_bf16 v[112:115], v[12:15], v[96:99], v[112:115]
  ds_read_b128 v[84:87], v4 offset:18432
  s_waitcnt lgkmcnt(5)
  v_mfma_f32_16x16x32_bf16 v[116:119], v[68:71], v[96:99], v[116:119]
  ds_read_b128 v[72:75], v4 offset:19456
  s_waitcnt lgkmcnt(5)
  v_mfma_f32_16x16x32_bf16 v[120:123], v[80:83], v[96:99], v[120:123]
  ds_read_b128 v[28:31], v4 offset:20480
  s_waitcnt lgkmcnt(5)
  v_mfma_f32_16x16x32_bf16 v[112:115], v[60:63], v[100:103], v[112:115]
  ds_read_b128 v[64:67], v4 offset:21504
  s_cmp_lt_u32 s34, 4
  s_cbranch_scc0 kf_kernel_ro70
  buffer_load_dwordx4 v[32:35], v1, s[20:23], s52 offen offset:0 sc1
  buffer_load_dwordx4 v[36:39], v1, s[20:23], s52 offen offset:1024 sc1
  buffer_load_dwordx4 v[40:43], v1, s[20:23], s52 offen offset:2048 sc1
  buffer_load_dwordx4 v[44:47], v1, s[20:23], s52 offen offset:3072 sc1
kf_kernel_ro70:
  s_cmp_lt_u32 s34, 4
  s_cbranch_scc0 kf_kernel_ro71
  ds_read_b128 v[48:51], v2 offset:0
  ds_read_b128 v[52:55], v2 offset:1024
kf_kernel_ro71:
  s_waitcnt lgkmcnt(5)
  v_mfma_f32_16x16x32_bf16 v[116:119], v[16:19], v[100:103], v[116:119]
  ds_read_b128 v[88:91], v4 offset:22528
  s_waitcnt lgkmcnt(5)
  v_mfma_f32_16x16x32_bf16 v[120:123], v[24:27], v[100:103], v[120:123]
  ds_read_b128 v[8:11], v4 offset:23552
  s_waitcnt lgkmcnt(5)
  v_mfma_f32_16x16x32_bf16 v[112:115], v[84:87], v[104:107], v[112:115]
  s_waitcnt lgkmcnt(4)
  v_mfma_f32_16x16x32_bf16 v[116:119], v[72:75], v[104:107], v[116:119]
  s_waitcnt lgkmcnt(3)
  v_mfma_f32_16x16x32_bf16 v[120:123], v[28:31], v[104:107], v[120:123]
  s_waitcnt lgkmcnt(2)
  v_mfma_f32_16x16x32_bf16 v[112:115], v[64:67], v[108:111], v[112:115]
  s_waitcnt lgkmcnt(1)
  v_mfma_f32_16x16x32_bf16 v[116:119], v[88:91], v[108:111], v[116:119]
  s_waitcnt lgkmcnt(0)
  v_mfma_f32_16x16x32_bf16 v[120:123], v[8:11], v[108:111], v[120:123]
  s_setprio 3
  s_cmp_lt_u32 s34, 4
  s_cbranch_scc0 kf_kernel_ro72
  s_mov_b32 s43, 400000
  s_waitcnt lgkmcnt(0)
  v_lshlrev_b32 v56, 16, v48
  v_and_b32 v57, 0xffff0000, v48
  v_lshlrev_b32 v58, 16, v49
  v_and_b32 v59, 0xffff0000, v49
  v_lshlrev_b32 v60, 16, v50
  v_and_b32 v61, 0xffff0000, v50
  v_lshlrev_b32 v62, 16, v51
  v_and_b32 v63, 0xffff0000, v51
  v_lshlrev_b32 v64, 16, v52
  v_and_b32 v65, 0xffff0000, v52
  v_lshlrev_b32 v66, 16, v53
  v_and_b32 v67, 0xffff0000, v53
  v_lshlrev_b32 v68, 16, v54
  v_and_b32 v69, 0xffff0000, v54
  v_lshlrev_b32 v70, 16, v55
  v_and_b32 v71, 0xffff0000, v55
  s_branch kf_kernel_l175
kf_kernel_lp73:
  s_sleep 6
  buffer_load_dwordx4 v[32:35], v1, s[20:23], s52 offen offset:0 sc1
  buffer_load_dwordx4 v[36:39], v1, s[20:23], s52 offen offset:1024 sc1
  buffer_load_dwordx4 v[40:43], v1, s[20:23], s52 offen offset:2048 sc1
  buffer_load_dwordx4 v[44:47], v1, s[20:23], s52 offen offset:3072 sc1
kf_kernel_l175:
  s_waitcnt vmcnt(2)
  v_max3_u32 v24, v32, v33, v34
  v_max3_u32 v25, v35, v36, v37
  v_max3_u32 v24, v24, v38, v39
  v_add_f32 v28, v32, v36
  v_add_f32 v29, v33, v37
  v_add_f32 v30, v34, v38
  v_add_f32 v31, v35, v39
  s_waitcnt vmcnt(0)
  v_max3_u32 v25, v25, v40, v41
  v_max3_u32 v24, v24, v42, v43
  v_max3_u32 v25, v25, v44, v45
  v_max3_u32 v24, v24, v46, v47
  v_max_u32 v24, v24, v25
  v_cmp_eq_u32 vcc, -1, v24
  v_add_f32 v16, v40, v44
  v_add_f32 v17, v41, v45
  v_add_f32 v18, v42, v46
  v_add_f32 v19, v43, v47
  s_cbranch_vccz kf_kernel_ld74
  s_sub_u32 s43, s43, 1
  s_cmp_lg_u32 s43, 0
  s_cbranch_scc1 kf_kernel_lp73
kf_kernel_ld74:
  v_add_f32 v28, v28, v16
  v_add_f32 v29, v29, v17
  v_add_f32 v30, v30, v18
  v_add_f32 v31, v31, v19
  v_add_f32_dpp v28, v28, v28 row_ror:4 row_mask:0xf bank_mask:0xf
  v_add_f32_dpp v29, v29, v29 row_ror:4 row_mask:0xf bank_mask:0xf
  v_add_f32_dpp v30, v30, v30 row_ror:4 row_mask:0xf bank_mask:0xf
  v_add_f32_dpp v31, v31, v31 row_ror:4 row_mask:0xf bank_mask:0xf
  v_add_f32_dpp v28, v28, v28 row_ror:8 row_mask:0xf bank_mask:0xf
  v_add_f32_dpp v29, v29, v29 row_ror:8 row_mask:0xf bank_mask:0xf
  v_add_f32_dpp v30, v30, v30 row_ror:8 row_mask:0xf bank_mask:0xf
  v_add_f32_dpp v31, v31, v31 row_ror:8 row_mask:0xf bank_mask:0xf
  v_mul_f32 v28, 0x3a97b426, v28
  v_mul_f32 v29, 0x3a97b426, v29
  v_mul_f32 v30, 0x3a97b426, v30
  v_mul_f32 v31, 0x3a97b426, v31
  v_fma_f32 v29, -v28, v28, v29
  v_fma_f32 v31, -v30, v30, v31
  v_max_f32 v29, 0, v29
  v_max_f32 v31, 0, v31
  v_cvt_pk_bf16_f32 v12, v28, v30
  v_cvt_pk_bf16_f32 v13, v29, v31
  v_lshlrev_b32 v8, 16, v12
  v_and_b32 v9, 0xffff0000, v12
  v_lshlrev_b32 v10, 16, v13
  v_and_b32 v11, 0xffff0000, v13
  v_add_f32 v10, 0x3727c5ac, v10
  v_add_f32 v11, 0x3727c5ac, v11
  v_cvt_pk_bf16_f32 v13, v10, v11
  v_lshlrev_b32 v10, 16, v13
  v_and_b32 v11, 0xffff0000, v13
  v_sqrt_f32 v10, v10
  v_sqrt_f32 v11, v11
  v_mov_b32_dpp v16, v8 quad_perm:[0,0,0,0] row_mask:0xf bank_mask:0xf
  v_mov_b32_dpp v17, v9 quad_perm:[0,0,0,0] row_mask:0xf bank_mask:0xf
  v_mov_b32_dpp v18, v8 quad_perm:[1,1,1,1] row_mask:0xf bank_mask:0xf
  v_mov_b32_dpp v19, v9 quad_perm:[1,1,1,1] row_mask:0xf bank_mask:0xf
  v_mov_b32_dpp v20, v8 quad_perm:[2,2,2,2] row_mask:0xf bank_mask:0xf
  v_mov_b32_dpp v21, v9 quad_perm:[2,2,2,2] row_mask:0xf bank_mask:0xf
  v_mov_b32_dpp v22, v8 quad_perm:[3,3,3,3] row_mask:0xf bank_mask:0xf
  v_mov_b32_dpp v23, v9 quad_perm:[3,3,3,3] row_mask:0xf bank_mask:0xf
  v_cvt_pk_bf16_f32 v13, v10, v11
  v_lshlrev_b32 v10, 16, v13
  v_and_b32 v11, 0xffff0000, v13
  v_rcp_f32 v10, v10
  v_rcp_f32 v11, v11
  v_pk_add_f32 v[56:57], v[56:57], v[16:17] neg_lo:[0,1] neg_hi:[0,1]
  v_pk_add_f32 v[58:59], v[58:59], v[18:19] neg_lo:[0,1] neg_hi:[0,1]
  v_pk_add_f32 v[60:61], v[60:61], v[20:21] neg_lo:[0,1] neg_hi:[0,1]
  v_pk_add_f32 v[62:63], v[62:63], v[22:23] neg_lo:[0,1] neg_hi:[0,1]
  v_mov_b32_dpp v24, v10 quad_perm:[0,0,0,0] row_mask:0xf bank_mask:0xf
  v_mov_b32_dpp v25, v11 quad_perm:[0,0,0,0] row_mask:0xf bank_mask:0xf
  v_mov_b32_dpp v26, v10 quad_perm:[1,1,1,1] row_mask:0xf bank_mask:0xf
  v_mov_b32_dpp v27, v11 quad_perm:[1,1,1,1] row_mask:0xf bank_mask:0xf
  v_mov_b32_dpp v28, v10 quad_perm:[2,2,2,2] row_mask:0xf bank_mask:0xf
  v_mov_b32_dpp v29, v11 quad_perm:[2,2,2,2] row_mask:0xf bank_mask:0xf
  v_mov_b32_dpp v30, v10 quad_perm:[3,3,3,3] row_mask:0xf bank_mask:0xf
  v_mov_b32_dpp v31, v11 quad_perm:[3,3,3,3] row_mask:0xf bank_mask:0xf
  v_pk_mul_f32 v[56:57], v[56:57], v[24:25]
  v_pk_mul_f32 v[58:59], v[58:59], v[26:27]
  v_pk_mul_f32 v[60:61], v[60:61], v[28:29]
  v_pk_mul_f32 v[62:63], v[62:63], v[30:31]
  v_cvt_pk_bf16_f32 v48, v56, v57
  v_cvt_pk_bf16_f32 v49, v58, v59
  v_cvt_pk_bf16_f32 v50, v60, v61
  v_cvt_pk_bf16_f32 v51, v62, v63
  buffer_store_dwordx4 v[48:51], v3, s[16:19], s54 offen sc1
  v_pk_add_f32 v[64:65], v[64:65], v[16:17] neg_lo:[0,1] neg_hi:[0,1]
  v_pk_add_f32 v[66:67], v[66:67], v[18:19] neg_lo:[0,1] neg_hi:[0,1]
  v_pk_add_f32 v[68:69], v[68:69], v[20:21] neg_lo:[0,1] neg_hi:[0,1]
  v_pk_add_f32 v[70:71], v[70:71], v[22:23] neg_lo:[0,1] neg_hi:[0,1]
  v_pk_mul_f32 v[64:65], v[64:65], v[24:25]
  v_pk_mul_f32 v[66:67], v[66:67], v[26:27]
  v_pk_mul_f32 v[68:69], v[68:69], v[28:29]
  v_pk_mul_f32 v[70:71], v[70:71], v[30:31]
  v_cvt_pk_bf16_f32 v52, v64, v65
  v_cvt_pk_bf16_f32 v53, v66, v67
  v_cvt_pk_bf16_f32 v54, v68, v69
  v_cvt_pk_bf16_f32 v55, v70, v71
  buffer_store_dwordx4 v[52:55], v3, s[16:19], s56 offen sc1
kf_kernel_ro72:
  s_setprio 2
  v_lshrrev_b32 v1, 1, v3
  v_pk_mul_f32 v[80:81], v[112:113], v[112:113]
  v_pk_mul_f32 v[82:83], v[114:115], v[114:115]
  v_pk_mul_f32 v[84:85], v[116:117], v[116:117]
  v_pk_mul_f32 v[86:87], v[118:119], v[118:119]
  v_pk_fma_f32 v[80:81], v[80:81], s[62:63], v[6:7]
  v_pk_fma_f32 v[82:83], v[82:83], s[62:63], v[6:7]
  v_pk_fma_f32 v[84:85], v[84:85], s[62:63], v[6:7]
  v_pk_fma_f32 v[86:87], v[86:87], s[62:63], v[6:7]
  v_pk_mul_f32 v[80:81], v[80:81], v[112:113]
  v_pk_mul_f32 v[82:83], v[82:83], v[114:115]
  v_pk_mul_f32 v[84:85], v[84:85], v[116:117]
  v_pk_mul_f32 v[86:87], v[86:87], v[118:119]
  v_exp_f32 v80, v80
  v_exp_f32 v81, v81
  v_exp_f32 v82, v82
  v_exp_f32 v83, v83
  v_exp_f32 v84, v84
  v_exp_f32 v85, v85
  v_exp_f32 v86, v86
  v_exp_f32 v87, v87
  v_pk_add_f32 v[80:81], v[80:81], 1.0 op_sel_hi:[1,0]
  v_pk_add_f32 v[82:83], v[82:83], 1.0 op_sel_hi:[1,0]
  v_pk_add_f32 v[84:85], v[84:85], 1.0 op_sel_hi:[1,0]
  v_pk_add_f32 v[86:87], v[86:87], 1.0 op_sel_hi:[1,0]
  v_rcp_f32 v80, v80
  v_rcp_f32 v81, v81
  v_rcp_f32 v82, v82
  v_rcp_f32 v83, v83
  v_rcp_f32 v84, v84
  v_rcp_f32 v85, v85
  v_rcp_f32 v86, v86
  v_rcp_f32 v87, v87
  v_pk_mul_f32 v[80:81], v[80:81], v[112:113]
  v_pk_mul_f32 v[82:83], v[82:83], v[114:115]
  v_pk_mul_f32 v[84:85], v[84:85], v[116:117]
  v_pk_mul_f32 v[86:87], v[86:87], v[118:119]
  v_cvt_pk_bf16_f32 v72, v80, v81
  v_cvt_pk_bf16_f32 v73, v82, v83
  v_cvt_pk_bf16_f32 v74, v84, v85
  v_cvt_pk_bf16_f32 v75, v86, v87
  s_cmp_lt_u32 s34, 4
  s_cbranch_scc0 kf_kernel_ro76
  s_waitcnt vmcnt(0)
  v_mov_b32 v56, 20000
  v_mov_b32 v57, 1
  s_mov_b64 exec, 1
  ds_add_rtn_u32 v57, v56, v57
  s_mov_b64 exec, -1
  s_waitcnt lgkmcnt(0)
  v_readfirstlane_b32 s42, v57
  s_cmp_lg_u32 s42, 7
  s_cbranch_scc1 kf_kernel_nf77
  s_mov_b64 exec, 1
  v_mov_b32 v0, 1
  buffer_store_dword v0, off, s[68:71], s47 sc1
  s_mov_b64 exec, -1
kf_kernel_nf77:
  buffer_load_dwordx4 v[40:43], v3, s[28:31], s60 offen offset:0
  buffer_load_dwordx4 v[44:47], v3, s[28:31], s60 offen offset:1024
  buffer_load_dwordx4 v[48:51], v3, s[28:31], s60 offen offset:2048
  buffer_load_dwordx4 v[52:55], v3, s[28:31], s60 offen offset:3072
kf_kernel_ro76:
  buffer_store_dwordx4 v[72:75], v3, s[12:15], s55 offen offset:2048 sc1
  v_pk_mul_f32 v[96:97], v[120:121], v[120:121]
  v_pk_mul_f32 v[98:99], v[122:123], v[122:123]
  v_pk_fma_f32 v[96:97], v[96:97], s[62:63], v[6:7]
  v_pk_fma_f32 v[98:99], v[98:99], s[62:63], v[6:7]
  v_pk_mul_f32 v[96:97], v[96:97], v[120:121]
  v_pk_mul_f32 v[98:99], v[98:99], v[122:123]
  v_exp_f32 v96, v96
  v_exp_f32 v97, v97
  v_exp_f32 v98, v98
  v_exp_f32 v99, v99
  v_pk_add_f32 v[96:97], v[96:97], 1.0 op_sel_hi:[1,0]
  v_pk_add_f32 v[98:99], v[98:99], 1.0 op_sel_hi:[1,0]
  v_rcp_f32 v96, v96
  v_rcp_f32 v97, v97
  v_rcp_f32 v98, v98
  v_rcp_f32 v99, v99
  v_pk_mul_f32 v[96:97], v[96:97], v[120:121]
  v_pk_mul_f32 v[98:99], v[98:99], v[122:123]
  v_cvt_pk_bf16_f32 v76, v96, v97
  v_cvt_pk_bf16_f32 v77, v98, v99
  buffer_store_dwordx2 v[76:77], v1, s[12:15], s55 offen offset:3072 sc1
  s_and_b32 s33, s2, 7
  s_lshr_b32 s42, s2, 3
  s_lshr_b32 s35, s33, 1
  s_lshl_b32 s35, s35, 3
  s_and_b32 s36, s42, 7
  s_add_u32 s35, s35, s36
  s_and_b32 s36, s33, 1
  s_lshl_b32 s36, s36, 2
  s_lshr_b32 s42, s42, 3
  s_add_u32 s36, s36, s42
  s_load_dwordx2 s[24:25], s[0:1], 48
  s_setprio 0
  s_lshl_b32 s44, s36, 12
  s_add_u32 s44, s44, 32768
  v_bfe_u32 v10, v3, 4, 5
  v_lshlrev_b32 v10, 7, v10
  s_cmp_lt_u32 s34, 4
  s_cbranch_scc0 kf_kernel_ro80
  s_and_b32 s43, s34, 3
  s_mul_i32 s43, s43, 4160
  s_add_u32 s43, s43, 119040
  v_lshrrev_b32 v14, 1, v3
  v_add_u32 v14, s43, v14
  v_bfe_u32 v15, v3, 4, 3
  v_mul_u32_u24 v15, 512, v15
  v_add_u32 v15, v14, v15
  ds_write_b64 v14, a[8:9] offset:0
  ds_write_b64 v14, a[24:25] offset:520
  ds_write_b64 v14, a[40:41] offset:1040
  ds_write_b64 v14, a[56:57] offset:1560
  ds_write_b64 v14, a[72:73] offset:2080
  ds_write_b64 v14, a[88:89] offset:2600
  ds_write_b64 v14, a[104:105] offset:3120
  ds_write_b64 v14, a[120:121] offset:3640
  ds_read_b64 a[8:9], v15 offset:0
  ds_read_b64 a[24:25], v15 offset:8
  ds_read_b64 a[40:41], v15 offset:16
  ds_read_b64 a[56:57], v15 offset:24
  ds_read_b64 a[72:73], v15 offset:32
  ds_read_b64 a[88:89], v15 offset:40
  ds_read_b64 a[104:105], v15 offset:48
  ds_read_b64 a[120:121], v15 offset:56
  ds_write_b64 v14, a[10:11] offset:0
  ds_write_b64 v14, a[26:27] offset:520
  ds_write_b64 v14, a[42:43] offset:1040
  ds_write_b64 v14, a[58:59] offset:1560
  ds_write_b64 v14, a[74:75] offset:2080
  ds_write_b64 v14, a[90:91] offset:2600
  ds_write_b64 v14, a[106:107] offset:3120
  ds_write_b64 v14, a[122:123] offset:3640
  ds_read_b64 a[10:11], v15 offset:0
  ds_read_b64 a[26:27], v15 offset:8
  ds_read_b64 a[42:43], v15 offset:16
  ds_read_b64 a[58:59], v15 offset:24
  ds_read_b64 a[74:75], v15 offset:32
  ds_read_b64 a[90:91], v15 offset:40
  ds_read_b64 a[106:107], v15 offset:48
  ds_read_b64 a[122:123], v15 offset:56
  ds_write_b64 v14, a[12:13] offset:0
  ds_write_b64 v14, a[28:29] offset:520
  ds_write_b64 v14, a[44:45] offset:1040
  ds_write_b64 v14, a[60:61] offset:1560
  ds_write_b64 v14, a[76:77] offset:2080
  ds_write_b64 v14, a[92:93] offset:2600
  ds_write_b64 v14, a[108:109] offset:3120
  ds_write_b64 v14, a[124:125] offset:3640
  ds_read_b64 a[12:13], v15 offset:0
  ds_read_b64 a[28:29], v15 offset:8
  ds_read_b64 a[44:45], v15 offset:16
  ds_read_b64 a[60:61], v15 offset:24
  ds_read_b64 a[76:77], v15 offset:32
  ds_read_b64 a[92:93], v15 offset:40
  ds_read_b64 a[108:109], v15 offset:48
  ds_read_b64 a[124:125], v15 offset:56
  ds_write_b64 v14, a[14:15] offset:0
  ds_write_b64 v14, a[30:31] offset:520
  ds_write_b64 v14, a[46:47] offset:1040
  ds_write_b64 v14, a[62:63] offset:1560
  ds_write_b64 v14, a[78:79] offset:2080
  ds_write_b64 v14, a[94:95] offset:2600
  ds_write_b64 v14, a[110:111] offset:3120
  ds_write_b64 v14, a[126:127] offset:3640
  ds_read_b64 a[14:15], v15 offset:0
  ds_read_b64 a[30:31], v15 offset:8
  ds_read_b64 a[46:47], v15 offset:16
  ds_read_b64 a[62:63], v15 offset:24
  ds_read_b64 a[78:79], v15 offset:32
  ds_read_b64 a[94:95], v15 offset:40
  ds_read_b64 a[110:111], v15 offset:48
  ds_read_b64 a[126:127], v15 offset:56
kf_kernel_ro80:
  s_cmp_ge_u32 s34, 4
  s_cbranch_scc1 kf_kernel_t479
  s_cmp_lg_u32 s34, 0
  s_cbranch_scc1 kf_kernel_tj78
  s_mov_b64 exec, 0xffffffff
  s_mov_b32 s43, 400000
kf_kernel_lp81:
  buffer_load_dword v9, v10, s[68:71], s44 offen sc1
  s_waitcnt vmcnt(0)
  v_cmp_eq_u32 vcc, 0, v9
  s_cbranch_vccz kf_kernel_ld82
  s_sub_u32 s43, s43, 1
  s_cmp_lg_u32 s43, 0
  s_cbranch_scc1 kf_kernel_lp81
kf_kernel_ld82:
  s_mov_b64 exec, -1
  s_branch kf_kernel_tj78
kf_kernel_t479:
  s_and_b32 s43, s34, 3
  s_mul_i32 s43, s43, 4160
  s_add_u32 s43, s43, 102400
  v_lshrrev_b32 v14, 1, v3
  v_add_u32 v14, s43, v14
  v_bfe_u32 v15, v3, 4, 3
  v_mul_u32_u24 v15, 512, v15
  v_add_u32 v15, v14, v15
  ds_write_b64 v14, a[12:13] offset:0
  ds_write_b64 v14, a[28:29] offset:520
  ds_write_b64 v14, a[44:45] offset:1040
  ds_write_b64 v14, a[60:61] offset:1560
  ds_write_b64 v14, a[76:77] offset:2080
  ds_write_b64 v14, a[92:93] offset:2600
  ds_write_b64 v14, a[108:109] offset:3120
  ds_write_b64 v14, a[124:125] offset:3640
  ds_read_b64 a[12:13], v15 offset:0
  ds_read_b64 a[28:29], v15 offset:8
  ds_read_b64 a[44:45], v15 offset:16
  ds_read_b64 a[60:61], v15 offset:24
  ds_read_b64 a[76:77], v15 offset:32
  ds_read_b64 a[92:93], v15 offset:40
  ds_read_b64 a[108:109], v15 offset:48
  ds_read_b64 a[124:125], v15 offset:56
  ds_write_b64 v14, a[14:15] offset:0
  ds_write_b64 v14, a[30:31] offset:520
  ds_write_b64 v14, a[46:47] offset:1040
  ds_write_b64 v14, a[62:63] offset:1560
  ds_write_b64 v14, a[78:79] offset:2080
  ds_write_b64 v14, a[94:95] offset:2600
  ds_write_b64 v14, a[110:111] offset:3120
  ds_write_b64 v14, a[126:127] offset:3640
  ds_read_b64 a[14:15], v15 offset:0
  ds_read_b64 a[30:31], v15 offset:8
  ds_read_b64 a[46:47], v15 offset:16
  ds_read_b64 a[62:63], v15 offset:24
  ds_read_b64 a[78:79], v15 offset:32
  ds_read_b64 a[94:95], v15 offset:40
  ds_read_b64 a[110:111], v15 offset:48
  ds_read_b64 a[126:127], v15 offset:56
kf_kernel_tj78:
  s_waitcnt lgkmcnt(0)
  s_barrier
  s_branch kf_kernel_g22
kf_kernel_h153:
  ds_read_b128 v[8:11], v4 offset:45056
  ds_read_b128 v[12:15], v4 offset:46080
  ds_read_b128 v[16:19], v4 offset:47104
  ds_read_b128 v[20:23], v4 offset:48128
  ds_read_b128 v[24:27], v4 offset:49152
  s_waitcnt vmcnt(7)
  s_waitcnt lgkmcnt(4)
  v_mfma_f32_16x16x32_bf16 v[112:115], v[32:35], v[8:11], 0
  ds_read_b128 v[28:31], v4 offset:50176
  buffer_load_dwordx4 v[64:67], v1, s[8:11], s44 offen offset:2048
  s_waitcnt lgkmcnt(4)
  v_mfma_f32_16x16x32_bf16 v[116:119], v[32:35], v[12:15], 0
  ds_read_b128 v[8:11], v4 offset:51200
  s_waitcnt lgkmcnt(4)
  v_mfma_f32_16x16x32_bf16 v[120:123], v[32:35], v[16:19], 0
  ds_read_b128 v[12:15], v4 offset:52224
  s_waitcnt vmcnt(7)
  s_waitcnt lgkmcnt(4)
  v_mfma_f32_16x16x32_bf16 v[112:115], v[36:39], v[20:23], v[112:115]
  ds_read_b128 v[16:19], v4 offset:53248
  buffer_load_dwordx4 v[68:71], v1, s[8:11], s44 offen offset:2304
  s_waitcnt lgkmcnt(4)
  v_mfma_f32_16x16x32_bf16 v[116:119], v[36:39], v[24:27], v[116:119]
  ds_read_b128 v[20:23], v4 offset:54272
  s_waitcnt lgkmcnt(4)
  v_mfma_f32_16x16x32_bf16 v[120:123], v[36:39], v[28:31], v[120:123]
  ds_read_b128 v[24:27], v4 offset:55296
  s_waitcnt vmcnt(7)
  s_waitcnt lgkmcnt(4)
  v_mfma_f32_16x16x32_bf16 v[112:115], v[40:43], v[8:11], v[112:115]
  ds_read_b128 v[28:31], v4 offset:56320
  buffer_load_dwordx4 v[72:75], v1, s[8:11], s44 offen offset:2560
  s_waitcnt lgkmcnt(4)
  v_mfma_f32_16x16x32_bf16 v[116:119], v[40:43], v[12:15], v[116:119]
  ds_read_b128 v[8:11], v5 offset:0
  s_waitcnt lgkmcnt(4)
  v_mfma_f32_16x16x32_bf16 v[120:123], v[40:43], v[16:19], v[120:123]
  ds_read_b128 v[12:15], v5 offset:1024
  s_waitcnt vmcnt(7)
  s_waitcnt lgkmcnt(4)
  v_mfma_f32_16x16x32_bf16 v[112:115], v[44:47], v[20:23], v[112:115]
  ds_read_b128 v[16:19], v5 offset:2048
  buffer_load_dwordx4 v[76:79], v1, s[8:11], s44 offen offset:2816
  s_waitcnt lgkmcnt(4)
  v_mfma_f32_16x16x32_bf16 v[116:119], v[44:47], v[24:27], v[116:119]
  ds_read_b128 v[20:23], v5 offset:3072
  s_waitcnt lgkmcnt(4)
  v_mfma_f32_16x16x32_bf16 v[120:123], v[44:47], v[28:31], v[120:123]
  ds_read_b128 v[24:27], v5 offset:4096
  s_waitcnt vmcnt(7)
  s_waitcnt lgkmcnt(4)
  v_mfma_f32_16x16x32_bf16 v[112:115], v[48:51], v[8:11], v[112:115]
  ds_read_b128 v[28:31], v5 offset:5120
  buffer_load_dwordx4 v[80:83], v1, s[8:11], s44 offen offset:3072
  s_waitcnt lgkmcnt(4)
  v_mfma_f32_16x16x32_bf16 v[116:119], v[48:51], v[12:15], v[116:119]
  ds_read_b128 v[8:11], v5 offset:6144
  s_waitcnt lgkmcnt(4)
  v_mfma_f32_16x16x32_bf16 v[120:123], v[48:51], v[16:19], v[120:123]
  ds_read_b128 v[12:15], v5 offset:7168
  s_waitcnt vmcnt(7)
  s_waitcnt lgkmcnt(4)
  v_mfma_f32_16x16x32_bf16 v[112:115], v[52:55], v[20:23], v[112:115]
  ds_read_b128 v[16:19], v5 offset:8192
  buffer_load_dwordx4 v[84:87], v1, s[8:11], s44 offen offset:3328
  s_waitcnt lgkmcnt(4)
  v_mfma_f32_16x16x32_bf16 v[116:119], v[52:55], v[24:27], v[116:119]
  ds_read_b128 v[20:23], v5 offset:9216
  s_waitcnt lgkmcnt(4)
  v_mfma_f32_16x16x32_bf16 v[120:123], v[52:55], v[28:31], v[120:123]
  ds_read_b128 v[24:27], v5 offset:10240
  s_waitcnt vmcnt(7)
  s_waitcnt lgkmcnt(4)
  v_mfma_f32_16x16x32_bf16 v[112:115], v[56:59], v[8:11], v[112:115]
  ds_read_b128 v[28:31], v5 offset:11264
  buffer_load_dwordx4 v[88:91], v1, s[8:11], s44 offen offset:3584
  s_waitcnt lgkmcnt(4)
  v_mfma_f32_16x16x32_bf16 v[116:119], v[56:59], v[12:15], v[116:119]
  ds_read_b128 v[8:11], v5 offset:12288
  s_waitcnt lgkmcnt(4)
  v_mfma_f32_16x16x32_bf16 v[120:123], v[56:59], v[16:19], v[120:123]
  ds_read_b128 v[12:15], v5 offset:13312
  s_waitcnt vmcnt(7)
  s_waitcnt lgkmcnt(4)
  v_mfma_f32_16x16x32_bf16 v[112:115], v[60:63], v[20:23], v[112:115]
  ds_read_b128 v[16:19], v5 offset:14336
  buffer_load_dwordx4 v[92:95], v1, s[8:11], s44 offen offset:3840
  s_waitcnt lgkmcnt(4)
  v_mfma_f32_16x16x32_bf16 v[116:119], v[60:63], v[24:27], v[116:119]
  ds_read_b128 v[20:23], v5 offset:15360
  s_waitcnt lgkmcnt(4)
  v_mfma_f32_16x16x32_bf16 v[120:123], v[60:63], v[28:31], v[120:123]
  ds_read_b128 v[24:27], v5 offset:16384
  s_waitcnt vmcnt(7)
  s_waitcnt lgkmcnt(4)
  v_mfma_f32_16x16x32_bf16 v[112:115], v[64:67], v[8:11], v[112:115]
  ds_read_b128 v[28:31], v5 offset:17408
  buffer_load_dwordx4 v[96:99], v1, s[8:11], s45 offen offset:0
  s_waitcnt lgkmcnt(4)
  v_mfma_f32_16x16x32_bf16 v[116:119], v[64:67], v[12:15], v[116:119]
  ds_read_b128 v[8:11], v5 offset:18432
  s_waitcnt lgkmcnt(4)
  v_mfma_f32_16x16x32_bf16 v[120:123], v[64:67], v[16:19], v[120:123]
  ds_read_b128 v[12:15], v5 offset:19456
  s_waitcnt vmcnt(7)
  s_waitcnt lgkmcnt(4)
  v_mfma_f32_16x16x32_bf16 v[112:115], v[68:71], v[20:23], v[112:115]
  ds_read_b128 v[16:19], v5 offset:20480
  buffer_load_dwordx4 v[100:103], v1, s[8:11], s45 offen offset:256
  s_waitcnt lgkmcnt(4)
  v_mfma_f32_16x16x32_bf16 v[116:119], v[68:71], v[24:27], v[116:119]
  ds_read_b128 v[20:23], v5 offset:21504
  s_waitcnt lgkmcnt(4)
  v_mfma_f32_16x16x32_bf16 v[120:123], v[68:71], v[28:31], v[120:123]
  ds_read_b128 v[24:27], v5 offset:22528
  s_waitcnt vmcnt(7)
  s_waitcnt lgkmcnt(4)
  v_mfma_f32_16x16x32_bf16 v[112:115], v[72:75], v[8:11], v[112:115]
  ds_read_b128 v[28:31], v5 offset:23552
  buffer_load_dwordx4 v[104:107], v1, s[8:11], s45 offen offset:512
  s_waitcnt lgkmcnt(4)
  v_mfma_f32_16x16x32_bf16 v[116:119], v[72:75], v[12:15], v[116:119]
  ds_read_b128 v[8:11], v5 offset:24576
  s_waitcnt lgkmcnt(4)
  v_mfma_f32_16x16x32_bf16 v[120:123], v[72:75], v[16:19], v[120:123]
  ds_read_b128 v[12:15], v5 offset:25600
  s_waitcnt vmcnt(7)
  s_waitcnt lgkmcnt(4)
  v_mfma_f32_16x16x32_bf16 v[112:115], v[76:79], v[20:23], v[112:115]
  ds_read_b128 v[16:19], v5 offset:26624
  buffer_load_dwordx4 v[108:111], v1, s[8:11], s45 offen offset:768
  s_waitcnt lgkmcnt(4)
  v_mfma_f32_16x16x32_bf16 v[116:119], v[76:79], v[24:27], v[116:119]
  ds_read_b128 v[20:23], v5 offset:27648
  s_waitcnt lgkmcnt(4)
  v_mfma_f32_16x16x32_bf16 v[120:123], v[76:79], v[28:31], v[120:123]
  ds_read_b128 v[24:27], v5 offset:28672
  s_waitcnt vmcnt(7)
  s_waitcnt lgkmcnt(4)
  v_mfma_f32_16x16x32_bf16 v[112:115], v[80:83], v[8:11], v[112:115]
  ds_read_b128 v[28:31], v5 offset:29696
  s_waitcnt lgkmcnt(4)
  v_mfma_f32_16x16x32_bf16 v[116:119], v[80:83], v[12:15], v[116:119]
  ds_read_b128 v[8:11], v5 offset:30720
  s_waitcnt lgkmcnt(4)
  v_mfma_f32_16x16x32_bf16 v[120:123], v[80:83], v[16:19], v[120:123]
  ds_read_b128 v[12:15], v5 offset:31744
  s_waitcnt vmcnt(6)
  s_waitcnt lgkmcnt(4)
  v_mfma_f32_16x16x32_bf16 v[112:115], v[84:87], v[20:23], v[112:115]
  ds_read_b128 v[16:19], v5 offset:32768
  s_waitcnt lgkmcnt(4)
  v_mfma_f32_16x16x32_bf16 v[116:119], v[84:87], v[24:27], v[116:119]
  ds_read_b128 v[20:23], v5 offset:33792
  s_waitcnt lgkmcnt(4)
  v_mfma_f32_16x16x32_bf16 v[120:123], v[84:87], v[28:31], v[120:123]
  ds_read_b128 v[24:27], v5 offset:34816
  s_waitcnt vmcnt(5)
  s_waitcnt lgkmcnt(4)
  v_mfma_f32_16x16x32_bf16 v[112:115], v[88:91], v[8:11], v[112:115]
  ds_read_b128 v[28:31], v5 offset:35840
  s_waitcnt lgkmcnt(4)
  v_mfma_f32_16x16x32_bf16 v[116:119], v[88:91], v[12:15], v[116:119]
  ds_read_b128 v[8:11], v5 offset:36864
  s_waitcnt lgkmcnt(4)
  v_mfma_f32_16x16x32_bf16 v[120:123], v[88:91], v[16:19], v[120:123]
  ds_read_b128 v[12:15], v5 offset:37888
  s_waitcnt vmcnt(4)
  s_waitcnt lgkmcnt(4)
  v_mfma_f32_16x16x32_bf16 v[112:115], v[92:95], v[20:23], v[112:115]
  ds_read_b128 v[16:19], v5 offset:38912
  s_waitcnt lgkmcnt(4)
  v_mfma_f32_16x16x32_bf16 v[116:119], v[92:95], v[24:27], v[116:119]
  ds_read_b128 v[20:23], v5 offset:39936
  s_waitcnt lgkmcnt(4)
  v_mfma_f32_16x16x32_bf16 v[120:123], v[92:95], v[28:31], v[120:123]
  ds_read_b128 v[24:27], v5 offset:40960
  s_waitcnt vmcnt(3)
  s_waitcnt lgkmcnt(4)
  v_mfma_f32_16x16x32_bf16 v[112:115], v[96:99], v[8:11], v[112:115]
  ds_read_b128 v[28:31], v5 offset:41984
  s_waitcnt lgkmcnt(4)
  v_mfma_f32_16x16x32_bf16 v[116:119], v[96:99], v[12:15], v[116:119]
  ds_read_b128 v[8:11], v5 offset:43008
  s_waitcnt lgkmcnt(4)
  v_mfma_f32_16x16x32_bf16 v[120:123], v[96:99], v[16:19], v[120:123]
  ds_read_b128 v[12:15], v5 offset:44032
  s_waitcnt vmcnt(2)
  s_waitcnt lgkmcnt(4)
  v_mfma_f32_16x16x32_bf16 v[112:115], v[100:103], v[20:23], v[112:115]
  ds_read_b128 v[16:19], v5 offset:45056
  s_waitcnt lgkmcnt(4)
  v_mfma_f32_16x16x32_bf16 v[116:119], v[100:103], v[24:27], v[116:119]
  ds_read_b128 v[20:23], v5 offset:46080
  s_waitcnt lgkmcnt(4)
  v_mfma_f32_16x16x32_bf16 v[120:123], v[100:103], v[28:31], v[120:123]
  ds_read_b128 v[24:27], v5 offset:47104
  s_waitcnt vmcnt(1)
  s_waitcnt lgkmcnt(4)
  v_mfma_f32_16x16x32_bf16 v[112:115], v[104:107], v[8:11], v[112:115]
  ds_read_b128 v[28:31], v5 offset:48128
  s_waitcnt lgkmcnt(4)
  v_mfma_f32_16x16x32_bf16 v[116:119], v[104:107], v[12:15], v[116:119]
  s_waitcnt lgkmcnt(3)
  v_mfma_f32_16x16x32_bf16 v[120:123], v[104:107], v[16:19], v[120:123]
  s_waitcnt vmcnt(0)
  s_waitcnt lgkmcnt(2)
  v_mfma_f32_16x16x32_bf16 v[112:115], v[108:111], v[20:23], v[112:115]
  s_waitcnt lgkmcnt(1)
  v_mfma_f32_16x16x32_bf16 v[116:119], v[108:111], v[24:27], v[116:119]
  s_waitcnt lgkmcnt(0)
  v_mfma_f32_16x16x32_bf16 v[120:123], v[108:111], v[28:31], v[120:123]
  v_add_u32 v1, s57, v3
  s_nop 2
  v_permlane32_swap_b32 v112, v114
  v_permlane32_swap_b32 v113, v115
  v_permlane32_swap_b32 v116, v118
  v_permlane32_swap_b32 v117, v119
  v_permlane16_swap_b32 v112, v113
  v_permlane16_swap_b32 v114, v115
  v_permlane16_swap_b32 v116, v117
  v_permlane16_swap_b32 v118, v119
  v_and_b32 v116, s48, v116
  v_and_b32 v117, s48, v117
  v_and_b32 v118, s48, v118
  v_and_b32 v119, s48, v119
  v_pk_mul_f32 v[12:13], v[112:113], v[112:113]
  v_pk_mul_f32 v[14:15], v[114:115], v[114:115]
  v_pk_mul_f32 v[16:17], v[116:117], v[116:117]
  v_pk_mul_f32 v[18:19], v[118:119], v[118:119]
  v_pk_fma_f32 v[12:13], v[12:13], s[62:63], v[6:7]
  v_pk_fma_f32 v[14:15], v[14:15], s[62:63], v[6:7]
  v_pk_fma_f32 v[16:17], v[16:17], s[62:63], v[6:7]
  v_pk_fma_f32 v[18:19], v[18:19], s[62:63], v[6:7]
  v_pk_mul_f32 v[12:13], v[12:13], v[112:113]
  v_pk_mul_f32 v[14:15], v[14:15], v[114:115]
  v_pk_mul_f32 v[16:17], v[16:17], v[116:117]
  v_pk_mul_f32 v[18:19], v[18:19], v[118:119]
  v_exp_f32 v12, v12
  v_exp_f32 v13, v13
  v_exp_f32 v14, v14
  v_exp_f32 v15, v15
  v_exp_f32 v16, v16
  v_exp_f32 v17, v17
  v_exp_f32 v18, v18
  v_exp_f32 v19, v19
  v_pk_add_f32 v[12:13], v[12:13], 1.0 op_sel_hi:[1,0]
  v_pk_add_f32 v[14:15], v[14:15], 1.0 op_sel_hi:[1,0]
  v_pk_add_f32 v[16:17], v[16:17], 1.0 op_sel_hi:[1,0]
  v_pk_add_f32 v[18:19], v[18:19], 1.0 op_sel_hi:[1,0]
  v_rcp_f32 v12, v12
  v_rcp_f32 v13, v13
  v_rcp_f32 v14, v14
  v_rcp_f32 v15, v15
  v_rcp_f32 v16, v16
  v_rcp_f32 v17, v17
  v_rcp_f32 v18, v18
  v_rcp_f32 v19, v19
  v_pk_mul_f32 v[12:13], v[12:13], v[112:113]
  v_pk_mul_f32 v[14:15], v[14:15], v[114:115]
  v_pk_mul_f32 v[16:17], v[16:17], v[116:117]
  v_pk_mul_f32 v[18:19], v[18:19], v[118:119]
  v_cvt_pk_bf16_f32 v24, v12, v13
  v_cvt_pk_bf16_f32 v25, v14, v15
  v_cvt_pk_bf16_f32 v26, v16, v17
  v_cvt_pk_bf16_f32 v27, v18, v19
  ds_write_b64 v1, v[24:25] offset:0
  ds_write_b64 v1, v[26:27] offset:1024
  v_pk_mul_f32 v[8:9], v[12:13], v[12:13]
  v_pk_mul_f32 v[10:11], v[14:15], v[14:15]
  v_pk_add_f32 v[20:21], v[12:13], v[16:17]
  v_pk_fma_f32 v[8:9], v[16:17], v[16:17], v[8:9]
  v_pk_add_f32 v[22:23], v[14:15], v[18:19]
  v_pk_fma_f32 v[10:11], v[18:19], v[18:19], v[10:11]
  v_permlane32_swap_b32 v120, v122
  v_permlane32_swap_b32 v121, v123
  s_nop 1
  v_permlane16_swap_b32 v120, v121
  v_permlane16_swap_b32 v122, v123
  v_and_b32 v120, s48, v120
  v_and_b32 v121, s48, v121
  v_and_b32 v122, s48, v122
  v_and_b32 v123, s48, v123
  v_pk_mul_f32 v[12:13], v[120:121], v[120:121]
  v_pk_mul_f32 v[14:15], v[122:123], v[122:123]
  v_pk_fma_f32 v[12:13], v[12:13], s[62:63], v[6:7]
  v_pk_fma_f32 v[14:15], v[14:15], s[62:63], v[6:7]
  v_pk_mul_f32 v[12:13], v[12:13], v[120:121]
  v_pk_mul_f32 v[14:15], v[14:15], v[122:123]
  v_exp_f32 v12, v12
  v_exp_f32 v13, v13
  v_exp_f32 v14, v14
  v_exp_f32 v15, v15
  v_pk_add_f32 v[12:13], v[12:13], 1.0 op_sel_hi:[1,0]
  v_pk_add_f32 v[14:15], v[14:15], 1.0 op_sel_hi:[1,0]
  v_rcp_f32 v12, v12
  v_rcp_f32 v13, v13
  v_rcp_f32 v14, v14
  v_rcp_f32 v15, v15
  v_pk_mul_f32 v[12:13], v[12:13], v[120:121]
  v_pk_mul_f32 v[14:15], v[14:15], v[122:123]
  v_cvt_pk_bf16_f32 v28, v12, v13
  v_cvt_pk_bf16_f32 v29, v14, v15
  ds_write_b64 v1, v[28:29] offset:2048
  v_pk_add_f32 v[20:21], v[20:21], v[12:13]
  v_pk_fma_f32 v[8:9], v[12:13], v[12:13], v[8:9]
  v_pk_add_f32 v[22:23], v[22:23], v[14:15]
  v_pk_fma_f32 v[10:11], v[14:15], v[14:15], v[10:11]
  v_add_f32_dpp v20, v20, v20 row_ror:8 row_mask:0xf bank_mask:0x3
  v_add_f32_dpp v8, v8, v8 row_ror:8 row_mask:0xf bank_mask:0x3
  v_add_f32_dpp v21, v21, v21 row_ror:8 row_mask:0xf bank_mask:0x3
  v_add_f32_dpp v9, v9, v9 row_ror:8 row_mask:0xf bank_mask:0x3
  v_add_f32_dpp v20, v22, v22 row_ror:8 row_mask:0xf bank_mask:0xc
  v_add_f32_dpp v8, v10, v10 row_ror:8 row_mask:0xf bank_mask:0xc
  v_add_f32_dpp v21, v23, v23 row_ror:8 row_mask:0xf bank_mask:0xc
  v_add_f32_dpp v9, v11, v11 row_ror:8 row_mask:0xf bank_mask:0xc
  v_add_f32_dpp v20, v20, v20 row_half_mirror row_mask:0xf bank_mask:0x5
  v_add_f32_dpp v8, v8, v8 row_half_mirror row_mask:0xf bank_mask:0x5
  v_and_b32 v12, 0xffff, v2
  v_add_f32_dpp v20, v21, v21 row_half_mirror row_mask:0xf bank_mask:0xa
  v_add_f32_dpp v8, v9, v9 row_half_mirror row_mask:0xf bank_mask:0xa
  v_lshrrev_b32 v1, 16, v2
  s_mov_b32 vcc_lo, 0xaaaaaaaa
  s_mov_b32 vcc_hi, 0xaaaaaaaa
  v_add_f32_dpp v20, v20, v20 quad_perm:[1,0,3,2] row_mask:0xf bank_mask:0xf
  v_add_f32_dpp v8, v8, v8 quad_perm:[1,0,3,2] row_mask:0xf bank_mask:0xf
  s_nop 0
  v_add_f32_dpp v20, v20, v20 quad_perm:[2,3,0,1] row_mask:0xf bank_mask:0xf
  v_add_f32_dpp v8, v8, v8 quad_perm:[2,3,0,1] row_mask:0xf bank_mask:0xf
  v_cndmask_b32 v13, v20, v8, vcc
  buffer_store_dword v13, v12, s[20:23], s53 offen sc1
  v_add_u32 v2, s58, v3
  s_lshl_b32 s49, s34, 2
  s_add_u32 s49, s49, s47
  s_add_u32 s49, s49, 65536
  s_waitcnt lgkmcnt(0)
  s_barrier
  s_add_u32 s28, s40, 0x1c00000
  s_addc_u32 s29, s41, 0
  s_mov_b32 s30, 0x118000
  s_mov_b32 s31, 0x00020000
  s_and_b32 s60, s2, 1
  s_lshl_b32 s60, s60, 2
  s_lshr_b32 s61, s2, 6
  s_add_u32 s60, s60, s61
  s_lshl_b32 s60, s60, 3
  s_add_u32 s61, s60, s38
  s_add_u32 s60, s60, s34
  s_mul_i32 s60, s60, 17920
  s_mul_i32 s61, s61, 17920
  s_add_u32 s61, s61, 9216
  s_mul_i32 s42, s38, 6144
  s_add_u32 m0, s42, 139264
  s_cmp_lt_u32 s34, 4
  s_cbranch_scc1 kf_kernel_ro83
  s_and_b32 s43, s34, 3
  s_mul_i32 s43, s43, 4160
  s_add_u32 s43, s43, 102400
  v_lshrrev_b32 v14, 1, v3
  v_add_u32 v14, s43, v14
  v_bfe_u32 v15, v3, 4, 3
  v_mul_u32_u24 v15, 512, v15
  v_add_u32 v15, v14, v15
  ds_write_b64 v14, a[8:9] offset:0
  ds_write_b64 v14, a[24:25] offset:520
  ds_write_b64 v14, a[40:41] offset:1040
  ds_write_b64 v14, a[56:57] offset:1560
  ds_write_b64 v14, a[72:73] offset:2080
  ds_write_b64 v14, a[88:89] offset:2600
  ds_write_b64 v14, a[104:105] offset:3120
  ds_write_b64 v14, a[120:121] offset:3640
  ds_read_b64 a[8:9], v15 offset:0
  ds_read_b64 a[24:25], v15 offset:8
  ds_read_b64 a[40:41], v15 offset:16
  ds_read_b64 a[56:57], v15 offset:24
  ds_read_b64 a[72:73], v15 offset:32
  ds_read_b64 a[88:89], v15 offset:40
  ds_read_b64 a[104:105], v15 offset:48
  ds_read_b64 a[120:121], v15 offset:56
  ds_write_b64 v14, a[10:11] offset:0
  ds_write_b64 v14, a[26:27] offset:520
  ds_write_b64 v14, a[42:43] offset:1040
  ds_write_b64 v14, a[58:59] offset:1560
  ds_write_b64 v14, a[74:75] offset:2080
  ds_write_b64 v14, a[90:91] offset:2600
  ds_write_b64 v14, a[106:107] offset:3120
  ds_write_b64 v14, a[122:123] offset:3640
  ds_read_b64 a[10:11], v15 offset:0
  ds_read_b64 a[26:27], v15 offset:8
  ds_read_b64 a[42:43], v15 offset:16
  ds_read_b64 a[58:59], v15 offset:24
  ds_read_b64 a[74:75], v15 offset:32
  ds_read_b64 a[90:91], v15 offset:40
  ds_read_b64 a[106:107], v15 offset:48
  ds_read_b64 a[122:123], v15 offset:56
  buffer_load_dwordx4 v[112:115], v1, s[20:23], s52 offen offset:0 sc1
  buffer_load_dwordx4 v[116:119], v1, s[20:23], s52 offen offset:1024 sc1
  buffer_load_dwordx4 v[120:123], v1, s[20:23], s52 offen offset:2048 sc1
  buffer_load_dwordx4 v[124:127], v1, s[20:23], s52 offen offset:3072 sc1
  s_setprio 3
  s_mov_b32 s43, 400000
  s_branch kf_kernel_l186
kf_kernel_lp84:
  s_sleep 6
  buffer_load_dwordx4 v[112:115], v1, s[20:23], s52 offen offset:0 sc1
  buffer_load_dwordx4 v[116:119], v1, s[20:23], s52 offen offset:1024 sc1
  buffer_load_dwordx4 v[120:123], v1, s[20:23], s52 offen offset:2048 sc1
  buffer_load_dwordx4 v[124:127], v1, s[20:23], s52 offen offset:3072 sc1
kf_kernel_l186:
  s_waitcnt vmcnt(2)
  v_max3_u32 v24, v112, v113, v114
  v_max3_u32 v25, v115, v116, v117
  v_max3_u32 v24, v24, v118, v119
  v_add_f32 v28, v112, v116
  v_add_f32 v29, v113, v117
  v_add_f32 v30, v114, v118
  v_add_f32 v31, v115, v119
  s_waitcnt vmcnt(0)
  v_max3_u32 v25, v25, v120, v121
  v_max3_u32 v24, v24, v122, v123
  v_max3_u32 v25, v25, v124, v125
  v_max3_u32 v24, v24, v126, v127
  v_max_u32 v24, v24, v25
  v_cmp_eq_u32 vcc, -1, v24
  v_add_f32 v16, v120, v124
  v_add_f32 v17, v121, v125
  v_add_f32 v18, v122, v126
  v_add_f32 v19, v123, v127
  s_cbranch_vccz kf_kernel_ld85
  s_sub_u32 s43, s43, 1
  s_cmp_lg_u32 s43, 0
  s_cbranch_scc1 kf_kernel_lp84
kf_kernel_ld85:
  ds_read_b128 v[120:123], v2 offset:0
  ds_read_b128 v[124:127], v2 offset:1024
  v_add_f32 v28, v28, v16
  v_add_f32 v29, v29, v17
  v_add_f32 v30, v30, v18
  v_add_f32 v31, v31, v19
  v_add_f32_dpp v28, v28, v28 row_ror:4 row_mask:0xf bank_mask:0xf
  v_add_f32_dpp v29, v29, v29 row_ror:4 row_mask:0xf bank_mask:0xf
  v_add_f32_dpp v30, v30, v30 row_ror:4 row_mask:0xf bank_mask:0xf
  v_add_f32_dpp v31, v31, v31 row_ror:4 row_mask:0xf bank_mask:0xf
  v_add_f32_dpp v28, v28, v28 row_ror:8 row_mask:0xf bank_mask:0xf
  v_add_f32_dpp v29, v29, v29 row_ror:8 row_mask:0xf bank_mask:0xf
  v_add_f32_dpp v30, v30, v30 row_ror:8 row_mask:0xf bank_mask:0xf
  v_add_f32_dpp v31, v31, v31 row_ror:8 row_mask:0xf bank_mask:0xf
  v_mul_f32 v28, 0x3a97b426, v28
  v_mul_f32 v29, 0x3a97b426, v29
  v_mul_f32 v30, 0x3a97b426, v30
  v_mul_f32 v31, 0x3a97b426, v31
  v_fma_f32 v29, -v28, v28, v29
  v_fma_f32 v31, -v30, v30, v31
  v_max_f32 v29, 0, v29
  v_max_f32 v31, 0, v31
  v_cvt_pk_bf16_f32 v12, v28, v30
  v_cvt_pk_bf16_f32 v13, v29, v31
  v_lshlrev_b32 v8, 16, v12
  v_and_b32 v9, 0xffff0000, v12
  v_lshlrev_b32 v10, 16, v13
  v_and_b32 v11, 0xffff0000, v13
  v_add_f32 v10, 0x3727c5ac, v10
  v_add_f32 v11, 0x3727c5ac, v11
  v_cvt_pk_bf16_f32 v13, v10, v11
  v_lshlrev_b32 v10, 16, v13
  v_and_b32 v11, 0xffff0000, v13
  v_sqrt_f32 v10, v10
  v_sqrt_f32 v11, v11
  v_mov_b32_dpp v16, v8 quad_perm:[0,0,0,0] row_mask:0xf bank_mask:0xf
  v_mov_b32_dpp v17, v9 quad_perm:[0,0,0,0] row_mask:0xf bank_mask:0xf
  v_mov_b32_dpp v18, v8 quad_perm:[1,1,1,1] row_mask:0xf bank_mask:0xf
  v_mov_b32_dpp v19, v9 quad_perm:[1,1,1,1] row_mask:0xf bank_mask:0xf
  v_mov_b32_dpp v20, v8 quad_perm:[2,2,2,2] row_mask:0xf bank_mask:0xf
  v_mov_b32_dpp v21, v9 quad_perm:[2,2,2,2] row_mask:0xf bank_mask:0xf
  v_mov_b32_dpp v22, v8 quad_perm:[3,3,3,3] row_mask:0xf bank_mask:0xf
  v_mov_b32_dpp v23, v9 quad_perm:[3,3,3,3] row_mask:0xf bank_mask:0xf
  v_cvt_pk_bf16_f32 v13, v10, v11
  v_lshlrev_b32 v10, 16, v13
  v_and_b32 v11, 0xffff0000, v13
  v_rcp_f32 v10, v10
  v_rcp_f32 v11, v11
  s_waitcnt lgkmcnt(1)
  v_lshlrev_b32 v112, 16, v120
  v_and_b32 v113, 0xffff0000, v120
  v_lshlrev_b32 v114, 16, v121
  v_and_b32 v115, 0xffff0000, v121
  v_lshlrev_b32 v116, 16, v122
  v_and_b32 v117, 0xffff0000, v122
  v_lshlrev_b32 v118, 16, v123
  v_and_b32 v119, 0xffff0000, v123
  v_pk_add_f32 v[112:113], v[112:113], v[16:17] neg_lo:[0,1] neg_hi:[0,1]
  v_pk_add_f32 v[114:115], v[114:115], v[18:19] neg_lo:[0,1] neg_hi:[0,1]
  v_pk_add_f32 v[116:117], v[116:117], v[20:21] neg_lo:[0,1] neg_hi:[0,1]
  v_pk_add_f32 v[118:119], v[118:119], v[22:23] neg_lo:[0,1] neg_hi:[0,1]
  v_mov_b32_dpp v24, v10 quad_perm:[0,0,0,0] row_mask:0xf bank_mask:0xf
  v_mov_b32_dpp v25, v11 quad_perm:[0,0,0,0] row_mask:0xf bank_mask:0xf
  v_mov_b32_dpp v26, v10 quad_perm:[1,1,1,1] row_mask:0xf bank_mask:0xf
  v_mov_b32_dpp v27, v11 quad_perm:[1,1,1,1] row_mask:0xf bank_mask:0xf
  v_mov_b32_dpp v28, v10 quad_perm:[2,2,2,2] row_mask:0xf bank_mask:0xf
  v_mov_b32_dpp v29, v11 quad_perm:[2,2,2,2] row_mask:0xf bank_mask:0xf
  v_mov_b32_dpp v30, v10 quad_perm:[3,3,3,3] row_mask:0xf bank_mask:0xf
  v_mov_b32_dpp v31, v11 quad_perm:[3,3,3,3] row_mask:0xf bank_mask:0xf
  v_pk_mul_f32 v[112:113], v[112:113], v[24:25]
  v_pk_mul_f32 v[114:115], v[114:115], v[26:27]
  v_pk_mul_f32 v[116:117], v[116:117], v[28:29]
  v_pk_mul_f32 v[118:119], v[118:119], v[30:31]
  v_cvt_pk_bf16_f32 v120, v112, v113
  v_cvt_pk_bf16_f32 v121, v114, v115
  v_cvt_pk_bf16_f32 v122, v116, v117
  v_cvt_pk_bf16_f32 v123, v118, v119
  buffer_store_dwordx4 v[120:123], v3, s[16:19], s54 offen sc1
  s_waitcnt lgkmcnt(0)
  v_lshlrev_b32 v112, 16, v124
  v_and_b32 v113, 0xffff0000, v124
  v_lshlrev_b32 v114, 16, v125
  v_and_b32 v115, 0xffff0000, v125
  v_lshlrev_b32 v116, 16, v126
  v_and_b32 v117, 0xffff0000, v126
  v_lshlrev_b32 v118, 16, v127
  v_and_b32 v119, 0xffff0000, v127
  v_pk_add_f32 v[112:113], v[112:113], v[16:17] neg_lo:[0,1] neg_hi:[0,1]
  v_pk_add_f32 v[114:115], v[114:115], v[18:19] neg_lo:[0,1] neg_hi:[0,1]
  v_pk_add_f32 v[116:117], v[116:117], v[20:21] neg_lo:[0,1] neg_hi:[0,1]
  v_pk_add_f32 v[118:119], v[118:119], v[22:23] neg_lo:[0,1] neg_hi:[0,1]
  v_pk_mul_f32 v[112:113], v[112:113], v[24:25]
  v_pk_mul_f32 v[114:115], v[114:115], v[26:27]
  v_pk_mul_f32 v[116:117], v[116:117], v[28:29]
  v_pk_mul_f32 v[118:119], v[118:119], v[30:31]
  v_cvt_pk_bf16_f32 v124, v112, v113
  v_cvt_pk_bf16_f32 v125, v114, v115
  v_cvt_pk_bf16_f32 v126, v116, v117
  v_cvt_pk_bf16_f32 v127, v118, v119
  buffer_store_dwordx4 v[124:127], v3, s[16:19], s56 offen sc1
  s_setprio 1
kf_kernel_ro83:
  ds_read_b128 v[16:19], v3 offset:20480
  ds_read_b128 v[24:27], v3 offset:21504
  ds_read_b128 v[28:31], v3 offset:22528
  ds_read_b128 v[8:11], v3 offset:23552
  ds_read_b128 v[20:23], v3 offset:24576
  ds_read_b128 v[12:15], v3 offset:25600
  s_waitcnt lgkmcnt(5)
  v_mfma_f32_16x16x32_bf16 v[112:115], v[16:19], v[32:35], 0
  s_waitcnt lgkmcnt(4)
  v_mfma_f32_16x16x32_bf16 v[116:119], v[24:27], v[32:35], 0
  ds_read_b128 v[16:19], v3 offset:26624
  s_waitcnt lgkmcnt(4)
  v_mfma_f32_16x16x32_bf16 v[120:123], v[28:31], v[32:35], 0
  ds_read_b128 v[24:27], v3 offset:27648
  s_waitcnt lgkmcnt(4)
  v_mfma_f32_16x16x32_bf16 v[124:127], v[8:11], v[32:35], 0
  ds_read_b128 v[28:31], v3 offset:28672
  s_waitcnt lgkmcnt(4)
  v_mfma_f32_16x16x32_bf16 v[112:115], v[20:23], v[36:39], v[112:115]
  ds_read_b128 v[8:11], v3 offset:29696
  s_waitcnt lgkmcnt(4)
  v_mfma_f32_16x16x32_bf16 v[116:119], v[12:15], v[36:39], v[116:119]
  ds_read_b128 v[20:23], v3 offset:30720
  s_waitcnt lgkmcnt(4)
  v_mfma_f32_16x16x32_bf16 v[120:123], v[16:19], v[36:39], v[120:123]
  ds_read_b128 v[12:15], v3 offset:31744
  s_waitcnt lgkmcnt(4)
  v_mfma_f32_16x16x32_bf16 v[124:127], v[24:27], v[36:39], v[124:127]
  ds_read_b128 v[16:19], v3 offset:32768
  s_waitcnt lgkmcnt(4)
  v_mfma_f32_16x16x32_bf16 v[112:115], v[28:31], v[40:43], v[112:115]
  ds_read_b128 v[24:27], v3 offset:33792
  s_waitcnt lgkmcnt(4)
  v_mfma_f32_16x16x32_bf16 v[116:119], v[8:11], v[40:43], v[116:119]
  ds_read_b128 v[28:31], v3 offset:34816
  s_waitcnt lgkmcnt(4)
  v_mfma_f32_16x16x32_bf16 v[120:123], v[20:23], v[40:43], v[120:123]
  ds_read_b128 v[8:11], v3 offset:35840
  s_waitcnt lgkmcnt(4)
  v_mfma_f32_16x16x32_bf16 v[124:127], v[12:15], v[40:43], v[124:127]
  ds_read_b128 v[20:23], v3 offset:36864
  s_waitcnt lgkmcnt(4)
  v_mfma_f32_16x16x32_bf16 v[112:115], v[16:19], v[44:47], v[112:115]
  ds_read_b128 v[12:15], v3 offset:37888
  s_waitcnt lgkmcnt(4)
  v_mfma_f32_16x16x32_bf16 v[116:119], v[24:27], v[44:47], v[116:119]
  ds_read_b128 v[16:19], v3 offset:38912
  s_waitcnt lgkmcnt(4)
  v_mfma_f32_16x16x32_bf16 v[120:123], v[28:31], v[44:47], v[120:123]
  ds_read_b128 v[24:27], v3 offset:39936
  s_waitcnt lgkmcnt(4)
  v_mfma_f32_16x16x32_bf16 v[124:127], v[8:11], v[44:47], v[124:127]
  ds_read_b128 v[28:31], v3 offset:40960
  s_waitcnt lgkmcnt(4)
  v_mfma_f32_16x16x32_bf16 v[112:115], v[20:23], v[48:51], v[112:115]
  ds_read_b128 v[8:11], v3 offset:41984
  s_waitcnt lgkmcnt(4)
  v_mfma_f32_16x16x32_bf16 v[116:119], v[12:15], v[48:51], v[116:119]
  ds_read_b128 v[20:23], v3 offset:43008
  s_waitcnt lgkmcnt(4)
  v_mfma_f32_16x16x32_bf16 v[120:123], v[16:19], v[48:51], v[120:123]
  ds_read_b128 v[12:15], v3 offset:44032
  s_waitcnt lgkmcnt(4)
  v_mfma_f32_16x16x32_bf16 v[124:127], v[24:27], v[48:51], v[124:127]
  ds_read_b128 v[16:19], v3 offset:45056
  s_waitcnt lgkmcnt(4)
  v_mfma_f32_16x16x32_bf16 v[112:115], v[28:31], v[52:55], v[112:115]
  ds_read_b128 v[24:27], v3 offset:46080
  s_waitcnt lgkmcnt(4)
  v_mfma_f32_16x16x32_bf16 v[116:119], v[8:11], v[52:55], v[116:119]
  ds_read_b128 v[28:31], v3 offset:47104
  s_waitcnt lgkmcnt(4)
  v_mfma_f32_16x16x32_bf16 v[120:123], v[20:23], v[52:55], v[120:123]
  ds_read_b128 v[8:11], v3 offset:48128
  s_waitcnt lgkmcnt(4)
  v_mfma_f32_16x16x32_bf16 v[124:127], v[12:15], v[52:55], v[124:127]
  ds_read_b128 v[20:23], v3 offset:49152
  s_waitcnt lgkmcnt(4)
  v_mfma_f32_16x16x32_bf16 v[112:115], v[16:19], v[56:59], v[112:115]
  ds_read_b128 v[12:15], v3 offset:50176
  s_waitcnt lgkmcnt(4)
  v_mfma_f32_16x16x32_bf16 v[116:119], v[24:27], v[56:59], v[116:119]
  ds_read_b128 v[16:19], v3 offset:51200
  s_waitcnt lgkmcnt(4)
  v_mfma_f32_16x16x32_bf16 v[120:123], v[28:31], v[56:59], v[120:123]
  ds_read_b128 v[24:27], v3 offset:52224
  s_waitcnt lgkmcnt(4)
  v_mfma_f32_16x16x32_bf16 v[124:127], v[8:11], v[56:59], v[124:127]
  ds_read_b128 v[28:31], v3 offset:53248
  s_waitcnt lgkmcnt(4)
  v_mfma_f32_16x16x32_bf16 v[112:115], v[20:23], v[60:63], v[112:115]
  ds_read_b128 v[8:11], v3 offset:54272
  s_waitcnt lgkmcnt(4)
  v_mfma_f32_16x16x32_bf16 v[116:119], v[12:15], v[60:63], v[116:119]
  ds_read_b128 v[20:23], v3 offset:55296
  s_waitcnt lgkmcnt(4)
  v_mfma_f32_16x16x32_bf16 v[120:123], v[16:19], v[60:63], v[120:123]
  ds_read_b128 v[12:15], v3 offset:56320
  s_waitcnt lgkmcnt(4)
  v_mfma_f32_16x16x32_bf16 v[124:127], v[24:27], v[60:63], v[124:127]
  ds_read_b128 v[16:19], v4 offset:0
  s_waitcnt lgkmcnt(4)
  v_mfma_f32_16x16x32_bf16 v[112:115], v[28:31], v[64:67], v[112:115]
  ds_read_b128 v[24:27], v4 offset:1024
  ds_read_b128 v[60:63], v4 offset:2048
  s_waitcnt lgkmcnt(5)
  v_mfma_f32_16x16x32_bf16 v[116:119], v[8:11], v[64:67], v[116:119]
  ds_read_b128 v[28:31], v4 offset:3072
  s_waitcnt lgkmcnt(5)
  v_mfma_f32_16x16x32_bf16 v[120:123], v[20:23], v[64:67], v[120:123]
  ds_read_b128 v[8:11], v4 offset:4096
  s_waitcnt lgkmcnt(5)
  v_mfma_f32_16x16x32_bf16 v[124:127], v[12:15], v[64:67], v[124:127]
  ds_read_b128 v[20:23], v4 offset:5120
  s_waitcnt lgkmcnt(5)
  v_mfma_f32_16x16x32_bf16 v[112:115], v[16:19], v[68:71], v[112:115]
  ds_read_b128 v[12:15], v4 offset:6144
  s_cmp_lt_u32 s34, 4
  s_cbranch_scc1 kf_kernel_ro87
  s_waitcnt vmcnt(0)
kf_kernel_ro87:
  v_mov_b32 v56, 20000
  v_mov_b32 v57, s46
  s_mov_b64 exec, 1
  ds_add_rtn_u32 v57, v56, v57
  s_mov_b64 exec, -1
  s_waitcnt lgkmcnt(6)
  v_mfma_f32_16x16x32_bf16 v[116:119], v[24:27], v[68:71], v[116:119]
  ds_read_b128 v[64:67], v4 offset:7168
  s_waitcnt lgkmcnt(6)
  v_mfma_f32_16x16x32_bf16 v[120:123], v[60:63], v[68:71], v[120:123]
  ds_read_b128 v[16:19], v4 offset:8192
  s_waitcnt lgkmcnt(6)
  v_mfma_f32_16x16x32_bf16 v[124:127], v[28:31], v[68:71], v[124:127]
  ds_read_b128 v[24:27], v4 offset:9216
  s_waitcnt lgkmcnt(6)
  v_mfma_f32_16x16x32_bf16 v[112:115], v[8:11], v[72:75], v[112:115]
  ds_read_b128 v[60:63], v4 offset:10240
  s_waitcnt lgkmcnt(6)
  v_mfma_f32_16x16x32_bf16 v[116:119], v[20:23], v[72:75], v[116:119]
  ds_read_b128 v[28:31], v4 offset:11264
  s_waitcnt lgkmcnt(6)
  v_mfma_f32_16x16x32_bf16 v[120:123], v[12:15], v[72:75], v[120:123]
  ds_read_b128 v[68:71], v4 offset:12288
  s_waitcnt lgkmcnt(6)
  s_cmp_lt_u32 s34, 4
  s_cbranch_scc1 kf_kernel_ro88
  v_readfirstlane_b32 s42, v57
  s_cmp_lg_u32 s42, 7
  s_cbranch_scc1 kf_kernel_nf89
  s_mov_b64 exec, 1
  v_mov_b32 v0, 1
  buffer_store_dword v0, off, s[68:71], s47 sc1
  s_mov_b64 exec, -1
kf_kernel_nf89:
  buffer_load_dwordx4 v[40:43], v3, s[28:31], s60 offen offset:0
  buffer_load_dwordx4 v[44:47], v3, s[28:31], s60 offen offset:1024
  buffer_load_dwordx4 v[48:51], v3, s[28:31], s60 offen offset:2048
  buffer_load_dwordx4 v[52:55], v3, s[28:31], s60 offen offset:3072
  buffer_load_dwordx4 v3, s[28:31], s61 offen offset:0 lds
  buffer_load_dwordx4 v3, s[28:31], s61 offen offset:1024 lds
  buffer_load_dwordx4 v3, s[28:31], s61 offen offset:2048 lds
  buffer_load_dwordx4 v3, s[28:31], s61 offen offset:3072 lds
  s_add_u32 m0, m0, 4096
  s_add_u32 s61, s61, 4096
  buffer_load_dwordx4 v3, s[28:31], s61 offen offset:0 lds
  buffer_load_dwordx4 v3, s[28:31], s61 offen offset:1024 lds
kf_kernel_ro88:
  s_waitcnt lgkmcnt(5)
  v_mfma_f32_16x16x32_bf16 v[124:127], v[64:67], v[72:75], v[124:127]
  ds_read_b128 v[8:11], v4 offset:13312
  s_waitcnt lgkmcnt(5)
  v_mfma_f32_16x16x32_bf16 v[112:115], v[16:19], v[76:79], v[112:115]
  ds_read_b128 v[20:23], v4 offset:14336
  s_waitcnt lgkmcnt(5)
  v_mfma_f32_16x16x32_bf16 v[116:119], v[24:27], v[76:79], v[116:119]
  ds_read_b128 v[12:15], v4 offset:15360
  s_waitcnt lgkmcnt(5)
  v_mfma_f32_16x16x32_bf16 v[120:123], v[60:63], v[76:79], v[120:123]
  ds_read_b128 v[64:67], v4 offset:16384
  s_waitcnt lgkmcnt(5)
  v_mfma_f32_16x16x32_bf16 v[124:127], v[28:31], v[76:79], v[124:127]
  ds_read_b128 v[72:75], v4 offset:17408
  s_waitcnt lgkmcnt(5)
  v_mfma_f32_16x16x32_bf16 v[112:115], v[68:71], v[80:83], v[112:115]
  ds_read_b128 v[16:19], v4 offset:18432
  s_waitcnt lgkmcnt(5)
  v_mfma_f32_16x16x32_bf16 v[116:119], v[8:11], v[80:83], v[116:119]
  ds_read_b128 v[24:27], v4 offset:19456
  s_waitcnt lgkmcnt(5)
  v_mfma_f32_16x16x32_bf16 v[120:123], v[20:23], v[80:83], v[120:123]
  ds_read_b128 v[60:63], v4 offset:20480
  s_waitcnt lgkmcnt(5)
  v_mfma_f32_16x16x32_bf16 v[124:127], v[12:15], v[80:83], v[124:127]
  ds_read_b128 v[28:31], v4 offset:21504
  s_waitcnt lgkmcnt(5)
  v_mfma_f32_16x16x32_bf16 v[112:115], v[64:67], v[84:87], v[112:115]
  ds_read_b128 v[76:79], v4 offset:22528
  s_waitcnt lgkmcnt(5)
  v_mfma_f32_16x16x32_bf16 v[116:119], v[72:75], v[84:87], v[116:119]
  ds_read_b128 v[68:71], v4 offset:23552
  s_waitcnt lgkmcnt(5)
  v_mfma_f32_16x16x32_bf16 v[120:123], v[16:19], v[84:87], v[120:123]
  ds_read_b128 v[8:11], v4 offset:24576
  s_waitcnt lgkmcnt(5)
  v_mfma_f32_16x16x32_bf16 v[124:127], v[24:27], v[84:87], v[124:127]
  ds_read_b128 v[20:23], v4 offset:25600
  s_waitcnt lgkmcnt(5)
  v_mfma_f32_16x16x32_bf16 v[112:115], v[60:63], v[88:91], v[112:115]
  ds_read_b128 v[12:15], v4 offset:26624
  s_waitcnt lgkmcnt(5)
  v_mfma_f32_16x16x32_bf16 v[116:119], v[28:31], v[88:91], v[116:119]
  ds_read_b128 v[80:83], v4 offset:27648
  s_waitcnt lgkmcnt(5)
  v_mfma_f32_16x16x32_bf16 v[120:123], v[76:79], v[88:91], v[120:123]
  ds_read_b128 v[64:67], v4 offset:28672
  s_waitcnt lgkmcnt(5)
  v_mfma_f32_16x16x32_bf16 v[124:127], v[68:71], v[88:91], v[124:127]
  ds_read_b128 v[72:75], v4 offset:29696
  s_waitcnt lgkmcnt(5)
  v_mfma_f32_16x16x32_bf16 v[112:115], v[8:11], v[92:95], v[112:115]
  ds_read_b128 v[16:19], v4 offset:30720
  s_waitcnt lgkmcnt(5)
  v_mfma_f32_16x16x32_bf16 v[116:119], v[20:23], v[92:95], v[116:119]
  ds_read_b128 v[24:27], v4 offset:31744
  s_waitcnt lgkmcnt(5)
  v_mfma_f32_16x16x32_bf16 v[120:123], v[12:15], v[92:95], v[120:123]
  ds_read_b128 v[84:87], v4 offset:32768
  s_waitcnt lgkmcnt(5)
  v_mfma_f32_16x16x32_bf16 v[124:127], v[80:83], v[92:95], v[124:127]
  ds_read_b128 v[60:63], v4 offset:33792
  s_waitcnt lgkmcnt(5)
  v_mfma_f32_16x16x32_bf16 v[112:115], v[64:67], v[96:99], v[112:115]
  ds_read_b128 v[28:31], v4 offset:34816
  s_waitcnt lgkmcnt(5)
  v_mfma_f32_16x16x32_bf16 v[116:119], v[72:75], v[96:99], v[116:119]
  ds_read_b128 v[76:79], v4 offset:35840
  s_waitcnt lgkmcnt(5)
  v_mfma_f32_16x16x32_bf16 v[120:123], v[16:19], v[96:99], v[120:123]
  ds_read_b128 v[68:71], v4 offset:36864
  s_waitcnt lgkmcnt(5)
  v_mfma_f32_16x16x32_bf16 v[124:127], v[24:27], v[96:99], v[124:127]
  ds_read_b128 v[88:91], v4 offset:37888
  s_waitcnt lgkmcnt(5)
  v_mfma_f32_16x16x32_bf16 v[112:115], v[84:87], v[100:103], v[112:115]
  ds_read_b128 v[8:11], v4 offset:38912
  s_waitcnt lgkmcnt(5)
  v_mfma_f32_16x16x32_bf16 v[116:119], v[60:63], v[100:103], v[116:119]
  ds_read_b128 v[20:23], v4 offset:39936
  s_waitcnt lgkmcnt(5)
  v_mfma_f32_16x16x32_bf16 v[120:123], v[28:31], v[100:103], v[120:123]
  ds_read_b128 v[12:15], v4 offset:40960
  s_waitcnt lgkmcnt(5)
  v_mfma_f32_16x16x32_bf16 v[124:127], v[76:79], v[100:103], v[124:127]
  ds_read_b128 v[80:83], v4 offset:41984
  s_cmp_lt_u32 s34, 4
  s_cbranch_scc0 kf_kernel_ro90
  buffer_load_dwordx4 v[32:35], v1, s[20:23], s52 offen offset:0 sc1
  buffer_load_dwordx4 v[36:39], v1, s[20:23], s52 offen offset:1024 sc1
  buffer_load_dwordx4 v[40:43], v1, s[20:23], s52 offen offset:2048 sc1
  buffer_load_dwordx4 v[44:47], v1, s[20:23], s52 offen offset:3072 sc1
kf_kernel_ro90:
  s_cmp_lt_u32 s34, 4
  s_cbranch_scc0 kf_kernel_ro91
  ds_read_b128 v[48:51], v2 offset:0
  ds_read_b128 v[52:55], v2 offset:1024
kf_kernel_ro91:
  s_waitcnt lgkmcnt(5)
  v_mfma_f32_16x16x32_bf16 v[112:115], v[68:71], v[104:107], v[112:115]
  ds_read_b128 v[92:95], v4 offset:43008
  s_waitcnt lgkmcnt(5)
  v_mfma_f32_16x16x32_bf16 v[116:119], v[88:91], v[104:107], v[116:119]
  ds_read_b128 v[64:67], v4 offset:44032
  s_waitcnt lgkmcnt(5)
  v_mfma_f32_16x16x32_bf16 v[120:123], v[8:11], v[104:107], v[120:123]
  s_waitcnt lgkmcnt(4)
  v_mfma_f32_16x16x32_bf16 v[124:127], v[20:23], v[104:107], v[124:127]
  s_waitcnt lgkmcnt(3)
  v_mfma_f32_16x16x32_bf16 v[112:115], v[12:15], v[108:111], v[112:115]
  s_waitcnt lgkmcnt(2)
  v_mfma_f32_16x16x32_bf16 v[116:119], v[80:83], v[108:111], v[116:119]
  s_waitcnt lgkmcnt(1)
  v_mfma_f32_16x16x32_bf16 v[120:123], v[92:95], v[108:111], v[120:123]
  s_waitcnt lgkmcnt(0)
  v_mfma_f32_16x16x32_bf16 v[124:127], v[64:67], v[108:111], v[124:127]
  s_setprio 3
  s_cmp_lt_u32 s34, 4
  s_cbranch_scc0 kf_kernel_ro92
  s_mov_b32 s43, 400000
  s_waitcnt lgkmcnt(0)
  v_lshlrev_b32 v56, 16, v48
  v_and_b32 v57, 0xffff0000, v48
  v_lshlrev_b32 v58, 16, v49
  v_and_b32 v59, 0xffff0000, v49
  v_lshlrev_b32 v60, 16, v50
  v_and_b32 v61, 0xffff0000, v50
  v_lshlrev_b32 v62, 16, v51
  v_and_b32 v63, 0xffff0000, v51
  v_lshlrev_b32 v64, 16, v52
  v_and_b32 v65, 0xffff0000, v52
  v_lshlrev_b32 v66, 16, v53
  v_and_b32 v67, 0xffff0000, v53
  v_lshlrev_b32 v68, 16, v54
  v_and_b32 v69, 0xffff0000, v54
  v_lshlrev_b32 v70, 16, v55
  v_and_b32 v71, 0xffff0000, v55
  s_branch kf_kernel_l195
kf_kernel_lp93:
  s_sleep 6
  buffer_load_dwordx4 v[32:35], v1, s[20:23], s52 offen offset:0 sc1
  buffer_load_dwordx4 v[36:39], v1, s[20:23], s52 offen offset:1024 sc1
  buffer_load_dwordx4 v[40:43], v1, s[20:23], s52 offen offset:2048 sc1
  buffer_load_dwordx4 v[44:47], v1, s[20:23], s52 offen offset:3072 sc1
kf_kernel_l195:
  s_waitcnt vmcnt(2)
  v_max3_u32 v24, v32, v33, v34
  v_max3_u32 v25, v35, v36, v37
  v_max3_u32 v24, v24, v38, v39
  v_add_f32 v28, v32, v36
  v_add_f32 v29, v33, v37
  v_add_f32 v30, v34, v38
  v_add_f32 v31, v35, v39
  s_waitcnt vmcnt(0)
  v_max3_u32 v25, v25, v40, v41
  v_max3_u32 v24, v24, v42, v43
  v_max3_u32 v25, v25, v44, v45
  v_max3_u32 v24, v24, v46, v47
  v_max_u32 v24, v24, v25
  v_cmp_eq_u32 vcc, -1, v24
  v_add_f32 v16, v40, v44
  v_add_f32 v17, v41, v45
  v_add_f32 v18, v42, v46
  v_add_f32 v19, v43, v47
  s_cbranch_vccz kf_kernel_ld94
  s_sub_u32 s43, s43, 1
  s_cmp_lg_u32 s43, 0
  s_cbranch_scc1 kf_kernel_lp93
kf_kernel_ld94:
  v_add_f32 v28, v28, v16
  v_add_f32 v29, v29, v17
  v_add_f32 v30, v30, v18
  v_add_f32 v31, v31, v19
  v_add_f32_dpp v28, v28, v28 row_ror:4 row_mask:0xf bank_mask:0xf
  v_add_f32_dpp v29, v29, v29 row_ror:4 row_mask:0xf bank_mask:0xf
  v_add_f32_dpp v30, v30, v30 row_ror:4 row_mask:0xf bank_mask:0xf
  v_add_f32_dpp v31, v31, v31 row_ror:4 row_mask:0xf bank_mask:0xf
  v_add_f32_dpp v28, v28, v28 row_ror:8 row_mask:0xf bank_mask:0xf
  v_add_f32_dpp v29, v29, v29 row_ror:8 row_mask:0xf bank_mask:0xf
  v_add_f32_dpp v30, v30, v30 row_ror:8 row_mask:0xf bank_mask:0xf
  v_add_f32_dpp v31, v31, v31 row_ror:8 row_mask:0xf bank_mask:0xf
  v_mul_f32 v28, 0x3a97b426, v28
  v_mul_f32 v29, 0x3a97b426, v29
  v_mul_f32 v30, 0x3a97b426, v30
  v_mul_f32 v31, 0x3a97b426, v31
  v_fma_f32 v29, -v28, v28, v29
  v_fma_f32 v31, -v30, v30, v31
  v_max_f32 v29, 0, v29
  v_max_f32 v31, 0, v31
  v_cvt_pk_bf16_f32 v12, v28, v30
  v_cvt_pk_bf16_f32 v13, v29, v31
  v_lshlrev_b32 v8, 16, v12
  v_and_b32 v9, 0xffff0000, v12
  v_lshlrev_b32 v10, 16, v13
  v_and_b32 v11, 0xffff0000, v13
  v_add_f32 v10, 0x3727c5ac, v10
  v_add_f32 v11, 0x3727c5ac, v11
  v_cvt_pk_bf16_f32 v13, v10, v11
  v_lshlrev_b32 v10, 16, v13
  v_and_b32 v11, 0xffff0000, v13
  v_sqrt_f32 v10, v10
  v_sqrt_f32 v11, v11
  v_mov_b32_dpp v16, v8 quad_perm:[0,0,0,0] row_mask:0xf bank_mask:0xf
  v_mov_b32_dpp v17, v9 quad_perm:[0,0,0,0] row_mask:0xf bank_mask:0xf
  v_mov_b32_dpp v18, v8 quad_perm:[1,1,1,1] row_mask:0xf bank_mask:0xf
  v_mov_b32_dpp v19, v9 quad_perm:[1,1,1,1] row_mask:0xf bank_mask:0xf
  v_mov_b32_dpp v20, v8 quad_perm:[2,2,2,2] row_mask:0xf bank_mask:0xf
  v_mov_b32_dpp v21, v9 quad_perm:[2,2,2,2] row_mask:0xf bank_mask:0xf
  v_mov_b32_dpp v22, v8 quad_perm:[3,3,3,3] row_mask:0xf bank_mask:0xf
  v_mov_b32_dpp v23, v9 quad_perm:[3,3,3,3] row_mask:0xf bank_mask:0xf
  v_cvt_pk_bf16_f32 v13, v10, v11
  v_lshlrev_b32 v10, 16, v13
  v_and_b32 v11, 0xffff0000, v13
  v_rcp_f32 v10, v10
  v_rcp_f32 v11, v11
  v_pk_add_f32 v[56:57], v[56:57], v[16:17] neg_lo:[0,1] neg_hi:[0,1]
  v_pk_add_f32 v[58:59], v[58:59], v[18:19] neg_lo:[0,1] neg_hi:[0,1]
  v_pk_add_f32 v[60:61], v[60:61], v[20:21] neg_lo:[0,1] neg_hi:[0,1]
  v_pk_add_f32 v[62:63], v[62:63], v[22:23] neg_lo:[0,1] neg_hi:[0,1]
  v_mov_b32_dpp v24, v10 quad_perm:[0,0,0,0] row_mask:0xf bank_mask:0xf
  v_mov_b32_dpp v25, v11 quad_perm:[0,0,0,0] row_mask:0xf bank_mask:0xf
  v_mov_b32_dpp v26, v10 quad_perm:[1,1,1,1] row_mask:0xf bank_mask:0xf
  v_mov_b32_dpp v27, v11 quad_perm:[1,1,1,1] row_mask:0xf bank_mask:0xf
  v_mov_b32_dpp v28, v10 quad_perm:[2,2,2,2] row_mask:0xf bank_mask:0xf
  v_mov_b32_dpp v29, v11 quad_perm:[2,2,2,2] row_mask:0xf bank_mask:0xf
  v_mov_b32_dpp v30, v10 quad_perm:[3,3,3,3] row_mask:0xf bank_mask:0xf
  v_mov_b32_dpp v31, v11 quad_perm:[3,3,3,3] row_mask:0xf bank_mask:0xf
  v_pk_mul_f32 v[56:57], v[56:57], v[24:25]
  v_pk_mul_f32 v[58:59], v[58:59], v[26:27]
  v_pk_mul_f32 v[60:61], v[60:61], v[28:29]
  v_pk_mul_f32 v[62:63], v[62:63], v[30:31]
  v_cvt_pk_bf16_f32 v48, v56, v57
  v_cvt_pk_bf16_f32 v49, v58, v59
  v_cvt_pk_bf16_f32 v50, v60, v61
  v_cvt_pk_bf16_f32 v51, v62, v63
  buffer_store_dwordx4 v[48:51], v3, s[16:19], s54 offen sc1
  v_pk_add_f32 v[64:65], v[64:65], v[16:17] neg_lo:[0,1] neg_hi:[0,1]
  v_pk_add_f32 v[66:67], v[66:67], v[18:19] neg_lo:[0,1] neg_hi:[0,1]
  v_pk_add_f32 v[68:69], v[68:69], v[20:21] neg_lo:[0,1] neg_hi:[0,1]
  v_pk_add_f32 v[70:71], v[70:71], v[22:23] neg_lo:[0,1] neg_hi:[0,1]
  v_pk_mul_f32 v[64:65], v[64:65], v[24:25]
  v_pk_mul_f32 v[66:67], v[66:67], v[26:27]
  v_pk_mul_f32 v[68:69], v[68:69], v[28:29]
  v_pk_mul_f32 v[70:71], v[70:71], v[30:31]
  v_cvt_pk_bf16_f32 v52, v64, v65
  v_cvt_pk_bf16_f32 v53, v66, v67
  v_cvt_pk_bf16_f32 v54, v68, v69
  v_cvt_pk_bf16_f32 v55, v70, v71
  buffer_store_dwordx4 v[52:55], v3, s[16:19], s56 offen sc1
kf_kernel_ro92:
  s_setprio 2
  v_lshrrev_b32 v1, 1, v3
  v_pk_mul_f32 v[80:81], v[112:113], v[112:113]
  v_pk_mul_f32 v[82:83], v[114:115], v[114:115]
  v_pk_mul_f32 v[84:85], v[116:117], v[116:117]
  v_pk_mul_f32 v[86:87], v[118:119], v[118:119]
  v_pk_fma_f32 v[80:81], v[80:81], s[62:63], v[6:7]
  v_pk_fma_f32 v[82:83], v[82:83], s[62:63], v[6:7]
  v_pk_fma_f32 v[84:85], v[84:85], s[62:63], v[6:7]
  v_pk_fma_f32 v[86:87], v[86:87], s[62:63], v[6:7]
  v_pk_mul_f32 v[80:81], v[80:81], v[112:113]
  v_pk_mul_f32 v[82:83], v[82:83], v[114:115]
  v_pk_mul_f32 v[84:85], v[84:85], v[116:117]
  v_pk_mul_f32 v[86:87], v[86:87], v[118:119]
  v_exp_f32 v80, v80
  v_exp_f32 v81, v81
  v_exp_f32 v82, v82
  v_exp_f32 v83, v83
  v_exp_f32 v84, v84
  v_exp_f32 v85, v85
  v_exp_f32 v86, v86
  v_exp_f32 v87, v87
  v_pk_add_f32 v[80:81], v[80:81], 1.0 op_sel_hi:[1,0]
  v_pk_add_f32 v[82:83], v[82:83], 1.0 op_sel_hi:[1,0]
  v_pk_add_f32 v[84:85], v[84:85], 1.0 op_sel_hi:[1,0]
  v_pk_add_f32 v[86:87], v[86:87], 1.0 op_sel_hi:[1,0]
  v_rcp_f32 v80, v80
  v_rcp_f32 v81, v81
  v_rcp_f32 v82, v82
  v_rcp_f32 v83, v83
  v_rcp_f32 v84, v84
  v_rcp_f32 v85, v85
  v_rcp_f32 v86, v86
  v_rcp_f32 v87, v87
  v_pk_mul_f32 v[80:81], v[80:81], v[112:113]
  v_pk_mul_f32 v[82:83], v[82:83], v[114:115]
  v_pk_mul_f32 v[84:85], v[84:85], v[116:117]
  v_pk_mul_f32 v[86:87], v[86:87], v[118:119]
  v_cvt_pk_bf16_f32 v72, v80, v81
  v_cvt_pk_bf16_f32 v73, v82, v83
  v_cvt_pk_bf16_f32 v74, v84, v85
  v_cvt_pk_bf16_f32 v75, v86, v87
  s_cmp_lt_u32 s34, 4
  s_cbranch_scc0 kf_kernel_ro96
  s_waitcnt vmcnt(0)
  v_mov_b32 v56, 20000
  v_mov_b32 v57, 1
  s_mov_b64 exec, 1
  ds_add_rtn_u32 v57, v56, v57
  s_mov_b64 exec, -1
  s_waitcnt lgkmcnt(0)
  v_readfirstlane_b32 s42, v57
  s_cmp_lg_u32 s42, 7
  s_cbranch_scc1 kf_kernel_nf97
  s_mov_b64 exec, 1
  v_mov_b32 v0, 1
  buffer_store_dword v0, off, s[68:71], s47 sc1
  s_mov_b64 exec, -1
kf_kernel_nf97:
  buffer_load_dwordx4 v[40:43], v3, s[28:31], s60 offen offset:0
  buffer_load_dwordx4 v[44:47], v3, s[28:31], s60 offen offset:1024
  buffer_load_dwordx4 v[48:51], v3, s[28:31], s60 offen offset:2048
  buffer_load_dwordx4 v[52:55], v3, s[28:31], s60 offen offset:3072
kf_kernel_ro96:
  buffer_store_dwordx4 v[72:75], v3, s[12:15], s55 offen offset:0 sc1
  v_pk_mul_f32 v[96:97], v[120:121], v[120:121]
  v_pk_mul_f32 v[98:99], v[122:123], v[122:123]
  v_pk_mul_f32 v[100:101], v[124:125], v[124:125]
  v_pk_mul_f32 v[102:103], v[126:127], v[126:127]
  v_pk_fma_f32 v[96:97], v[96:97], s[62:63], v[6:7]
  v_pk_fma_f32 v[98:99], v[98:99], s[62:63], v[6:7]
  v_pk_fma_f32 v[100:101], v[100:101], s[62:63], v[6:7]
  v_pk_fma_f32 v[102:103], v[102:103], s[62:63], v[6:7]
  v_pk_mul_f32 v[96:97], v[96:97], v[120:121]
  v_pk_mul_f32 v[98:99], v[98:99], v[122:123]
  v_pk_mul_f32 v[100:101], v[100:101], v[124:125]
  v_pk_mul_f32 v[102:103], v[102:103], v[126:127]
  v_exp_f32 v96, v96
  v_exp_f32 v97, v97
  v_exp_f32 v98, v98
  v_exp_f32 v99, v99
  v_exp_f32 v100, v100
  v_exp_f32 v101, v101
  v_exp_f32 v102, v102
  v_exp_f32 v103, v103
  v_pk_add_f32 v[96:97], v[96:97], 1.0 op_sel_hi:[1,0]
  v_pk_add_f32 v[98:99], v[98:99], 1.0 op_sel_hi:[1,0]
  v_pk_add_f32 v[100:101], v[100:101], 1.0 op_sel_hi:[1,0]
  v_pk_add_f32 v[102:103], v[102:103], 1.0 op_sel_hi:[1,0]
  v_rcp_f32 v96, v96
  v_rcp_f32 v97, v97
  v_rcp_f32 v98, v98
  v_rcp_f32 v99, v99
  v_rcp_f32 v100, v100
  v_rcp_f32 v101, v101
  v_rcp_f32 v102, v102
  v_rcp_f32 v103, v103
  v_pk_mul_f32 v[96:97], v[96:97], v[120:121]
  v_pk_mul_f32 v[98:99], v[98:99], v[122:123]
  v_pk_mul_f32 v[100:101], v[100:101], v[124:125]
  v_pk_mul_f32 v[102:103], v[102:103], v[126:127]
  v_cvt_pk_bf16_f32 v76, v96, v97
  v_cvt_pk_bf16_f32 v77, v98, v99
  v_cvt_pk_bf16_f32 v78, v100, v101
  v_cvt_pk_bf16_f32 v79, v102, v103
  buffer_store_dwordx4 v[76:79], v3, s[12:15], s55 offen offset:1024 sc1
  s_and_b32 s33, s2, 7
  s_lshr_b32 s42, s2, 3
  s_lshr_b32 s35, s33, 1
  s_lshl_b32 s35, s35, 3
  s_and_b32 s36, s42, 7
  s_add_u32 s35, s35, s36
  s_and_b32 s36, s33, 1
  s_lshl_b32 s36, s36, 2
  s_lshr_b32 s42, s42, 3
  s_add_u32 s36, s36, s42
  s_load_dwordx2 s[24:25], s[0:1], 48
  s_setprio 0
  s_lshl_b32 s44, s36, 12
  s_add_u32 s44, s44, 32768
  v_bfe_u32 v10, v3, 4, 5
  v_lshlrev_b32 v10, 7, v10
  s_cmp_lt_u32 s34, 4
  s_cbranch_scc0 kf_kernel_ro100
  s_and_b32 s43, s34, 3
  s_mul_i32 s43, s43, 4160
  s_add_u32 s43, s43, 119040
  v_lshrrev_b32 v14, 1, v3
  v_add_u32 v14, s43, v14
  v_bfe_u32 v15, v3, 4, 3
  v_mul_u32_u24 v15, 512, v15
  v_add_u32 v15, v14, v15
  ds_write_b64 v14, a[8:9] offset:0
  ds_write_b64 v14, a[24:25] offset:520
  ds_write_b64 v14, a[40:41] offset:1040
  ds_write_b64 v14, a[56:57] offset:1560
  ds_write_b64 v14, a[72:73] offset:2080
  ds_write_b64 v14, a[88:89] offset:2600
  ds_write_b64 v14, a[104:105] offset:3120
  ds_write_b64 v14, a[120:121] offset:3640
  ds_read_b64 a[8:9], v15 offset:0
  ds_read_b64 a[24:25], v15 offset:8
  ds_read_b64 a[40:41], v15 offset:16
  ds_read_b64 a[56:57], v15 offset:24
  ds_read_b64 a[72:73], v15 offset:32
  ds_read_b64 a[88:89], v15 offset:40
  ds_read_b64 a[104:105], v15 offset:48
  ds_read_b64 a[120:121], v15 offset:56
  ds_write_b64 v14, a[10:11] offset:0
  ds_write_b64 v14, a[26:27] offset:520
  ds_write_b64 v14, a[42:43] offset:1040
  ds_write_b64 v14, a[58:59] offset:1560
  ds_write_b64 v14, a[74:75] offset:2080
  ds_write_b64 v14, a[90:91] offset:2600
  ds_write_b64 v14, a[106:107] offset:3120
  ds_write_b64 v14, a[122:123] offset:3640
  ds_read_b64 a[10:11], v15 offset:0
  ds_read_b64 a[26:27], v15 offset:8
  ds_read_b64 a[42:43], v15 offset:16
  ds_read_b64 a[58:59], v15 offset:24
  ds_read_b64 a[74:75], v15 offset:32
  ds_read_b64 a[90:91], v15 offset:40
  ds_read_b64 a[106:107], v15 offset:48
  ds_read_b64 a[122:123], v15 offset:56
  ds_write_b64 v14, a[12:13] offset:0
  ds_write_b64 v14, a[28:29] offset:520
  ds_write_b64 v14, a[44:45] offset:1040
  ds_write_b64 v14, a[60:61] offset:1560
  ds_write_b64 v14, a[76:77] offset:2080
  ds_write_b64 v14, a[92:93] offset:2600
  ds_write_b64 v14, a[108:109] offset:3120
  ds_write_b64 v14, a[124:125] offset:3640
  ds_read_b64 a[12:13], v15 offset:0
  ds_read_b64 a[28:29], v15 offset:8
  ds_read_b64 a[44:45], v15 offset:16
  ds_read_b64 a[60:61], v15 offset:24
  ds_read_b64 a[76:77], v15 offset:32
  ds_read_b64 a[92:93], v15 offset:40
  ds_read_b64 a[108:109], v15 offset:48
  ds_read_b64 a[124:125], v15 offset:56
  ds_write_b64 v14, a[14:15] offset:0
  ds_write_b64 v14, a[30:31] offset:520
  ds_write_b64 v14, a[46:47] offset:1040
  ds_write_b64 v14, a[62:63] offset:1560
  ds_write_b64 v14, a[78:79] offset:2080
  ds_write_b64 v14, a[94:95] offset:2600
  ds_write_b64 v14, a[110:111] offset:3120
  ds_write_b64 v14, a[126:127] offset:3640
  ds_read_b64 a[14:15], v15 offset:0
  ds_read_b64 a[30:31], v15 offset:8
  ds_read_b64 a[46:47], v15 offset:16
  ds_read_b64 a[62:63], v15 offset:24
  ds_read_b64 a[78:79], v15 offset:32
  ds_read_b64 a[94:95], v15 offset:40
  ds_read_b64 a[110:111], v15 offset:48
  ds_read_b64 a[126:127], v15 offset:56
kf_kernel_ro100:
  s_cmp_ge_u32 s34, 4
  s_cbranch_scc1 kf_kernel_t499
  s_cmp_lg_u32 s34, 0
  s_cbranch_scc1 kf_kernel_tj98
  s_mov_b64 exec, 0xffffffff
  s_mov_b32 s43, 400000
kf_kernel_lp101:
  buffer_load_dword v9, v10, s[68:71], s44 offen sc1
  s_waitcnt vmcnt(0)
  v_cmp_eq_u32 vcc, 0, v9
  s_cbranch_vccz kf_kernel_ld102
  s_sub_u32 s43, s43, 1
  s_cmp_lg_u32 s43, 0
  s_cbranch_scc1 kf_kernel_lp101
kf_kernel_ld102:
  s_mov_b64 exec, -1
  s_branch kf_kernel_tj98
kf_kernel_t499:
  s_and_b32 s43, s34, 3
  s_mul_i32 s43, s43, 4160
  s_add_u32 s43, s43, 102400
  v_lshrrev_b32 v14, 1, v3
  v_add_u32 v14, s43, v14
  v_bfe_u32 v15, v3, 4, 3
  v_mul_u32_u24 v15, 512, v15
  v_add_u32 v15, v14, v15
  ds_write_b64 v14, a[12:13] offset:0
  ds_write_b64 v14, a[28:29] offset:520
  ds_write_b64 v14, a[44:45] offset:1040
  ds_write_b64 v14, a[60:61] offset:1560
  ds_write_b64 v14, a[76:77] offset:2080
  ds_write_b64 v14, a[92:93] offset:2600
  ds_write_b64 v14, a[108:109] offset:3120
  ds_write_b64 v14, a[124:125] offset:3640
  ds_read_b64 a[12:13], v15 offset:0
  ds_read_b64 a[28:29], v15 offset:8
  ds_read_b64 a[44:45], v15 offset:16
  ds_read_b64 a[60:61], v15 offset:24
  ds_read_b64 a[76:77], v15 offset:32
  ds_read_b64 a[92:93], v15 offset:40
  ds_read_b64 a[108:109], v15 offset:48
  ds_read_b64 a[124:125], v15 offset:56
  ds_write_b64 v14, a[14:15] offset:0
  ds_write_b64 v14, a[30:31] offset:520
  ds_write_b64 v14, a[46:47] offset:1040
  ds_write_b64 v14, a[62:63] offset:1560
  ds_write_b64 v14, a[78:79] offset:2080
  ds_write_b64 v14, a[94:95] offset:2600
  ds_write_b64 v14, a[110:111] offset:3120
  ds_write_b64 v14, a[126:127] offset:3640
  ds_read_b64 a[14:15], v15 offset:0
  ds_read_b64 a[30:31], v15 offset:8
  ds_read_b64 a[46:47], v15 offset:16
  ds_read_b64 a[62:63], v15 offset:24
  ds_read_b64 a[78:79], v15 offset:32
  ds_read_b64 a[94:95], v15 offset:40
  ds_read_b64 a[110:111], v15 offset:48
  ds_read_b64 a[126:127], v15 offset:56
kf_kernel_tj98:
  s_waitcnt lgkmcnt(0)
  s_barrier
  s_branch kf_kernel_g22
kf_kernel_g22:
  s_add_u32 s28, s40, 0x1c00000
  s_addc_u32 s29, s41, 0
  s_mov_b32 s30, 0x118000
  s_mov_b32 s31, 0x00020000
  s_lshl_b32 s60, s36, 3
  s_add_u32 s60, s60, s34
  s_mul_i32 s60, s60, 17920
  s_add_u32 s8, s40, 0x1000000
  s_addc_u32 s9, s41, 0
  s_mov_b32 s10, 0x380000
  s_mov_b32 s11, 0x00020000
  s_lshl_b32 s56, s36, 3
  s_add_u32 s56, s56, s34
  s_mul_i32 s56, s56, 57344
  v_lshrrev_b32 v2, 4, v3
  buffer_load_dwordx4 v[56:59], v3, s[8:11], s56 offen offset:0
  buffer_load_dwordx4 v[60:63], v3, s[8:11], s56 offen offset:1024
  buffer_load_dwordx4 v[64:67], v3, s[8:11], s56 offen offset:2048
  buffer_load_dwordx4 v[68:71], v3, s[8:11], s56 offen offset:3072
  s_add_u32 s12, s40, 0xc00000
  s_addc_u32 s13, s41, 0
  s_mov_b32 s14, 0x400000
  s_mov_b32 s15, 0x00020000
  s_add_u32 s16, s40, 0xc00000
  s_addc_u32 s17, s41, 0
  s_mov_b32 s18, 0x400000
  s_mov_b32 s19, 0x00020000
  s_mov_b32 s26, 0x1000
  s_mov_b32 s27, 0x00020000
  s_and_b32 s37, s34, 3
  s_bfe_u32 s43, s2, 0x20006
  s_xor_b32 s43, s43, s37
  s_lshl_b32 s44, s35, 3
  s_add_u32 s44, s44, s36
  s_lshl_b32 s44, s44, 2
  s_add_u32 s44, s44, s43
  s_lshl_b32 s44, s44, 12
  s_and_b32 s42, s43, 1
  s_lshl_b32 s42, s42, 3
  s_lshl_b32 s45, s35, 4
  s_add_u32 s45, s45, s42
  s_and_b32 s42, s43, 2
  s_lshl_b32 s42, s42, 10
  s_add_u32 s45, s45, s42
  v_bfe_u32 v4, v2, 2, 2
  v_and_b32 v5, 3, v2
  v_lshlrev_b32 v5, 9, v5
  v_lshl_add_u32 v4, v4, 1, v5
  buffer_load_ushort v1, v4, s[24:27], s45 offen
  v_lshlrev_b32 v2, 3, v2
  s_lshl_b32 s42, s34, 10
  v_add_u32 v4, s42, v3
  v_add_u32 v5, 0x10000, v4
  v_add_u32 v6, 0x20000, v4
  s_lshl_b32 s42, s37, 13
  v_add_u32 v7, s42, v3
  s_mov_b32 s58, 0xffff0000
  s_lshl_b32 s48, s36, 5
  s_lshr_b32 s42, s35, 1
  s_add_u32 s48, s48, s42
  s_lshl_b32 s48, s48, 5
  s_and_b32 s42, s35, 1
  s_lshl_b32 s42, s42, 1
  s_add_u32 s48, s48, s42
  s_lshr_b32 s42, s43, 1
  s_add_u32 s48, s48, s42
  s_and_b32 s42, s43, 1
  s_lshl_b32 s42, s42, 2
  s_add_u32 s48, s48, s42
  s_lshl_b32 s48, s48, 2
  s_add_u32 s48, s48, 98304
  v_bfe_u32 v8, v3, 4, 1
  v_lshlrev_b32 v8, 11, v8
  v_mov_b32 v10, 2
  s_cmp_eq_u32 s36, 7
  s_cselect_b32 s46, 0x7f000000, s44
  s_cselect_b32 s59, 0, -1
  s_cmp_ge_u32 s34, 4
  s_cbranch_scc1 kf_kernel_hi103
  v_add_u32 v38, 0x10000, v7
  s_mul_i32 s42, s37, 6144
  s_add_u32 s42, s42, 139264
  v_add_u32 v39, s42, v3
  s_setprio 3
  s_waitcnt vmcnt(4)
  v_mfma_f32_16x16x32_bf16 v[96:99], v[56:59], a[0:3], 0
  v_mfma_f32_16x16x32_bf16 v[100:103], v[56:59], a[4:7], 0
  s_add_u32 s56, s56, 4096
  buffer_load_dwordx4 v[72:75], v3, s[8:11], s56 offen offset:0
  s_mov_b64 exec, 1
  buffer_store_dword v10, off, s[68:71], s49 sc1
  s_mov_b64 exec, -1
  v_mfma_f32_16x16x32_bf16 v[104:107], v[56:59], a[8:11], 0
  v_mfma_f32_16x16x32_bf16 v[108:111], v[56:59], a[12:15], 0
  buffer_load_dwordx4 v[76:79], v3, s[8:11], s56 offen offset:1024
  s_waitcnt vmcnt(6)
  v_mfma_f32_16x16x32_bf16 v[96:99], v[60:63], a[16:19], v[96:99]
  v_mfma_f32_16x16x32_bf16 v[100:103], v[60:63], a[20:23], v[100:103]
  buffer_load_dwordx4 v[80:83], v3, s[8:11], s56 offen offset:2048
  v_mfma_f32_16x16x32_bf16 v[104:107], v[60:63], a[24:27], v[104:107]
  v_mfma_f32_16x16x32_bf16 v[108:111], v[60:63], a[28:31], v[108:111]
  buffer_load_dwordx4 v[84:87], v3, s[8:11], s56 offen offset:3072
  s_waitcnt vmcnt(7)
  v_mfma_f32_16x16x32_bf16 v[96:99], v[64:67], a[32:35], v[96:99]
  v_mfma_f32_16x16x32_bf16 v[100:103], v[64:67], a[36:39], v[100:103]
  s_add_u32 s56, s56, 4096
  buffer_load_dwordx4 v[88:91], v3, s[8:11], s56 offen offset:0
  v_mfma_f32_16x16x32_bf16 v[104:107], v[64:67], a[40:43], v[104:107]
  v_mfma_f32_16x16x32_bf16 v[108:111], v[64:67], a[44:47], v[108:111]
  buffer_load_dwordx4 v[92:95], v3, s[8:11], s56 offen offset:1024
  s_waitcnt vmcnt(8)
  v_mfma_f32_16x16x32_bf16 v[96:99], v[68:71], a[48:51], v[96:99]
  v_mfma_f32_16x16x32_bf16 v[100:103], v[68:71], a[52:55], v[100:103]
  buffer_load_dwordx4 v[56:59], v3, s[8:11], s56 offen offset:2048
  v_mfma_f32_16x16x32_bf16 v[104:107], v[68:71], a[56:59], v[104:107]
  v_mfma_f32_16x16x32_bf16 v[108:111], v[68:71], a[60:63], v[108:111]
  buffer_load_dwordx4 v[60:63], v3, s[8:11], s56 offen offset:3072
  s_waitcnt vmcnt(8)
  v_mfma_f32_16x16x32_bf16 v[96:99], v[72:75], a[64:67], v[96:99]
  v_mfma_f32_16x16x32_bf16 v[100:103], v[72:75], a[68:71], v[100:103]
  s_add_u32 s56, s56, 4096
  buffer_load_dwordx4 v[64:67], v3, s[8:11], s56 offen offset:0
  v_mfma_f32_16x16x32_bf16 v[104:107], v[72:75], a[72:75], v[104:107]
  v_mfma_f32_16x16x32_bf16 v[108:111], v[72:75], a[76:79], v[108:111]
  buffer_load_dwordx4 v[68:71], v3, s[8:11], s56 offen offset:1024
  s_setprio 2
  s_waitcnt vmcnt(8)
  v_mfma_f32_16x16x32_bf16 v[96:99], v[76:79], a[80:83], v[96:99]
  v_mfma_f32_16x16x32_bf16 v[100:103], v[76:79], a[84:87], v[100:103]
  buffer_load_dwordx4 v[72:75], v3, s[8:11], s56 offen offset:2048
  v_mfma_f32_16x16x32_bf16 v[104:107], v[76:79], a[88:91], v[104:107]
  v_mfma_f32_16x16x32_bf16 v[108:111], v[76:79], a[92:95], v[108:111]
  buffer_load_dwordx4 v[76:79], v3, s[8:11], s56 offen offset:3072
  s_waitcnt vmcnt(9)
  v_mfma_f32_16x16x32_bf16 v[96:99], v[80:83], a[96:99], v[96:99]
  v_mfma_f32_16x16x32_bf16 v[100:103], v[80:83], a[100:103], v[100:103]
  v_mfma_f32_16x16x32_bf16 v[104:107], v[80:83], a[104:107], v[104:107]
  v_mfma_f32_16x16x32_bf16 v[108:111], v[80:83], a[108:111], v[108:111]
  s_add_u32 s56, s56, 4096
  buffer_load_dwordx4 v[80:83], v3, s[8:11], s56 offen offset:0
  s_waitcnt vmcnt(9)
  v_mfma_f32_16x16x32_bf16 v[96:99], v[84:87], a[112:115], v[96:99]
  v_mfma_f32_16x16x32_bf16 v[100:103], v[84:87], a[116:119], v[100:103]
  v_mfma_f32_16x16x32_bf16 v[104:107], v[84:87], a[120:123], v[104:107]
  v_mfma_f32_16x16x32_bf16 v[108:111], v[84:87], a[124:127], v[108:111]
  buffer_load_dwordx4 v[84:87], v3, s[8:11], s56 offen offset:1024
  s_waitcnt vmcnt(9)
  v_mfma_f32_16x16x32_bf16 v[112:115], v[88:91], a[0:3], 0
  v_mfma_f32_16x16x32_bf16 v[116:119], v[88:91], a[4:7], 0
  v_mfma_f32_16x16x32_bf16 v[120:123], v[88:91], a[8:11], 0
  v_mfma_f32_16x16x32_bf16 v[124:127], v[88:91], a[12:15], 0
  buffer_load_dwordx4 v[88:91], v3, s[8:11], s56 offen offset:2048
  ds_write_b128 v4, v[96:99] offset:0
  s_waitcnt vmcnt(9)
  v_mfma_f32_16x16x32_bf16 v[112:115], v[92:95], a[16:19], v[112:115]
  v_mfma_f32_16x16x32_bf16 v[116:119], v[92:95], a[20:23], v[116:119]
  ds_write_b128 v4, v[100:103] offset:8192
  v_mfma_f32_16x16x32_bf16 v[120:123], v[92:95], a[24:27], v[120:123]
  v_mfma_f32_16x16x32_bf16 v[124:127], v[92:95], a[28:31], v[124:127]
  buffer_load_dwordx4 v[92:95], v3, s[8:11], s56 offen offset:3072
  ds_write_b128 v4, v[104:107] offset:16384
  s_setprio 1
  s_waitcnt vmcnt(9)
  v_mfma_f32_16x16x32_bf16 v[112:115], v[56:59], a[32:35], v[112:115]
  v_lshlrev_b32 v1, 16, v1
  v_mfma_f32_16x16x32_bf16 v[116:119], v[56:59], a[36:39], v[116:119]
  ds_write_b128 v4, v[108:111] offset:24576
  v_mfma_f32_16x16x32_bf16 v[120:123], v[56:59], a[40:43], v[120:123]
  v_mfma_f32_16x16x32_bf16 v[124:127], v[56:59], a[44:47], v[124:127]
  s_add_u32 s56, s56, 4096
  buffer_load_dwordx4 v[56:59], v3, s[8:11], s56 offen offset:0
  s_waitcnt vmcnt(9)
  v_mfma_f32_16x16x32_bf16 v[112:115], v[60:63], a[48:51], v[112:115]
  buffer_load_dword v9, v8, s[68:71], s48 offen sc1
  v_mfma_f32_16x16x32_bf16 v[116:119], v[60:63], a[52:55], v[116:119]
  v_mfma_f32_16x16x32_bf16 v[120:123], v[60:63], a[56:59], v[120:123]
  v_mfma_f32_16x16x32_bf16 v[124:127], v[60:63], a[60:63], v[124:127]
  buffer_load_dwordx4 v[60:63], v3, s[8:11], s56 offen offset:1024
  s_waitcnt vmcnt(10)
  v_mfma_f32_16x16x32_bf16 v[112:115], v[64:67], a[64:67], v[112:115]
  v_mfma_f32_16x16x32_bf16 v[116:119], v[64:67], a[68:71], v[116:119]
  v_mfma_f32_16x16x32_bf16 v[120:123], v[64:67], a[72:75], v[120:123]
  v_mfma_f32_16x16x32_bf16 v[124:127], v[64:67], a[76:79], v[124:127]
  buffer_load_dwordx4 v[64:67], v3, s[8:11], s56 offen offset:2048
  s_waitcnt vmcnt(10)
  v_mfma_f32_16x16x32_bf16 v[112:115], v[68:71], a[80:83], v[112:115]
  v_mfma_f32_16x16x32_bf16 v[116:119], v[68:71], a[84:87], v[116:119]
  v_mfma_f32_16x16x32_bf16 v[120:123], v[68:71], a[88:91], v[120:123]
  v_mfma_f32_16x16x32_bf16 v[124:127], v[68:71], a[92:95], v[124:127]
  buffer_load_dwordx4 v[68:71], v3, s[8:11], s56 offen offset:3072
  s_waitcnt vmcnt(10)
  v_mfma_f32_16x16x32_bf16 v[112:115], v[72:75], a[96:99], v[112:115]
  v_mfma_f32_16x16x32_bf16 v[116:119], v[72:75], a[100:103], v[116:119]
  v_mfma_f32_16x16x32_bf16 v[120:123], v[72:75], a[104:107], v[120:123]
  v_mfma_f32_16x16x32_bf16 v[124:127], v[72:75], a[108:111], v[124:127]
  s_add_u32 s56, s56, 4096
  buffer_load_dwordx4 v[72:75], v3, s[8:11], s56 offen offset:0
  s_setprio 0
  s_waitcnt vmcnt(10)
  v_mfma_f32_16x16x32_bf16 v[112:115], v[76:79], a[112:115], v[112:115]
  s_waitcnt vmcnt(4)
  v_cmp_ne_u32 vcc, 2, v9
  s_cbranch_vccz kf_kernel_ld105
  s_mov_b32 s43, 400000
kf_kernel_lp104:
  buffer_load_dword v9, v8, s[68:71], s48 offen sc1
  s_waitcnt vmcnt(0)
  v_cmp_ne_u32 vcc, 2, v9
  s_cbranch_vccz kf_kernel_ld105
  s_sub_u32 s43, s43, 1
  s_cmp_lg_u32 s43, 0
  s_cbranch_scc1 kf_kernel_lp104
kf_kernel_ld105:
  v_mfma_f32_16x16x32_bf16 v[116:119], v[76:79], a[116:119], v[116:119]
  buffer_load_dwordx4 v[32:35], v3, s[12:15], s44 offen offset:0
  v_mfma_f32_16x16x32_bf16 v[120:123], v[76:79], a[120:123], v[120:123]
  v_mfma_f32_16x16x32_bf16 v[124:127], v[76:79], a[124:127], v[124:127]
  buffer_load_dwordx4 v[76:79], v3, s[8:11], s56 offen offset:1024
  v_mfma_f32_16x16x32_bf16 v[96:99], v[80:83], a[0:3], 0
  v_mfma_f32_16x16x32_bf16 v[100:103], v[80:83], a[4:7], 0
  v_mfma_f32_16x16x32_bf16 v[104:107], v[80:83], a[8:11], 0
  v_mfma_f32_16x16x32_bf16 v[108:111], v[80:83], a[12:15], 0
  buffer_load_dwordx4 v[80:83], v3, s[8:11], s56 offen offset:2048
  ds_write_b128 v4, v[112:115] offset:32768
  v_mfma_f32_16x16x32_bf16 v[96:99], v[84:87], a[16:19], v[96:99]
  v_mfma_f32_16x16x32_bf16 v[100:103], v[84:87], a[20:23], v[100:103]
  ds_write_b128 v4, v[116:119] offset:40960
  v_mfma_f32_16x16x32_bf16 v[104:107], v[84:87], a[24:27], v[104:107]
  v_mfma_f32_16x16x32_bf16 v[108:111], v[84:87], a[28:31], v[108:111]
  buffer_load_dwordx4 v[84:87], v3, s[8:11], s56 offen offset:3072
  ds_write_b128 v4, v[120:123] offset:49152
  v_mfma_f32_16x16x32_bf16 v[96:99], v[88:91], a[32:35], v[96:99]
  v_mfma_f32_16x16x32_bf16 v[100:103], v[88:91], a[36:39], v[100:103]
  ds_write_b128 v4, v[124:127] offset:57344
  v_mfma_f32_16x16x32_bf16 v[104:107], v[88:91], a[40:43], v[104:107]
  v_mfma_f32_16x16x32_bf16 v[108:111], v[88:91], a[44:47], v[108:111]
  s_add_u32 s56, s56, 4096
  buffer_load_dwordx4 v[88:91], v3, s[8:11], s56 offen offset:0
  v_mfma_f32_16x16x32_bf16 v[96:99], v[92:95], a[48:51], v[96:99]
  v_mfma_f32_16x16x32_bf16 v[100:103], v[92:95], a[52:55], v[100:103]
  v_mfma_f32_16x16x32_bf16 v[104:107], v[92:95], a[56:59], v[104:107]
  v_mfma_f32_16x16x32_bf16 v[108:111], v[92:95], a[60:63], v[108:111]
  buffer_load_dwordx4 v[92:95], v3, s[8:11], s56 offen offset:1024
  v_mfma_f32_16x16x32_bf16 v[96:99], v[56:59], a[64:67], v[96:99]
  s_waitcnt lgkmcnt(0)
  s_barrier
  s_setprio 3
  v_mfma_f32_16x16x32_bf16 v[100:103], v[56:59], a[68:71], v[100:103]
  ds_read_b128 v[8:11], v7 offset:0
  ds_read_b128 v[12:15], v7 offset:1024
  ds_read_b128 v[16:19], v7 offset:2048
  v_mfma_f32_16x16x32_bf16 v[104:107], v[56:59], a[72:75], v[104:107]
  ds_read_b128 v[20:23], v7 offset:3072
  v_mfma_f32_16x16x32_bf16 v[108:111], v[56:59], a[76:79], v[108:111]
  buffer_load_dwordx4 v[56:59], v3, s[8:11], s56 offen offset:2048
  s_waitcnt lgkmcnt(2)
  v_add_f32 v24, v8, v12
  v_add_f32 v25, v9, v13
  s_waitcnt vmcnt(10)
  v_mfma_f32_16x16x32_bf16 v[96:99], v[60:63], a[80:83], v[96:99]
  v_add_f32 v26, v10, v14
  v_add_f32 v27, v11, v15
  s_waitcnt lgkmcnt(0)
  v_mfma_f32_16x16x32_bf16 v[100:103], v[60:63], a[84:87], v[100:103]
  v_add_f32 v16, v16, v20
  v_add_f32 v17, v17, v21
  v_add_f32 v18, v18, v22
  v_mfma_f32_16x16x32_bf16 v[104:107], v[60:63], a[88:91], v[104:107]
  v_add_f32 v19, v19, v23
  v_add_f32 v24, v24, v16
  v_add_f32 v25, v25, v17
  v_mfma_f32_16x16x32_bf16 v[108:111], v[60:63], a[92:95], v[108:111]
  buffer_load_dwordx4 v[60:63], v3, s[8:11], s56 offen offset:3072
  v_add_f32 v26, v26, v18
  v_add_f32 v27, v27, v19
  ds_read_b128 v[8:11], v7 offset:4096
  s_waitcnt vmcnt(10)
  v_mfma_f32_16x16x32_bf16 v[96:99], v[64:67], a[96:99], v[96:99]
  ds_read_b128 v[12:15], v7 offset:5120
  ds_read_b128 v[16:19], v7 offset:6144
  ds_read_b128 v[20:23], v7 offset:7168
  v_mfma_f32_16x16x32_bf16 v[100:103], v[64:67], a[100:103], v[100:103]
  s_waitcnt lgkmcnt(2)
  v_mfma_f32_16x16x32_bf16 v[104:107], v[64:67], a[104:107], v[104:107]
  v_add_f32 v8, v8, v12
  v_add_f32 v9, v9, v13
  v_add_f32 v10, v10, v14
  v_mfma_f32_16x16x32_bf16 v[108:111], v[64:67], a[108:111], v[108:111]
  s_add_u32 s56, s56, 4096
  buffer_load_dwordx4 v[64:67], v3, s[8:11], s56 offen offset:0
  v_add_f32 v11, v11, v15
  v_add_f32 v24, v24, v8
  v_add_f32 v25, v25, v9
  s_waitcnt vmcnt(10)
  v_mfma_f32_16x16x32_bf16 v[96:99], v[68:71], a[112:115], v[96:99]
  v_add_f32 v26, v26, v10
  v_add_f32 v27, v27, v11
  s_waitcnt lgkmcnt(0)
  v_mfma_f32_16x16x32_bf16 v[100:103], v[68:71], a[116:119], v[100:103]
  v_add_f32 v16, v16, v20
  v_add_f32 v17, v17, v21
  v_add_f32 v18, v18, v22
  v_mfma_f32_16x16x32_bf16 v[104:107], v[68:71], a[120:123], v[104:107]
  v_add_f32 v19, v19, v23
  v_add_f32 v24, v24, v16
  v_add_f32 v25, v25, v17
  v_mfma_f32_16x16x32_bf16 v[108:111], v[68:71], a[124:127], v[108:111]
  buffer_load_dwordx4 v[68:71], v3, s[8:11], s56 offen offset:1024
  v_add_f32 v26, v26, v18
  v_add_f32 v27, v27, v19
  ds_read_b128 v[8:11], v7 offset:32768
  s_waitcnt vmcnt(10)
  v_mfma_f32_16x16x32_bf16 v[112:115], v[72:75], a[0:3], 0
  s_setprio 2
  ds_read_b128 v[12:15], v7 offset:33792
  ds_read_b128 v[16:19], v7 offset:34816
  ds_read_b128 v[20:23], v7 offset:35840
  v_mfma_f32_16x16x32_bf16 v[116:119], v[72:75], a[4:7], 0
  s_waitcnt lgkmcnt(2)
  v_mfma_f32_16x16x32_bf16 v[120:123], v[72:75], a[8:11], 0
  v_add_f32 v28, v8, v12
  v_add_f32 v29, v9, v13
  v_add_f32 v30, v10, v14
  v_mfma_f32_16x16x32_bf16 v[124:127], v[72:75], a[12:15], 0
  buffer_load_dwordx4 v[72:75], v3, s[8:11], s56 offen offset:2048
  ds_write_b128 v5, v[96:99] offset:0
  v_add_f32 v31, v11, v15
  s_waitcnt lgkmcnt(1)
  v_add_f32 v16, v16, v20
  s_waitcnt vmcnt(9)
  v_mfma_f32_16x16x32_bf16 v[112:115], v[76:79], a[16:19], v[112:115]
  v_add_f32 v17, v17, v21
  v_add_f32 v18, v18, v22
  v_add_f32 v19, v19, v23
  v_mfma_f32_16x16x32_bf16 v[116:119], v[76:79], a[20:23], v[116:119]
  ds_write_b128 v5, v[100:103] offset:8192
  v_add_f32 v28, v28, v16
  v_add_f32 v29, v29, v17
  v_add_f32 v30, v30, v18
  v_mfma_f32_16x16x32_bf16 v[120:123], v[76:79], a[24:27], v[120:123]
  v_add_f32 v31, v31, v19
  ds_read_b128 v[8:11], v7 offset:36864
  ds_read_b128 v[12:15], v7 offset:37888
  v_mfma_f32_16x16x32_bf16 v[124:127], v[76:79], a[28:31], v[124:127]
  buffer_load_dwordx4 v[76:79], v3, s[8:11], s56 offen offset:3072
  ds_write_b128 v5, v[104:107] offset:16384
  ds_read_b128 v[16:19], v7 offset:38912
  ds_read_b128 v[20:23], v7 offset:39936
  s_waitcnt vmcnt(9)
  v_mfma_f32_16x16x32_bf16 v[112:115], v[80:83], a[32:35], v[112:115]
  s_waitcnt lgkmcnt(3)
  v_add_f32 v8, v8, v12
  v_mfma_f32_16x16x32_bf16 v[116:119], v[80:83], a[36:39], v[116:119]
  ds_write_b128 v5, v[108:111] offset:24576
  v_add_f32 v9, v9, v13
  v_add_f32 v10, v10, v14
  v_add_f32 v11, v11, v15
  v_mfma_f32_16x16x32_bf16 v[120:123], v[80:83], a[40:43], v[120:123]
  v_add_f32 v28, v28, v8
  v_add_f32 v29, v29, v9
  v_add_f32 v30, v30, v10
  v_mfma_f32_16x16x32_bf16 v[124:127], v[80:83], a[44:47], v[124:127]
  s_add_u32 s56, s56, 4096
  buffer_load_dwordx4 v[80:83], v3, s[8:11], s56 offen offset:0
  v_add_f32 v31, v31, v11
  s_waitcnt lgkmcnt(1)
  v_add_f32 v16, v16, v20
  s_waitcnt vmcnt(9)
  v_mfma_f32_16x16x32_bf16 v[112:115], v[84:87], a[48:51], v[112:115]
  v_add_f32 v17, v17, v21
  v_add_f32 v18, v18, v22
  v_add_f32 v19, v19, v23
  v_mfma_f32_16x16x32_bf16 v[116:119], v[84:87], a[52:55], v[116:119]
  v_add_f32 v28, v28, v16
  v_add_f32 v29, v29, v17
  v_add_f32 v30, v30, v18
  v_mfma_f32_16x16x32_bf16 v[120:123], v[84:87], a[56:59], v[120:123]
  v_add_f32 v31, v31, v19
  v_add_f32 v24, v24, v1
  v_mfma_f32_16x16x32_bf16 v[124:127], v[84:87], a[60:63], v[124:127]
  buffer_load_dwordx4 v[84:87], v3, s[8:11], s56 offen offset:1024
  v_add_f32 v25, v25, v1
  v_add_f32 v26, v26, v1
  v_add_f32 v27, v27, v1
  s_waitcnt vmcnt(9)
  v_mfma_f32_16x16x32_bf16 v[112:115], v[88:91], a[64:67], v[112:115]
  s_setprio 1
  v_add_f32 v28, v28, v1
  v_add_f32 v29, v29, v1
  v_add_f32 v30, v30, v1
  v_mfma_f32_16x16x32_bf16 v[116:119], v[88:91], a[68:71], v[116:119]
  v_add_f32 v31, v31, v1
  v_lshlrev_b32 v16, 16, v32
  v_and_b32 v17, s58, v32
  v_mfma_f32_16x16x32_bf16 v[120:123], v[88:91], a[72:75], v[120:123]
  v_lshlrev_b32 v18, 16, v33
  v_and_b32 v19, s58, v33
  v_lshlrev_b32 v20, 16, v34
  v_mfma_f32_16x16x32_bf16 v[124:127], v[88:91], a[76:79], v[124:127]
  buffer_load_dwordx4 v[88:91], v3, s[8:11], s56 offen offset:2048
  v_and_b32 v21, s58, v34
  v_lshlrev_b32 v22, 16, v35
  v_and_b32 v23, s58, v35
  s_waitcnt vmcnt(9)
  v_mfma_f32_16x16x32_bf16 v[112:115], v[92:95], a[80:83], v[112:115]
  v_mul_f32 v24, v24, v16
  v_mul_f32 v25, v25, v17
  v_mul_f32 v26, v26, v18
  v_mfma_f32_16x16x32_bf16 v[116:119], v[92:95], a[84:87], v[116:119]
  v_mul_f32 v27, v27, v19
  v_mul_f32 v28, v28, v20
  v_mul_f32 v29, v29, v21
  v_mfma_f32_16x16x32_bf16 v[120:123], v[92:95], a[88:91], v[120:123]
  v_mul_f32 v30, v30, v22
  v_mul_f32 v31, v31, v23
  v_cvt_pk_bf16_f32 v32, v24, v25
  v_mfma_f32_16x16x32_bf16 v[124:127], v[92:95], a[92:95], v[124:127]
  buffer_load_dwordx4 v[92:95], v3, s[8:11], s56 offen offset:3072
  v_cvt_pk_bf16_f32 v33, v26, v27
  v_cvt_pk_bf16_f32 v34, v28, v29
  v_cvt_pk_bf16_f32 v35, v30, v31
  s_waitcnt vmcnt(9)
  v_mfma_f32_16x16x32_bf16 v[112:115], v[56:59], a[96:99], v[112:115]
  buffer_store_dwordx4 v[32:35], v3, s[16:19], s44 offen offset:0 sc1
  v_mfma_f32_16x16x32_bf16 v[116:119], v[56:59], a[100:103], v[116:119]
  v_mfma_f32_16x16x32_bf16 v[120:123], v[56:59], a[104:107], v[120:123]
  v_mfma_f32_16x16x32_bf16 v[124:127], v[56:59], a[108:111], v[124:127]
  s_add_u32 s56, s56, 4096
  s_cmp_eq_u32 s36, 7
  s_cselect_b32 s56, 0x7f000000, s56
  buffer_load_dwordx4 v[56:59], v3, s[8:11], s56 offen offset:0
  s_waitcnt vmcnt(10)
  v_mfma_f32_16x16x32_bf16 v[112:115], v[60:63], a[112:115], v[112:115]
  v_mfma_f32_16x16x32_bf16 v[116:119], v[60:63], a[116:119], v[116:119]
  v_mfma_f32_16x16x32_bf16 v[120:123], v[60:63], a[120:123], v[120:123]
  v_mfma_f32_16x16x32_bf16 v[124:127], v[60:63], a[124:127], v[124:127]
  buffer_load_dwordx4 v[60:63], v3, s[8:11], s56 offen offset:1024
  s_waitcnt vmcnt(10)
  v_mfma_f32_16x16x32_bf16 v[96:99], v[64:67], a[0:3], 0
  s_setprio 0
  v_mfma_f32_16x16x32_bf16 v[100:103], v[64:67], a[4:7], 0
  v_mfma_f32_16x16x32_bf16 v[104:107], v[64:67], a[8:11], 0
  v_mfma_f32_16x16x32_bf16 v[108:111], v[64:67], a[12:15], 0
  buffer_load_dwordx4 v[64:67], v3, s[8:11], s56 offen offset:2048
  ds_write_b128 v5, v[112:115] offset:32768
  s_waitcnt vmcnt(10)
  v_mfma_f32_16x16x32_bf16 v[96:99], v[68:71], a[16:19], v[96:99]
  v_mfma_f32_16x16x32_bf16 v[100:103], v[68:71], a[20:23], v[100:103]
  ds_write_b128 v5, v[116:119] offset:40960
  v_mfma_f32_16x16x32_bf16 v[104:107], v[68:71], a[24:27], v[104:107]
  v_mfma_f32_16x16x32_bf16 v[108:111], v[68:71], a[28:31], v[108:111]
  buffer_load_dwordx4 v[68:71], v3, s[8:11], s56 offen offset:3072
  ds_write_b128 v5, v[120:123] offset:49152
  s_waitcnt vmcnt(10)
  v_mfma_f32_16x16x32_bf16 v[96:99], v[72:75], a[32:35], v[96:99]
  v_mfma_f32_16x16x32_bf16 v[100:103], v[72:75], a[36:39], v[100:103]
  ds_write_b128 v5, v[124:127] offset:57344
  v_mfma_f32_16x16x32_bf16 v[104:107], v[72:75], a[40:43], v[104:107]
  v_mfma_f32_16x16x32_bf16 v[108:111], v[72:75], a[44:47], v[108:111]
  s_add_u32 s56, s56, 4096
  buffer_load_dwordx4 v[72:75], v3, s[8:11], s56 offen offset:0
  s_waitcnt vmcnt(10)
  v_mfma_f32_16x16x32_bf16 v[96:99], v[76:79], a[48:51], v[96:99]
  v_mfma_f32_16x16x32_bf16 v[100:103], v[76:79], a[52:55], v[100:103]
  v_mfma_f32_16x16x32_bf16 v[104:107], v[76:79], a[56:59], v[104:107]
  v_mfma_f32_16x16x32_bf16 v[108:111], v[76:79], a[60:63], v[108:111]
  buffer_load_dwordx4 v[76:79], v3, s[8:11], s56 offen offset:1024
  s_waitcnt vmcnt(10)
  v_mfma_f32_16x16x32_bf16 v[96:99], v[80:83], a[64:67], v[96:99]
  s_waitcnt lgkmcnt(0)
  s_barrier
  s_setprio 3
  v_mfma_f32_16x16x32_bf16 v[100:103], v[80:83], a[68:71], v[100:103]
  v_mfma_f32_16x16x32_bf16 v[104:107], v[80:83], a[72:75], v[104:107]
  v_mfma_f32_16x16x32_bf16 v[108:111], v[80:83], a[76:79], v[108:111]
  buffer_load_dwordx4 v[80:83], v3, s[8:11], s56 offen offset:2048
  s_waitcnt vmcnt(10)
  v_mfma_f32_16x16x32_bf16 v[96:99], v[84:87], a[80:83], v[96:99]
  v_mfma_f32_16x16x32_bf16 v[100:103], v[84:87], a[84:87], v[100:103]
  v_mfma_f32_16x16x32_bf16 v[104:107], v[84:87], a[88:91], v[104:107]
  v_mfma_f32_16x16x32_bf16 v[108:111], v[84:87], a[92:95], v[108:111]
  buffer_load_dwordx4 v[84:87], v3, s[8:11], s56 offen offset:3072
  s_waitcnt vmcnt(10)
  v_mfma_f32_16x16x32_bf16 v[96:99], v[88:91], a[96:99], v[96:99]
  v_mfma_f32_16x16x32_bf16 v[100:103], v[88:91], a[100:103], v[100:103]
  v_mfma_f32_16x16x32_bf16 v[104:107], v[88:91], a[104:107], v[104:107]
  v_mfma_f32_16x16x32_bf16 v[108:111], v[88:91], a[108:111], v[108:111]
  s_add_u32 s56, s56, 4096
  buffer_load_dwordx4 v[88:91], v3, s[8:11], s56 offen offset:0
  s_waitcnt vmcnt(10)
  v_mfma_f32_16x16x32_bf16 v[96:99], v[92:95], a[112:115], v[96:99]
  v_mfma_f32_16x16x32_bf16 v[100:103], v[92:95], a[116:119], v[100:103]
  v_mfma_f32_16x16x32_bf16 v[104:107], v[92:95], a[120:123], v[104:107]
  v_mfma_f32_16x16x32_bf16 v[108:111], v[92:95], a[124:127], v[108:111]
  buffer_load_dwordx4 v[92:95], v3, s[8:11], s56 offen offset:1024
  s_waitcnt vmcnt(9)
  v_mfma_f32_16x16x32_bf16 v[112:115], v[56:59], a[0:3], 0
  s_setprio 2
  buffer_load_dwordx4 v[32:35], v3, s[12:15], s44 offen offset:2048
  v_mfma_f32_16x16x32_bf16 v[116:119], v[56:59], a[4:7], 0
  v_mfma_f32_16x16x32_bf16 v[120:123], v[56:59], a[8:11], 0
  v_mfma_f32_16x16x32_bf16 v[124:127], v[56:59], a[12:15], 0
  buffer_load_dwordx4 v[56:59], v3, s[8:11], s56 offen offset:2048
  ds_write_b128 v4, v[96:99] offset:0
  s_waitcnt vmcnt(10)
  v_mfma_f32_16x16x32_bf16 v[112:115], v[60:63], a[16:19], v[112:115]
  v_mfma_f32_16x16x32_bf16 v[116:119], v[60:63], a[20:23], v[116:119]
  ds_write_b128 v4, v[100:103] offset:8192
  v_mfma_f32_16x16x32_bf16 v[120:123], v[60:63], a[24:27], v[120:123]
  v_mfma_f32_16x16x32_bf16 v[124:127], v[60:63], a[28:31], v[124:127]
  buffer_load_dwordx4 v[60:63], v3, s[8:11], s56 offen offset:3072
  ds_write_b128 v4, v[104:107] offset:16384
  s_waitcnt vmcnt(10)
  v_mfma_f32_16x16x32_bf16 v[112:115], v[64:67], a[32:35], v[112:115]
  v_mfma_f32_16x16x32_bf16 v[116:119], v[64:67], a[36:39], v[116:119]
  ds_write_b128 v4, v[108:111] offset:24576
  v_mfma_f32_16x16x32_bf16 v[120:123], v[64:67], a[40:43], v[120:123]
  v_mfma_f32_16x16x32_bf16 v[124:127], v[64:67], a[44:47], v[124:127]
  s_add_u32 s56, s56, 4096
  buffer_load_dwordx4 v[64:67], v3, s[8:11], s56 offen offset:0
  s_waitcnt vmcnt(10)
  v_mfma_f32_16x16x32_bf16 v[112:115], v[68:71], a[48:51], v[112:115]
  v_mfma_f32_16x16x32_bf16 v[116:119], v[68:71], a[52:55], v[116:119]
  v_mfma_f32_16x16x32_bf16 v[120:123], v[68:71], a[56:59], v[120:123]
  v_mfma_f32_16x16x32_bf16 v[124:127], v[68:71], a[60:63], v[124:127]
  buffer_load_dwordx4 v[68:71], v3, s[8:11], s56 offen offset:1024
  s_waitcnt vmcnt(10)
  v_mfma_f32_16x16x32_bf16 v[112:115], v[72:75], a[64:67], v[112:115]
  s_setprio 1
  v_mfma_f32_16x16x32_bf16 v[116:119], v[72:75], a[68:71], v[116:119]
  v_mfma_f32_16x16x32_bf16 v[120:123], v[72:75], a[72:75], v[120:123]
  v_mfma_f32_16x16x32_bf16 v[124:127], v[72:75], a[76:79], v[124:127]
  buffer_load_dwordx4 v[72:75], v3, s[8:11], s56 offen offset:2048
  s_waitcnt vmcnt(10)
  v_mfma_f32_16x16x32_bf16 v[112:115], v[76:79], a[80:83], v[112:115]
  v_mfma_f32_16x16x32_bf16 v[116:119], v[76:79], a[84:87], v[116:119]
  v_mfma_f32_16x16x32_bf16 v[120:123], v[76:79], a[88:91], v[120:123]
  v_mfma_f32_16x16x32_bf16 v[124:127], v[76:79], a[92:95], v[124:127]
  buffer_load_dwordx4 v[76:79], v3, s[8:11], s56 offen offset:3072
  s_waitcnt vmcnt(10)
  v_mfma_f32_16x16x32_bf16 v[112:115], v[80:83], a[96:99], v[112:115]
  v_mfma_f32_16x16x32_bf16 v[116:119], v[80:83], a[100:103], v[116:119]
  v_mfma_f32_16x16x32_bf16 v[120:123], v[80:83], a[104:107], v[120:123]
  v_mfma_f32_16x16x32_bf16 v[124:127], v[80:83], a[108:111], v[124:127]
  s_waitcnt vmcnt(9)
  v_mfma_f32_16x16x32_bf16 v[112:115], v[84:87], a[112:115], v[112:115]
  v_mfma_f32_16x16x32_bf16 v[116:119], v[84:87], a[116:119], v[116:119]
  v_mfma_f32_16x16x32_bf16 v[120:123], v[84:87], a[120:123], v[120:123]
  v_mfma_f32_16x16x32_bf16 v[124:127], v[84:87], a[124:127], v[124:127]
  s_waitcnt vmcnt(8)
  v_mfma_f32_16x16x32_bf16 v[96:99], v[88:91], a[0:3], 0
  s_setprio 0
  v_mfma_f32_16x16x32_bf16 v[100:103], v[88:91], a[4:7], 0
  v_mfma_f32_16x16x32_bf16 v[104:107], v[88:91], a[8:11], 0
  v_mfma_f32_16x16x32_bf16 v[108:111], v[88:91], a[12:15], 0
  ds_write_b128 v4, v[112:115] offset:32768
  s_waitcnt vmcnt(7)
  v_mfma_f32_16x16x32_bf16 v[96:99], v[92:95], a[16:19], v[96:99]
  s_add_u32 s60, s60, 4096
  buffer_load_dwordx4 a[16:19], v3, s[28:31], s60 offen offset:0
  v_mfma_f32_16x16x32_bf16 v[100:103], v[92:95], a[20:23], v[100:103]
  ds_write_b128 v4, v[116:119] offset:40960
  buffer_load_dwordx4 a[20:23], v3, s[28:31], s60 offen offset:1024
  v_mfma_f32_16x16x32_bf16 v[104:107], v[92:95], a[24:27], v[104:107]
  buffer_load_dwordx4 a[24:27], v3, s[28:31], s60 offen offset:2048
  v_mfma_f32_16x16x32_bf16 v[108:111], v[92:95], a[28:31], v[108:111]
  ds_write_b128 v4, v[120:123] offset:49152
  buffer_load_dwordx4 a[28:31], v3, s[28:31], s60 offen offset:3072
  s_waitcnt vmcnt(9)
  v_mfma_f32_16x16x32_bf16 v[96:99], v[56:59], a[32:35], v[96:99]
  s_add_u32 s60, s60, 4096
  buffer_load_dwordx4 a[32:35], v3, s[28:31], s60 offen offset:0
  v_mfma_f32_16x16x32_bf16 v[100:103], v[56:59], a[36:39], v[100:103]
  ds_write_b128 v4, v[124:127] offset:57344
  ds_read_b128 a[36:39], v39 offset:0
  v_mfma_f32_16x16x32_bf16 v[104:107], v[56:59], a[40:43], v[104:107]
  ds_read_b128 a[40:43], v39 offset:1024
  v_mfma_f32_16x16x32_bf16 v[108:111], v[56:59], a[44:47], v[108:111]
  ds_read_b128 a[44:47], v39 offset:2048
  s_waitcnt vmcnt(9)
  v_mfma_f32_16x16x32_bf16 v[96:99], v[60:63], a[48:51], v[96:99]
  ds_read_b128 a[48:51], v39 offset:3072
  v_mfma_f32_16x16x32_bf16 v[100:103], v[60:63], a[52:55], v[100:103]
  ds_read_b128 a[52:55], v39 offset:4096
  v_mfma_f32_16x16x32_bf16 v[104:107], v[60:63], a[56:59], v[104:107]
  ds_read_b128 a[56:59], v39 offset:5120
  v_mfma_f32_16x16x32_bf16 v[108:111], v[60:63], a[60:63], v[108:111]
  s_add_u32 s60, s60, 7168
  buffer_load_dwordx2 a[60:61], v2, s[28:31], s60 offen offset:0
  s_waitcnt vmcnt(9)
  v_mfma_f32_16x16x32_bf16 v[96:99], v[64:67], a[64:67], v[96:99]
  s_waitcnt lgkmcnt(6)
  s_barrier
  s_setprio 3
  buffer_load_dwordx2 a[62:63], v2, s[28:31], s60 offen offset:512
  v_mfma_f32_16x16x32_bf16 v[100:103], v[64:67], a[68:71], v[100:103]
  buffer_load_dwordx2 a[64:65], v2, s[28:31], s60 offen offset:1024
  ds_read_b128 v[8:11], v7 offset:0
  ds_read_b128 v[12:15], v7 offset:1024
  ds_read_b128 v[16:19], v7 offset:2048
  v_mfma_f32_16x16x32_bf16 v[104:107], v[64:67], a[72:75], v[104:107]
  buffer_load_dwordx2 a[66:67], v2, s[28:31], s60 offen offset:1536
  ds_read_b128 v[20:23], v7 offset:3072
  v_mfma_f32_16x16x32_bf16 v[108:111], v[64:67], a[76:79], v[108:111]
  buffer_load_dwordx2 a[68:69], v2, s[28:31], s60 offen offset:2048
  s_waitcnt lgkmcnt(2)
  v_add_f32 v24, v8, v12
  v_add_f32 v25, v9, v13
  s_waitcnt vmcnt(12)
  v_mfma_f32_16x16x32_bf16 v[96:99], v[68:71], a[80:83], v[96:99]
  s_setprio 2
  v_add_f32 v26, v10, v14
  v_add_f32 v27, v11, v15
  s_waitcnt lgkmcnt(0)
  v_mfma_f32_16x16x32_bf16 v[100:103], v[68:71], a[84:87], v[100:103]
  v_add_f32 v16, v16, v20
  v_add_f32 v17, v17, v21
  v_add_f32 v18, v18, v22
  v_mfma_f32_16x16x32_bf16 v[104:107], v[68:71], a[88:91], v[104:107]
  v_add_f32 v19, v19, v23
  v_add_f32 v24, v24, v16
  v_add_f32 v25, v25, v17
  v_mfma_f32_16x16x32_bf16 v[108:111], v[68:71], a[92:95], v[108:111]
  v_add_f32 v26, v26, v18
  v_add_f32 v27, v27, v19
  ds_read_b128 v[8:11], v7 offset:4096
  s_waitcnt vmcnt(11)
  v_mfma_f32_16x16x32_bf16 v[96:99], v[72:75], a[96:99], v[96:99]
  s_setprio 1
  ds_read_b128 v[12:15], v7 offset:5120
  ds_read_b128 v[16:19], v7 offset:6144
  ds_read_b128 v[20:23], v7 offset:7168
  v_mfma_f32_16x16x32_bf16 v[100:103], v[72:75], a[100:103], v[100:103]
  s_waitcnt lgkmcnt(2)
  v_mfma_f32_16x16x32_bf16 v[104:107], v[72:75], a[104:107], v[104:107]
  v_add_f32 v8, v8, v12
  v_add_f32 v9, v9, v13
  v_add_f32 v10, v10, v14
  v_mfma_f32_16x16x32_bf16 v[108:111], v[72:75], a[108:111], v[108:111]
  v_add_f32 v11, v11, v15
  v_add_f32 v24, v24, v8
  v_add_f32 v25, v25, v9
  s_waitcnt vmcnt(10)
  v_mfma_f32_16x16x32_bf16 v[96:99], v[76:79], a[112:115], v[96:99]
  s_setprio 0
  v_add_f32 v26, v26, v10
  v_add_f32 v27, v27, v11
  s_waitcnt lgkmcnt(0)
  v_mfma_f32_16x16x32_bf16 v[100:103], v[76:79], a[116:119], v[100:103]
  v_add_f32 v16, v16, v20
  v_add_f32 v17, v17, v21
  v_add_f32 v18, v18, v22
  v_mfma_f32_16x16x32_bf16 v[104:107], v[76:79], a[120:123], v[104:107]
  v_add_f32 v19, v19, v23
  v_add_f32 v24, v24, v16
  v_add_f32 v25, v25, v17
  v_mfma_f32_16x16x32_bf16 v[108:111], v[76:79], a[124:127], v[108:111]
  v_add_f32 v26, v26, v18
  v_add_f32 v27, v27, v19
  ds_read_b128 v[8:11], v7 offset:32768
  ds_write_b128 v5, v[96:99] offset:0
  ds_write_b128 v5, v[100:103] offset:8192
  ds_write_b128 v5, v[104:107] offset:16384
  s_nop 1
  ds_write_b128 v5, v[108:111] offset:24576
  s_waitcnt lgkmcnt(0)
  s_barrier
  ds_read_b128 v[12:15], v7 offset:33792
  ds_read_b128 v[16:19], v7 offset:34816
  ds_read_b128 v[20:23], v7 offset:35840
  s_waitcnt lgkmcnt(2)
  v_add_f32 v28, v8, v12
  v_add_f32 v29, v9, v13
  v_add_f32 v30, v10, v14
  v_add_f32 v31, v11, v15
  s_waitcnt lgkmcnt(0)
  v_add_f32 v16, v16, v20
  v_add_f32 v17, v17, v21
  v_add_f32 v18, v18, v22
  v_add_f32 v19, v19, v23
  v_add_f32 v28, v28, v16
  v_add_f32 v29, v29, v17
  v_add_f32 v30, v30, v18
  v_add_f32 v31, v31, v19
  ds_read_b128 v[8:11], v7 offset:36864
  ds_read_b128 v[12:15], v7 offset:37888
  ds_read_b128 v[16:19], v7 offset:38912
  ds_read_b128 v[20:23], v7 offset:39936
  s_waitcnt lgkmcnt(2)
  v_add_f32 v8, v8, v12
  v_add_f32 v9, v9, v13
  v_add_f32 v10, v10, v14
  v_add_f32 v11, v11, v15
  v_add_f32 v28, v28, v8
  v_add_f32 v29, v29, v9
  v_add_f32 v30, v30, v10
  v_add_f32 v31, v31, v11
  s_waitcnt lgkmcnt(0)
  v_add_f32 v16, v16, v20
  v_add_f32 v17, v17, v21
  v_add_f32 v18, v18, v22
  v_add_f32 v19, v19, v23
  v_add_f32 v28, v28, v16
  v_add_f32 v29, v29, v17
  v_add_f32 v30, v30, v18
  v_add_f32 v31, v31, v19
  v_add_f32 v24, v24, v1
  v_add_f32 v25, v25, v1
  v_add_f32 v26, v26, v1
  v_add_f32 v27, v27, v1
  v_add_f32 v28, v28, v1
  v_add_f32 v29, v29, v1
  v_add_f32 v30, v30, v1
  v_add_f32 v31, v31, v1
  v_lshlrev_b32 v16, 16, v32
  v_and_b32 v17, s58, v32
  v_lshlrev_b32 v18, 16, v33
  v_and_b32 v19, s58, v33
  v_lshlrev_b32 v20, 16, v34
  v_and_b32 v21, s58, v34
  v_lshlrev_b32 v22, 16, v35
  v_and_b32 v23, s58, v35
  v_mul_f32 v24, v24, v16
  v_mul_f32 v25, v25, v17
  v_mul_f32 v26, v26, v18
  v_mul_f32 v27, v27, v19
  v_mul_f32 v28, v28, v20
  v_mul_f32 v29, v29, v21
  v_mul_f32 v30, v30, v22
  v_mul_f32 v31, v31, v23
  v_cvt_pk_bf16_f32 v32, v24, v25
  v_cvt_pk_bf16_f32 v33, v26, v27
  v_cvt_pk_bf16_f32 v34, v28, v29
  v_cvt_pk_bf16_f32 v35, v30, v31
  v_and_b32 v34, s59, v34
  v_and_b32 v35, s59, v35
  buffer_store_dwordx4 v[32:35], v3, s[16:19], s44 offen offset:2048 sc1
  s_setprio 0
  s_branch kf_kernel_g33
kf_kernel_hi103:
  v_add_u32 v38, 0x10000, v7
  s_mul_i32 s42, s37, 6144
  s_add_u32 s42, s42, 139264
  v_add_u32 v39, s42, v3
  s_setprio 3
  s_waitcnt vmcnt(4)
  v_mfma_f32_16x16x32_bf16 v[96:99], v[56:59], a[0:3], 0
  v_mfma_f32_16x16x32_bf16 v[100:103], v[56:59], a[4:7], 0
  s_add_u32 s56, s56, 4096
  buffer_load_dwordx4 v[72:75], v3, s[8:11], s56 offen offset:0
  s_mov_b64 exec, 1
  buffer_store_dword v10, off, s[68:71], s49 sc1
  s_mov_b64 exec, -1
  v_mfma_f32_16x16x32_bf16 v[104:107], v[56:59], a[8:11], 0
  v_mfma_f32_16x16x32_bf16 v[108:111], v[56:59], a[12:15], 0
  buffer_load_dwordx4 v[76:79], v3, s[8:11], s56 offen offset:1024
  s_waitcnt vmcnt(6)
  v_mfma_f32_16x16x32_bf16 v[96:99], v[60:63], a[16:19], v[96:99]
  v_mfma_f32_16x16x32_bf16 v[100:103], v[60:63], a[20:23], v[100:103]
  buffer_load_dwordx4 v[80:83], v3, s[8:11], s56 offen offset:2048
  v_mfma_f32_16x16x32_bf16 v[104:107], v[60:63], a[24:27], v[104:107]
  v_mfma_f32_16x16x32_bf16 v[108:111], v[60:63], a[28:31], v[108:111]
  buffer_load_dwordx4 v[84:87], v3, s[8:11], s56 offen offset:3072
  s_waitcnt vmcnt(7)
  v_mfma_f32_16x16x32_bf16 v[96:99], v[64:67], a[32:35], v[96:99]
  v_mfma_f32_16x16x32_bf16 v[100:103], v[64:67], a[36:39], v[100:103]
  s_add_u32 s56, s56, 4096
  buffer_load_dwordx4 v[88:91], v3, s[8:11], s56 offen offset:0
  v_mfma_f32_16x16x32_bf16 v[104:107], v[64:67], a[40:43], v[104:107]
  v_mfma_f32_16x16x32_bf16 v[108:111], v[64:67], a[44:47], v[108:111]
  buffer_load_dwordx4 v[92:95], v3, s[8:11], s56 offen offset:1024
  s_waitcnt vmcnt(8)
  v_mfma_f32_16x16x32_bf16 v[96:99], v[68:71], a[48:51], v[96:99]
  v_mfma_f32_16x16x32_bf16 v[100:103], v[68:71], a[52:55], v[100:103]
  buffer_load_dwordx4 v[56:59], v3, s[8:11], s56 offen offset:2048
  v_mfma_f32_16x16x32_bf16 v[104:107], v[68:71], a[56:59], v[104:107]
  v_mfma_f32_16x16x32_bf16 v[108:111], v[68:71], a[60:63], v[108:111]
  buffer_load_dwordx4 v[60:63], v3, s[8:11], s56 offen offset:3072
  s_waitcnt vmcnt(8)
  v_mfma_f32_16x16x32_bf16 v[96:99], v[72:75], a[64:67], v[96:99]
  v_mfma_f32_16x16x32_bf16 v[100:103], v[72:75], a[68:71], v[100:103]
  s_add_u32 s56, s56, 4096
  buffer_load_dwordx4 v[64:67], v3, s[8:11], s56 offen offset:0
  v_mfma_f32_16x16x32_bf16 v[104:107], v[72:75], a[72:75], v[104:107]
  v_mfma_f32_16x16x32_bf16 v[108:111], v[72:75], a[76:79], v[108:111]
  buffer_load_dwordx4 v[68:71], v3, s[8:11], s56 offen offset:1024
  s_setprio 2
  s_waitcnt vmcnt(8)
  v_mfma_f32_16x16x32_bf16 v[96:99], v[76:79], a[80:83], v[96:99]
  v_mfma_f32_16x16x32_bf16 v[100:103], v[76:79], a[84:87], v[100:103]
  buffer_load_dwordx4 v[72:75], v3, s[8:11], s56 offen offset:2048
  v_mfma_f32_16x16x32_bf16 v[104:107], v[76:79], a[88:91], v[104:107]
  v_mfma_f32_16x16x32_bf16 v[108:111], v[76:79], a[92:95], v[108:111]
  buffer_load_dwordx4 v[76:79], v3, s[8:11], s56 offen offset:3072
  s_waitcnt vmcnt(9)
  v_mfma_f32_16x16x32_bf16 v[96:99], v[80:83], a[96:99], v[96:99]
  v_mfma_f32_16x16x32_bf16 v[100:103], v[80:83], a[100:103], v[100:103]
  v_mfma_f32_16x16x32_bf16 v[104:107], v[80:83], a[104:107], v[104:107]
  v_mfma_f32_16x16x32_bf16 v[108:111], v[80:83], a[108:111], v[108:111]
  s_add_u32 s56, s56, 4096
  buffer_load_dwordx4 v[80:83], v3, s[8:11], s56 offen offset:0
  s_waitcnt vmcnt(9)
  v_mfma_f32_16x16x32_bf16 v[96:99], v[84:87], a[112:115], v[96:99]
  v_mfma_f32_16x16x32_bf16 v[100:103], v[84:87], a[116:119], v[100:103]
  v_mfma_f32_16x16x32_bf16 v[104:107], v[84:87], a[120:123], v[104:107]
  v_mfma_f32_16x16x32_bf16 v[108:111], v[84:87], a[124:127], v[108:111]
  buffer_load_dwordx4 v[84:87], v3, s[8:11], s56 offen offset:1024
  s_waitcnt vmcnt(9)
  v_mfma_f32_16x16x32_bf16 v[112:115], v[88:91], a[0:3], 0
  v_mfma_f32_16x16x32_bf16 v[116:119], v[88:91], a[4:7], 0
  v_mfma_f32_16x16x32_bf16 v[120:123], v[88:91], a[8:11], 0
  v_mfma_f32_16x16x32_bf16 v[124:127], v[88:91], a[12:15], 0
  buffer_load_dwordx4 v[88:91], v3, s[8:11], s56 offen offset:2048
  ds_write_b128 v4, v[96:99] offset:0
  s_waitcnt vmcnt(9)
  v_mfma_f32_16x16x32_bf16 v[112:115], v[92:95], a[16:19], v[112:115]
  v_mfma_f32_16x16x32_bf16 v[116:119], v[92:95], a[20:23], v[116:119]
  ds_write_b128 v4, v[100:103] offset:8192
  v_mfma_f32_16x16x32_bf16 v[120:123], v[92:95], a[24:27], v[120:123]
  v_mfma_f32_16x16x32_bf16 v[124:127], v[92:95], a[28:31], v[124:127]
  buffer_load_dwordx4 v[92:95], v3, s[8:11], s56 offen offset:3072
  ds_write_b128 v4, v[104:107] offset:16384
  s_setprio 1
  s_waitcnt vmcnt(9)
  v_mfma_f32_16x16x32_bf16 v[112:115], v[56:59], a[32:35], v[112:115]
  v_lshlrev_b32 v1, 16, v1
  v_mfma_f32_16x16x32_bf16 v[116:119], v[56:59], a[36:39], v[116:119]
  ds_write_b128 v4, v[108:111] offset:24576
  v_mfma_f32_16x16x32_bf16 v[120:123], v[56:59], a[40:43], v[120:123]
  v_mfma_f32_16x16x32_bf16 v[124:127], v[56:59], a[44:47], v[124:127]
  s_add_u32 s56, s56, 4096
  buffer_load_dwordx4 v[56:59], v3, s[8:11], s56 offen offset:0
  s_waitcnt vmcnt(9)
  v_mfma_f32_16x16x32_bf16 v[112:115], v[60:63], a[48:51], v[112:115]
  v_mfma_f32_16x16x32_bf16 v[116:119], v[60:63], a[52:55], v[116:119]
  v_mfma_f32_16x16x32_bf16 v[120:123], v[60:63], a[56:59], v[120:123]
  v_mfma_f32_16x16x32_bf16 v[124:127], v[60:63], a[60:63], v[124:127]
  buffer_load_dwordx4 v[60:63], v3, s[8:11], s56 offen offset:1024
  s_waitcnt vmcnt(9)
  v_mfma_f32_16x16x32_bf16 v[112:115], v[64:67], a[64:67], v[112:115]
  v_mfma_f32_16x16x32_bf16 v[116:119], v[64:67], a[68:71], v[116:119]
  v_mfma_f32_16x16x32_bf16 v[120:123], v[64:67], a[72:75], v[120:123]
  v_mfma_f32_16x16x32_bf16 v[124:127], v[64:67], a[76:79], v[124:127]
  buffer_load_dwordx4 v[64:67], v3, s[8:11], s56 offen offset:2048
  s_waitcnt vmcnt(9)
  v_mfma_f32_16x16x32_bf16 v[112:115], v[68:71], a[80:83], v[112:115]
  v_mfma_f32_16x16x32_bf16 v[116:119], v[68:71], a[84:87], v[116:119]
  v_mfma_f32_16x16x32_bf16 v[120:123], v[68:71], a[88:91], v[120:123]
  v_mfma_f32_16x16x32_bf16 v[124:127], v[68:71], a[92:95], v[124:127]
  buffer_load_dwordx4 v[68:71], v3, s[8:11], s56 offen offset:3072
  s_waitcnt vmcnt(9)
  v_mfma_f32_16x16x32_bf16 v[112:115], v[72:75], a[96:99], v[112:115]
  v_mfma_f32_16x16x32_bf16 v[116:119], v[72:75], a[100:103], v[116:119]
  v_mfma_f32_16x16x32_bf16 v[120:123], v[72:75], a[104:107], v[120:123]
  v_mfma_f32_16x16x32_bf16 v[124:127], v[72:75], a[108:111], v[124:127]
  s_add_u32 s56, s56, 4096
  buffer_load_dwordx4 v[72:75], v3, s[8:11], s56 offen offset:0
  s_setprio 0
  s_waitcnt vmcnt(9)
  v_mfma_f32_16x16x32_bf16 v[112:115], v[76:79], a[112:115], v[112:115]
  v_mfma_f32_16x16x32_bf16 v[116:119], v[76:79], a[116:119], v[116:119]
  v_mfma_f32_16x16x32_bf16 v[120:123], v[76:79], a[120:123], v[120:123]
  v_mfma_f32_16x16x32_bf16 v[124:127], v[76:79], a[124:127], v[124:127]
  buffer_load_dwordx4 v[76:79], v3, s[8:11], s56 offen offset:1024
  s_waitcnt vmcnt(9)
  v_mfma_f32_16x16x32_bf16 v[96:99], v[80:83], a[0:3], 0
  v_mfma_f32_16x16x32_bf16 v[100:103], v[80:83], a[4:7], 0
  v_mfma_f32_16x16x32_bf16 v[104:107], v[80:83], a[8:11], 0
  v_mfma_f32_16x16x32_bf16 v[108:111], v[80:83], a[12:15], 0
  buffer_load_dwordx4 v[80:83], v3, s[8:11], s56 offen offset:2048
  ds_write_b128 v4, v[112:115] offset:32768
  s_waitcnt vmcnt(9)
  v_mfma_f32_16x16x32_bf16 v[96:99], v[84:87], a[16:19], v[96:99]
  buffer_load_dword v9, v8, s[68:71], s48 offen sc1
  v_mfma_f32_16x16x32_bf16 v[100:103], v[84:87], a[20:23], v[100:103]
  ds_write_b128 v4, v[116:119] offset:40960
  v_mfma_f32_16x16x32_bf16 v[104:107], v[84:87], a[24:27], v[104:107]
  v_mfma_f32_16x16x32_bf16 v[108:111], v[84:87], a[28:31], v[108:111]
  buffer_load_dwordx4 v[84:87], v3, s[8:11], s56 offen offset:3072
  ds_write_b128 v4, v[120:123] offset:49152
  s_waitcnt vmcnt(10)
  v_mfma_f32_16x16x32_bf16 v[96:99], v[88:91], a[32:35], v[96:99]
  v_mfma_f32_16x16x32_bf16 v[100:103], v[88:91], a[36:39], v[100:103]
  ds_write_b128 v4, v[124:127] offset:57344
  v_mfma_f32_16x16x32_bf16 v[104:107], v[88:91], a[40:43], v[104:107]
  v_mfma_f32_16x16x32_bf16 v[108:111], v[88:91], a[44:47], v[108:111]
  s_add_u32 s56, s56, 4096
  buffer_load_dwordx4 v[88:91], v3, s[8:11], s56 offen offset:0
  s_waitcnt vmcnt(10)
  v_mfma_f32_16x16x32_bf16 v[96:99], v[92:95], a[48:51], v[96:99]
  v_mfma_f32_16x16x32_bf16 v[100:103], v[92:95], a[52:55], v[100:103]
  v_mfma_f32_16x16x32_bf16 v[104:107], v[92:95], a[56:59], v[104:107]
  v_mfma_f32_16x16x32_bf16 v[108:111], v[92:95], a[60:63], v[108:111]
  buffer_load_dwordx4 v[92:95], v3, s[8:11], s56 offen offset:1024
  s_waitcnt vmcnt(10)
  v_mfma_f32_16x16x32_bf16 v[96:99], v[56:59], a[64:67], v[96:99]
  s_waitcnt lgkmcnt(0)
  s_barrier
  s_setprio 3
  v_mfma_f32_16x16x32_bf16 v[100:103], v[56:59], a[68:71], v[100:103]
  v_mfma_f32_16x16x32_bf16 v[104:107], v[56:59], a[72:75], v[104:107]
  v_mfma_f32_16x16x32_bf16 v[108:111], v[56:59], a[76:79], v[108:111]
  buffer_load_dwordx4 v[56:59], v3, s[8:11], s56 offen offset:2048
  s_waitcnt vmcnt(10)
  v_mfma_f32_16x16x32_bf16 v[96:99], v[60:63], a[80:83], v[96:99]
  s_waitcnt vmcnt(4)
  v_cmp_ne_u32 vcc, 2, v9
  s_cbranch_vccz kf_kernel_ld107
  s_mov_b32 s43, 400000
kf_kernel_lp106:
  buffer_load_dword v9, v8, s[68:71], s48 offen sc1
  s_waitcnt vmcnt(0)
  v_cmp_ne_u32 vcc, 2, v9
  s_cbranch_vccz kf_kernel_ld107
  s_sub_u32 s43, s43, 1
  s_cmp_lg_u32 s43, 0
  s_cbranch_scc1 kf_kernel_lp106
kf_kernel_ld107:
  v_mfma_f32_16x16x32_bf16 v[100:103], v[60:63], a[84:87], v[100:103]
  v_mfma_f32_16x16x32_bf16 v[104:107], v[60:63], a[88:91], v[104:107]
  v_mfma_f32_16x16x32_bf16 v[108:111], v[60:63], a[92:95], v[108:111]
  buffer_load_dwordx4 v[60:63], v3, s[8:11], s56 offen offset:3072
  v_mfma_f32_16x16x32_bf16 v[96:99], v[64:67], a[96:99], v[96:99]
  v_mfma_f32_16x16x32_bf16 v[100:103], v[64:67], a[100:103], v[100:103]
  v_mfma_f32_16x16x32_bf16 v[104:107], v[64:67], a[104:107], v[104:107]
  v_mfma_f32_16x16x32_bf16 v[108:111], v[64:67], a[108:111], v[108:111]
  s_add_u32 s56, s56, 4096
  buffer_load_dwordx4 v[64:67], v3, s[8:11], s56 offen offset:0
  v_mfma_f32_16x16x32_bf16 v[96:99], v[68:71], a[112:115], v[96:99]
  v_mfma_f32_16x16x32_bf16 v[100:103], v[68:71], a[116:119], v[100:103]
  v_mfma_f32_16x16x32_bf16 v[104:107], v[68:71], a[120:123], v[104:107]
  v_mfma_f32_16x16x32_bf16 v[108:111], v[68:71], a[124:127], v[108:111]
  buffer_load_dwordx4 v[68:71], v3, s[8:11], s56 offen offset:1024
  v_mfma_f32_16x16x32_bf16 v[112:115], v[72:75], a[0:3], 0
  s_setprio 2
  v_mfma_f32_16x16x32_bf16 v[116:119], v[72:75], a[4:7], 0
  buffer_load_dwordx4 v[32:35], v3, s[12:15], s44 offen offset:1024
  v_mfma_f32_16x16x32_bf16 v[120:123], v[72:75], a[8:11], 0
  v_mfma_f32_16x16x32_bf16 v[124:127], v[72:75], a[12:15], 0
  buffer_load_dwordx4 v[72:75], v3, s[8:11], s56 offen offset:2048
  ds_write_b128 v5, v[96:99] offset:0
  v_mfma_f32_16x16x32_bf16 v[112:115], v[76:79], a[16:19], v[112:115]
  v_mfma_f32_16x16x32_bf16 v[116:119], v[76:79], a[20:23], v[116:119]
  ds_write_b128 v5, v[100:103] offset:8192
  v_mfma_f32_16x16x32_bf16 v[120:123], v[76:79], a[24:27], v[120:123]
  v_mfma_f32_16x16x32_bf16 v[124:127], v[76:79], a[28:31], v[124:127]
  buffer_load_dwordx4 v[76:79], v3, s[8:11], s56 offen offset:3072
  ds_write_b128 v5, v[104:107] offset:16384
  v_mfma_f32_16x16x32_bf16 v[112:115], v[80:83], a[32:35], v[112:115]
  v_mfma_f32_16x16x32_bf16 v[116:119], v[80:83], a[36:39], v[116:119]
  ds_write_b128 v5, v[108:111] offset:24576
  v_mfma_f32_16x16x32_bf16 v[120:123], v[80:83], a[40:43], v[120:123]
  v_mfma_f32_16x16x32_bf16 v[124:127], v[80:83], a[44:47], v[124:127]
  s_add_u32 s56, s56, 4096
  buffer_load_dwordx4 v[80:83], v3, s[8:11], s56 offen offset:0
  s_waitcnt vmcnt(10)
  v_mfma_f32_16x16x32_bf16 v[112:115], v[84:87], a[48:51], v[112:115]
  v_mfma_f32_16x16x32_bf16 v[116:119], v[84:87], a[52:55], v[116:119]
  v_mfma_f32_16x16x32_bf16 v[120:123], v[84:87], a[56:59], v[120:123]
  v_mfma_f32_16x16x32_bf16 v[124:127], v[84:87], a[60:63], v[124:127]
  buffer_load_dwordx4 v[84:87], v3, s[8:11], s56 offen offset:1024
  s_waitcnt vmcnt(10)
  v_mfma_f32_16x16x32_bf16 v[112:115], v[88:91], a[64:67], v[112:115]
  s_setprio 1
  v_mfma_f32_16x16x32_bf16 v[116:119], v[88:91], a[68:71], v[116:119]
  v_mfma_f32_16x16x32_bf16 v[120:123], v[88:91], a[72:75], v[120:123]
  v_mfma_f32_16x16x32_bf16 v[124:127], v[88:91], a[76:79], v[124:127]
  buffer_load_dwordx4 v[88:91], v3, s[8:11], s56 offen offset:2048
  s_waitcnt vmcnt(10)
  v_mfma_f32_16x16x32_bf16 v[112:115], v[92:95], a[80:83], v[112:115]
  v_mfma_f32_16x16x32_bf16 v[116:119], v[92:95], a[84:87], v[116:119]
  v_mfma_f32_16x16x32_bf16 v[120:123], v[92:95], a[88:91], v[120:123]
  v_mfma_f32_16x16x32_bf16 v[124:127], v[92:95], a[92:95], v[124:127]
  buffer_load_dwordx4 v[92:95], v3, s[8:11], s56 offen offset:3072
  s_waitcnt vmcnt(10)
  v_mfma_f32_16x16x32_bf16 v[112:115], v[56:59], a[96:99], v[112:115]
  v_mfma_f32_16x16x32_bf16 v[116:119], v[56:59], a[100:103], v[116:119]
  v_mfma_f32_16x16x32_bf16 v[120:123], v[56:59], a[104:107], v[120:123]
  v_mfma_f32_16x16x32_bf16 v[124:127], v[56:59], a[108:111], v[124:127]
  s_add_u32 s56, s56, 4096
  s_cmp_eq_u32 s36, 7
  s_cselect_b32 s56, 0x7f000000, s56
  buffer_load_dwordx4 v[56:59], v3, s[8:11], s56 offen offset:0
  s_waitcnt vmcnt(10)
  v_mfma_f32_16x16x32_bf16 v[112:115], v[60:63], a[112:115], v[112:115]
  v_mfma_f32_16x16x32_bf16 v[116:119], v[60:63], a[116:119], v[116:119]
  v_mfma_f32_16x16x32_bf16 v[120:123], v[60:63], a[120:123], v[120:123]
  v_mfma_f32_16x16x32_bf16 v[124:127], v[60:63], a[124:127], v[124:127]
  buffer_load_dwordx4 v[60:63], v3, s[8:11], s56 offen offset:1024
  s_waitcnt vmcnt(10)
  v_mfma_f32_16x16x32_bf16 v[96:99], v[64:67], a[0:3], 0
  s_setprio 0
  v_mfma_f32_16x16x32_bf16 v[100:103], v[64:67], a[4:7], 0
  v_mfma_f32_16x16x32_bf16 v[104:107], v[64:67], a[8:11], 0
  v_mfma_f32_16x16x32_bf16 v[108:111], v[64:67], a[12:15], 0
  buffer_load_dwordx4 v[64:67], v3, s[8:11], s56 offen offset:2048
  ds_write_b128 v5, v[112:115] offset:32768
  s_waitcnt vmcnt(10)
  v_mfma_f32_16x16x32_bf16 v[96:99], v[68:71], a[16:19], v[96:99]
  v_mfma_f32_16x16x32_bf16 v[100:103], v[68:71], a[20:23], v[100:103]
  ds_write_b128 v5, v[116:119] offset:40960
  v_mfma_f32_16x16x32_bf16 v[104:107], v[68:71], a[24:27], v[104:107]
  v_mfma_f32_16x16x32_bf16 v[108:111], v[68:71], a[28:31], v[108:111]
  buffer_load_dwordx4 v[68:71], v3, s[8:11], s56 offen offset:3072
  ds_write_b128 v5, v[120:123] offset:49152
  s_waitcnt vmcnt(9)
  v_mfma_f32_16x16x32_bf16 v[96:99], v[72:75], a[32:35], v[96:99]
  v_mfma_f32_16x16x32_bf16 v[100:103], v[72:75], a[36:39], v[100:103]
  ds_write_b128 v5, v[124:127] offset:57344
  v_mfma_f32_16x16x32_bf16 v[104:107], v[72:75], a[40:43], v[104:107]
  v_mfma_f32_16x16x32_bf16 v[108:111], v[72:75], a[44:47], v[108:111]
  s_add_u32 s56, s56, 4096
  buffer_load_dwordx4 v[72:75], v3, s[8:11], s56 offen offset:0
  s_waitcnt vmcnt(9)
  v_mfma_f32_16x16x32_bf16 v[96:99], v[76:79], a[48:51], v[96:99]
  v_mfma_f32_16x16x32_bf16 v[100:103], v[76:79], a[52:55], v[100:103]
  v_mfma_f32_16x16x32_bf16 v[104:107], v[76:79], a[56:59], v[104:107]
  v_mfma_f32_16x16x32_bf16 v[108:111], v[76:79], a[60:63], v[108:111]
  buffer_load_dwordx4 v[76:79], v3, s[8:11], s56 offen offset:1024
  s_waitcnt vmcnt(9)
  v_mfma_f32_16x16x32_bf16 v[96:99], v[80:83], a[64:67], v[96:99]
  s_waitcnt lgkmcnt(0)
  s_barrier
  s_setprio 3
  v_mfma_f32_16x16x32_bf16 v[100:103], v[80:83], a[68:71], v[100:103]
  ds_read_b128 v[8:11], v38 offset:0
  ds_read_b128 v[12:15], v38 offset:1024
  ds_read_b128 v[16:19], v38 offset:2048
  v_mfma_f32_16x16x32_bf16 v[104:107], v[80:83], a[72:75], v[104:107]
  ds_read_b128 v[20:23], v38 offset:3072
  v_mfma_f32_16x16x32_bf16 v[108:111], v[80:83], a[76:79], v[108:111]
  buffer_load_dwordx4 v[80:83], v3, s[8:11], s56 offen offset:2048
  s_waitcnt lgkmcnt(2)
  v_add_f32 v24, v8, v12
  v_add_f32 v25, v9, v13
  s_waitcnt vmcnt(9)
  v_mfma_f32_16x16x32_bf16 v[96:99], v[84:87], a[80:83], v[96:99]
  v_add_f32 v26, v10, v14
  v_add_f32 v27, v11, v15
  s_waitcnt lgkmcnt(0)
  v_mfma_f32_16x16x32_bf16 v[100:103], v[84:87], a[84:87], v[100:103]
  v_add_f32 v16, v16, v20
  v_add_f32 v17, v17, v21
  v_add_f32 v18, v18, v22
  v_mfma_f32_16x16x32_bf16 v[104:107], v[84:87], a[88:91], v[104:107]
  v_add_f32 v19, v19, v23
  v_add_f32 v24, v24, v16
  v_add_f32 v25, v25, v17
  v_mfma_f32_16x16x32_bf16 v[108:111], v[84:87], a[92:95], v[108:111]
  buffer_load_dwordx4 v[84:87], v3, s[8:11], s56 offen offset:3072
  v_add_f32 v26, v26, v18
  v_add_f32 v27, v27, v19
  ds_read_b128 v[8:11], v38 offset:4096
  s_waitcnt vmcnt(9)
  v_mfma_f32_16x16x32_bf16 v[96:99], v[88:91], a[96:99], v[96:99]
  ds_read_b128 v[12:15], v38 offset:5120
  ds_read_b128 v[16:19], v38 offset:6144
  ds_read_b128 v[20:23], v38 offset:7168
  v_mfma_f32_16x16x32_bf16 v[100:103], v[88:91], a[100:103], v[100:103]
  s_waitcnt lgkmcnt(2)
  v_mfma_f32_16x16x32_bf16 v[104:107], v[88:91], a[104:107], v[104:107]
  v_add_f32 v8, v8, v12
  v_add_f32 v9, v9, v13
  v_add_f32 v10, v10, v14
  v_mfma_f32_16x16x32_bf16 v[108:111], v[88:91], a[108:111], v[108:111]
  s_add_u32 s56, s56, 4096
  buffer_load_dwordx4 v[88:91], v3, s[8:11], s56 offen offset:0
  v_add_f32 v11, v11, v15
  v_add_f32 v24, v24, v8
  v_add_f32 v25, v25, v9
  s_waitcnt vmcnt(9)
  v_mfma_f32_16x16x32_bf16 v[96:99], v[92:95], a[112:115], v[96:99]
  v_add_f32 v26, v26, v10
  v_add_f32 v27, v27, v11
  s_waitcnt lgkmcnt(0)
  v_mfma_f32_16x16x32_bf16 v[100:103], v[92:95], a[116:119], v[100:103]
  v_add_f32 v16, v16, v20
  v_add_f32 v17, v17, v21
  v_add_f32 v18, v18, v22
  v_mfma_f32_16x16x32_bf16 v[104:107], v[92:95], a[120:123], v[104:107]
  v_add_f32 v19, v19, v23
  v_add_f32 v24, v24, v16
  v_add_f32 v25, v25, v17
  v_mfma_f32_16x16x32_bf16 v[108:111], v[92:95], a[124:127], v[108:111]
  buffer_load_dwordx4 v[92:95], v3, s[8:11], s56 offen offset:1024
  v_add_f32 v26, v26, v18
  v_add_f32 v27, v27, v19
  ds_read_b128 v[8:11], v38 offset:32768
  s_waitcnt vmcnt(9)
  v_mfma_f32_16x16x32_bf16 v[112:115], v[56:59], a[0:3], 0
  s_setprio 2
  ds_read_b128 v[12:15], v38 offset:33792
  ds_read_b128 v[16:19], v38 offset:34816
  ds_read_b128 v[20:23], v38 offset:35840
  v_mfma_f32_16x16x32_bf16 v[116:119], v[56:59], a[4:7], 0
  s_waitcnt lgkmcnt(2)
  v_mfma_f32_16x16x32_bf16 v[120:123], v[56:59], a[8:11], 0
  v_add_f32 v28, v8, v12
  v_add_f32 v29, v9, v13
  v_add_f32 v30, v10, v14
  v_mfma_f32_16x16x32_bf16 v[124:127], v[56:59], a[12:15], 0
  buffer_load_dwordx4 v[56:59], v3, s[8:11], s56 offen offset:2048
  ds_write_b128 v4, v[96:99] offset:0
  v_add_f32 v31, v11, v15
  s_waitcnt lgkmcnt(1)
  v_add_f32 v16, v16, v20
  s_waitcnt vmcnt(9)
  v_mfma_f32_16x16x32_bf16 v[112:115], v[60:63], a[16:19], v[112:115]
  v_add_f32 v17, v17, v21
  v_add_f32 v18, v18, v22
  v_add_f32 v19, v19, v23
  v_mfma_f32_16x16x32_bf16 v[116:119], v[60:63], a[20:23], v[116:119]
  ds_write_b128 v4, v[100:103] offset:8192
  v_add_f32 v28, v28, v16
  v_add_f32 v29, v29, v17
  v_add_f32 v30, v30, v18
  v_mfma_f32_16x16x32_bf16 v[120:123], v[60:63], a[24:27], v[120:123]
  v_add_f32 v31, v31, v19
  ds_read_b128 v[8:11], v38 offset:36864
  ds_read_b128 v[12:15], v38 offset:37888
  v_mfma_f32_16x16x32_bf16 v[124:127], v[60:63], a[28:31], v[124:127]
  buffer_load_dwordx4 v[60:63], v3, s[8:11], s56 offen offset:3072
  ds_write_b128 v4, v[104:107] offset:16384
  ds_read_b128 v[16:19], v38 offset:38912
  ds_read_b128 v[20:23], v38 offset:39936
  s_waitcnt vmcnt(9)
  v_mfma_f32_16x16x32_bf16 v[112:115], v[64:67], a[32:35], v[112:115]
  s_waitcnt lgkmcnt(3)
  v_add_f32 v8, v8, v12
  v_mfma_f32_16x16x32_bf16 v[116:119], v[64:67], a[36:39], v[116:119]
  ds_write_b128 v4, v[108:111] offset:24576
  v_add_f32 v9, v9, v13
  v_add_f32 v10, v10, v14
  v_add_f32 v11, v11, v15
  v_mfma_f32_16x16x32_bf16 v[120:123], v[64:67], a[40:43], v[120:123]
  v_add_f32 v28, v28, v8
  v_add_f32 v29, v29, v9
  v_add_f32 v30, v30, v10
  v_mfma_f32_16x16x32_bf16 v[124:127], v[64:67], a[44:47], v[124:127]
  s_add_u32 s56, s56, 4096
  buffer_load_dwordx4 v[64:67], v3, s[8:11], s56 offen offset:0
  v_add_f32 v31, v31, v11
  s_waitcnt lgkmcnt(1)
  v_add_f32 v16, v16, v20
  s_waitcnt vmcnt(9)
  v_mfma_f32_16x16x32_bf16 v[112:115], v[68:71], a[48:51], v[112:115]
  v_add_f32 v17, v17, v21
  v_add_f32 v18, v18, v22
  v_add_f32 v19, v19, v23
  v_mfma_f32_16x16x32_bf16 v[116:119], v[68:71], a[52:55], v[116:119]
  v_add_f32 v28, v28, v16
  v_add_f32 v29, v29, v17
  v_add_f32 v30, v30, v18
  v_mfma_f32_16x16x32_bf16 v[120:123], v[68:71], a[56:59], v[120:123]
  v_add_f32 v31, v31, v19
  v_add_f32 v24, v24, v1
  v_mfma_f32_16x16x32_bf16 v[124:127], v[68:71], a[60:63], v[124:127]
  buffer_load_dwordx4 v[68:71], v3, s[8:11], s56 offen offset:1024
  v_add_f32 v25, v25, v1
  v_add_f32 v26, v26, v1
  v_add_f32 v27, v27, v1
  s_waitcnt vmcnt(9)
  v_mfma_f32_16x16x32_bf16 v[112:115], v[72:75], a[64:67], v[112:115]
  s_setprio 1
  v_add_f32 v28, v28, v1
  v_add_f32 v29, v29, v1
  v_add_f32 v30, v30, v1
  v_mfma_f32_16x16x32_bf16 v[116:119], v[72:75], a[68:71], v[116:119]
  v_add_f32 v31, v31, v1
  v_lshlrev_b32 v16, 16, v32
  v_and_b32 v17, s58, v32
  v_mfma_f32_16x16x32_bf16 v[120:123], v[72:75], a[72:75], v[120:123]
  v_lshlrev_b32 v18, 16, v33
  v_and_b32 v19, s58, v33
  v_lshlrev_b32 v20, 16, v34
  v_mfma_f32_16x16x32_bf16 v[124:127], v[72:75], a[76:79], v[124:127]
  buffer_load_dwordx4 v[72:75], v3, s[8:11], s56 offen offset:2048
  v_and_b32 v21, s58, v34
  v_lshlrev_b32 v22, 16, v35
  v_and_b32 v23, s58, v35
  s_waitcnt vmcnt(9)
  v_mfma_f32_16x16x32_bf16 v[112:115], v[76:79], a[80:83], v[112:115]
  v_mul_f32 v24, v24, v16
  v_mul_f32 v25, v25, v17
  v_mul_f32 v26, v26, v18
  v_mfma_f32_16x16x32_bf16 v[116:119], v[76:79], a[84:87], v[116:119]
  v_mul_f32 v27, v27, v19
  v_mul_f32 v28, v28, v20
  v_mul_f32 v29, v29, v21
  v_mfma_f32_16x16x32_bf16 v[120:123], v[76:79], a[88:91], v[120:123]
  v_mul_f32 v30, v30, v22
  v_mul_f32 v31, v31, v23
  v_cvt_pk_bf16_f32 v32, v24, v25
  v_mfma_f32_16x16x32_bf16 v[124:127], v[76:79], a[92:95], v[124:127]
  buffer_load_dwordx4 v[76:79], v3, s[8:11], s56 offen offset:3072
  v_cvt_pk_bf16_f32 v33, v26, v27
  v_cvt_pk_bf16_f32 v34, v28, v29
  v_cvt_pk_bf16_f32 v35, v30, v31
  s_waitcnt vmcnt(9)
  v_mfma_f32_16x16x32_bf16 v[112:115], v[80:83], a[96:99], v[112:115]
  buffer_store_dwordx4 v[32:35], v3, s[16:19], s44 offen offset:1024 sc1
  v_mfma_f32_16x16x32_bf16 v[116:119], v[80:83], a[100:103], v[116:119]
  v_mfma_f32_16x16x32_bf16 v[120:123], v[80:83], a[104:107], v[120:123]
  v_mfma_f32_16x16x32_bf16 v[124:127], v[80:83], a[108:111], v[124:127]
  s_waitcnt vmcnt(9)
  v_mfma_f32_16x16x32_bf16 v[112:115], v[84:87], a[112:115], v[112:115]
  v_mfma_f32_16x16x32_bf16 v[116:119], v[84:87], a[116:119], v[116:119]
  v_mfma_f32_16x16x32_bf16 v[120:123], v[84:87], a[120:123], v[120:123]
  buffer_load_dwordx2 v[36:37], v2, s[12:15], s46 offen offset:3072
  v_mfma_f32_16x16x32_bf16 v[124:127], v[84:87], a[124:127], v[124:127]
  s_waitcnt vmcnt(9)
  v_mfma_f32_16x16x32_bf16 v[96:99], v[88:91], a[0:3], 0
  s_setprio 0
  v_mfma_f32_16x16x32_bf16 v[100:103], v[88:91], a[4:7], 0
  v_mfma_f32_16x16x32_bf16 v[104:107], v[88:91], a[8:11], 0
  v_mfma_f32_16x16x32_bf16 v[108:111], v[88:91], a[12:15], 0
  ds_write_b128 v4, v[112:115] offset:32768
  s_waitcnt vmcnt(8)
  v_mfma_f32_16x16x32_bf16 v[96:99], v[92:95], a[16:19], v[96:99]
  s_add_u32 s60, s60, 4096
  buffer_load_dwordx4 a[16:19], v3, s[28:31], s60 offen offset:0
  v_mfma_f32_16x16x32_bf16 v[100:103], v[92:95], a[20:23], v[100:103]
  ds_write_b128 v4, v[116:119] offset:40960
  buffer_load_dwordx4 a[20:23], v3, s[28:31], s60 offen offset:1024
  v_mfma_f32_16x16x32_bf16 v[104:107], v[92:95], a[24:27], v[104:107]
  buffer_load_dwordx4 a[24:27], v3, s[28:31], s60 offen offset:2048
  v_mfma_f32_16x16x32_bf16 v[108:111], v[92:95], a[28:31], v[108:111]
  ds_write_b128 v4, v[120:123] offset:49152
  s_waitcnt vmcnt(10)
  v_mfma_f32_16x16x32_bf16 v[96:99], v[56:59], a[32:35], v[96:99]
  v_mfma_f32_16x16x32_bf16 v[100:103], v[56:59], a[36:39], v[100:103]
  ds_write_b128 v4, v[124:127] offset:57344
  v_mfma_f32_16x16x32_bf16 v[104:107], v[56:59], a[40:43], v[104:107]
  v_mfma_f32_16x16x32_bf16 v[108:111], v[56:59], a[44:47], v[108:111]
  s_waitcnt vmcnt(9)
  v_mfma_f32_16x16x32_bf16 v[96:99], v[60:63], a[48:51], v[96:99]
  v_mfma_f32_16x16x32_bf16 v[100:103], v[60:63], a[52:55], v[100:103]
  v_mfma_f32_16x16x32_bf16 v[104:107], v[60:63], a[56:59], v[104:107]
  v_mfma_f32_16x16x32_bf16 v[108:111], v[60:63], a[60:63], v[108:111]
  s_waitcnt vmcnt(8)
  v_mfma_f32_16x16x32_bf16 v[96:99], v[64:67], a[64:67], v[96:99]
  s_waitcnt lgkmcnt(0)
  s_barrier
  s_setprio 3
  v_mfma_f32_16x16x32_bf16 v[100:103], v[64:67], a[68:71], v[100:103]
  v_mfma_f32_16x16x32_bf16 v[104:107], v[64:67], a[72:75], v[104:107]
  v_mfma_f32_16x16x32_bf16 v[108:111], v[64:67], a[76:79], v[108:111]
  s_waitcnt vmcnt(7)
  v_mfma_f32_16x16x32_bf16 v[96:99], v[68:71], a[80:83], v[96:99]
  s_setprio 2
  v_mfma_f32_16x16x32_bf16 v[100:103], v[68:71], a[84:87], v[100:103]
  v_mfma_f32_16x16x32_bf16 v[104:107], v[68:71], a[88:91], v[104:107]
  v_mfma_f32_16x16x32_bf16 v[108:111], v[68:71], a[92:95], v[108:111]
  s_waitcnt vmcnt(6)
  v_mfma_f32_16x16x32_bf16 v[96:99], v[72:75], a[96:99], v[96:99]
  s_setprio 1
  v_mfma_f32_16x16x32_bf16 v[100:103], v[72:75], a[100:103], v[100:103]
  v_mfma_f32_16x16x32_bf16 v[104:107], v[72:75], a[104:107], v[104:107]
  v_mfma_f32_16x16x32_bf16 v[108:111], v[72:75], a[108:111], v[108:111]
  s_waitcnt vmcnt(5)
  v_mfma_f32_16x16x32_bf16 v[96:99], v[76:79], a[112:115], v[96:99]
  s_setprio 0
  v_mfma_f32_16x16x32_bf16 v[100:103], v[76:79], a[116:119], v[100:103]
  v_mfma_f32_16x16x32_bf16 v[104:107], v[76:79], a[120:123], v[104:107]
  v_mfma_f32_16x16x32_bf16 v[108:111], v[76:79], a[124:127], v[108:111]
  s_nop 3
  ds_write_b128 v5, v[96:99] offset:0
  s_nop 0
  ds_write_b128 v5, v[100:103] offset:8192
  ds_write_b128 v5, v[104:107] offset:16384
  ds_write_b128 v5, v[108:111] offset:24576
  s_waitcnt lgkmcnt(0)
  s_barrier
  ds_read_b128 v[8:11], v38 offset:0
  ds_read_b128 v[12:15], v38 offset:1024
  ds_read_b128 v[16:19], v38 offset:2048
  ds_read_b128 v[20:23], v38 offset:3072
  s_waitcnt lgkmcnt(2)
  v_add_f32 v24, v8, v12
  v_add_f32 v25, v9, v13
  v_add_f32 v26, v10, v14
  v_add_f32 v27, v11, v15
  s_waitcnt lgkmcnt(0)
  v_add_f32 v16, v16, v20
  v_add_f32 v17, v17, v21
  v_add_f32 v18, v18, v22
  v_add_f32 v19, v19, v23
  v_add_f32 v24, v24, v16
  v_add_f32 v25, v25, v17
  v_add_f32 v26, v26, v18
  v_add_f32 v27, v27, v19
  ds_read_b128 v[8:11], v38 offset:4096
  ds_read_b128 v[12:15], v38 offset:5120
  ds_read_b128 v[16:19], v38 offset:6144
  ds_read_b128 v[20:23], v38 offset:7168
  s_waitcnt lgkmcnt(2)
  v_add_f32 v8, v8, v12
  v_add_f32 v9, v9, v13
  v_add_f32 v10, v10, v14
  v_add_f32 v11, v11, v15
  v_add_f32 v24, v24, v8
  v_add_f32 v25, v25, v9
  v_add_f32 v26, v26, v10
  v_add_f32 v27, v27, v11
  s_waitcnt lgkmcnt(0)
  v_add_f32 v16, v16, v20
  v_add_f32 v17, v17, v21
  v_add_f32 v18, v18, v22
  v_add_f32 v19, v19, v23
  v_add_f32 v24, v24, v16
  v_add_f32 v25, v25, v17
  v_add_f32 v26, v26, v18
  v_add_f32 v27, v27, v19
  s_waitcnt vmcnt(3)
  v_add_f32 v24, v24, v1
  v_add_f32 v25, v25, v1
  v_add_f32 v26, v26, v1
  v_add_f32 v27, v27, v1
  v_lshlrev_b32 v16, 16, v36
  v_and_b32 v17, s58, v36
  v_lshlrev_b32 v18, 16, v37
  v_and_b32 v19, s58, v37
  v_mul_f32 v24, v24, v16
  v_mul_f32 v25, v25, v17
  v_mul_f32 v26, v26, v18
  v_mul_f32 v27, v27, v19
  v_cvt_pk_bf16_f32 v36, v24, v25
  v_cvt_pk_bf16_f32 v37, v26, v27
  buffer_store_dwordx2 v[36:37], v2, s[16:19], s46 offen offset:3072 sc1
  s_setprio 0
  s_branch kf_kernel_g33
kf_kernel_g33:
  s_lshl_b32 s42, s35, 10
  s_add_u32 s42, s42, 65536
  s_lshl_b32 s46, s36, 7
  s_add_u32 s46, s46, s42
  v_lshrrev_b32 v124, 4, v3
  v_lshlrev_b32 v124, 7, v124
  v_mov_b32 v125, 1
  s_waitcnt vmcnt(0)
  s_barrier
  s_cmp_lg_u32 s34, 0
  s_cbranch_scc1 kf_kernel_np2108
  s_mov_b64 exec, 1
  buffer_store_dword v125, v124, s[68:71], s46 offen sc1
  s_mov_b64 exec, -1
kf_kernel_np2108:
  s_cmp_ge_u32 s34, 4
  s_cbranch_scc1 kf_kernel_wh109
  s_branch kf_kernel_wx110
kf_kernel_wh109:
  buffer_load_dwordx4 a[28:31], v3, s[28:31], s60 offen offset:3072
  s_add_u32 s60, s60, 4096
  buffer_load_dwordx4 a[32:35], v3, s[28:31], s60 offen offset:0
  buffer_load_dwordx4 a[36:39], v3, s[28:31], s60 offen offset:1024
  buffer_load_dwordx4 a[40:43], v3, s[28:31], s60 offen offset:2048
  buffer_load_dwordx4 a[44:47], v3, s[28:31], s60 offen offset:3072
  s_add_u32 s60, s60, 4096
  buffer_load_dwordx4 a[48:51], v3, s[28:31], s60 offen offset:0
  buffer_load_dwordx4 a[52:55], v3, s[28:31], s60 offen offset:1024
  buffer_load_dwordx4 a[56:59], v3, s[28:31], s60 offen offset:2048
  buffer_load_dwordx2 a[60:61], v2, s[28:31], s60 offen offset:3072
  buffer_load_dwordx2 a[62:63], v2, s[28:31], s60 offen offset:3584
  s_add_u32 s60, s60, 4096
  buffer_load_dwordx2 a[64:65], v2, s[28:31], s60 offen offset:0
  buffer_load_dwordx2 a[66:67], v2, s[28:31], s60 offen offset:512
  buffer_load_dwordx2 a[68:69], v2, s[28:31], s60 offen offset:1024
kf_kernel_wx110:
  s_add_u32 s8, s40, 0xc00000
  s_addc_u32 s9, s41, 0
  s_mov_b32 s10, 0x400000
  s_mov_b32 s11, 0x00020000
  s_mov_b32 s12, s80
  s_mov_b32 s13, s81
  s_mov_b32 s14, 0x280000
  s_mov_b32 s15, 0x00020000
  s_lshl_b32 s44, s35, 3
  s_add_u32 s44, s44, s34
  s_lshl_b32 s44, s44, 14
  v_lshrrev_b32 v1, 4, v3
  v_and_b32 v6, 15, v1
  v_lshrrev_b32 v7, 4, v1
  s_lshr_b32 s45, s34, 1
  s_mul_i32 s45, s45, 40960
  s_and_b32 s46, s34, 1
  s_lshl_b32 s46, s46, 3
  v_add_u32 v8, 0, v1
  v_mul_u32_u24 v9, 3277, v8
  v_lshrrev_b32 v9, 16, v9
  v_mul_u32_u24 v10, 20, v9
  v_sub_u32 v10, v8, v10
  v_add_u32 v9, s46, v9
  v_add_u32 v11, v9, v10
  v_and_b32 v11, 15, v11
  v_lshlrev_b32 v11, 4, v11
  v_lshrrev_b32 v12, 2, v10
  v_lshl_add_u32 v11, v12, 13, v11
  v_and_b32 v12, 3, v10
  v_lshl_add_u32 v11, v12, 8, v11
  v_add_u32 v116, s45, v11
  v_lshrrev_b32 v11, 2, v9
  v_and_b32 v12, 3, v9
  v_lshl_add_u32 v11, v12, 8, v11
  v_mul_u32_u24 v11, 1280, v11
  v_lshl_add_u32 v120, v10, 3, v11
  v_add_u32 v8, 64, v1
  v_mul_u32_u24 v9, 3277, v8
  v_lshrrev_b32 v9, 16, v9
  v_mul_u32_u24 v10, 20, v9
  v_sub_u32 v10, v8, v10
  v_add_u32 v9, s46, v9
  v_add_u32 v11, v9, v10
  v_and_b32 v11, 15, v11
  v_lshlrev_b32 v11, 4, v11
  v_lshrrev_b32 v12, 2, v10
  v_lshl_add_u32 v11, v12, 13, v11
  v_and_b32 v12, 3, v10
  v_lshl_add_u32 v11, v12, 8, v11
  v_add_u32 v117, s45, v11
  v_lshrrev_b32 v11, 2, v9
  v_and_b32 v12, 3, v9
  v_lshl_add_u32 v11, v12, 8, v11
  v_mul_u32_u24 v11, 1280, v11
  v_lshl_add_u32 v121, v10, 3, v11
  v_add_u32 v8, 128, v1
  v_mul_u32_u24 v9, 3277, v8
  v_lshrrev_b32 v9, 16, v9
  v_mul_u32_u24 v10, 20, v9
  v_sub_u32 v10, v8, v10
  v_add_u32 v9, s46, v9
  v_add_u32 v11, v9, v10
  v_and_b32 v11, 15, v11
  v_lshlrev_b32 v11, 4, v11
  v_lshrrev_b32 v12, 2, v10
  v_lshl_add_u32 v11, v12, 13, v11
  v_and_b32 v12, 3, v10
  v_lshl_add_u32 v11, v12, 8, v11
  v_add_u32 v118, s45, v11
  v_lshrrev_b32 v11, 2, v9
  v_and_b32 v12, 3, v9
  v_lshl_add_u32 v11, v12, 8, v11
  v_mul_u32_u24 v11, 1280, v11
  v_lshl_add_u32 v122, v10, 3, v11
  v_mov_b32 v8, 0x7fffffff
  v_cmp_gt_u32 vcc, 32, v1
  s_nop 1
  v_cndmask_b32 v122, v8, v122, vcc
  s_lshl_b32 s47, s35, 3
  s_and_b32 s43, s34, 2
  s_lshl_b32 s43, s43, 1
  s_add_u32 s47, s47, s43
  s_and_b32 s43, s34, 4
  s_lshl_b32 s43, s43, 8
  s_add_u32 s47, s47, s43
  s_mul_i32 s47, s47, 1280
  s_mul_i32 s43, s36, 160
  s_add_u32 s47, s47, s43
  s_cmp_eq_u32 s34, 0
  s_cbranch_scc1 kf_kernel_nh111
  buffer_load_dwordx2 v[104:105], v120, s[12:15], s47 offen
  buffer_load_dwordx2 v[106:107], v121, s[12:15], s47 offen
  buffer_load_dwordx2 v[108:109], v122, s[12:15], s47 offen
kf_kernel_nh111:
  s_lshl_b32 s43, s34, 10
  v_add_u32 v8, v6, v7
  v_lshlrev_b32 v9, 8, v7
  v_add_u32 v9, s43, v9
  v_add_u32 v10, 0, v8
  v_and_b32 v10, 15, v10
  v_lshl_add_u32 v10, v10, 4, v9
  v_add_u32 v88, 0, v10
  v_add_u32 v93, 81920, v10
  v_add_u32 v10, 4, v8
  v_and_b32 v10, 15, v10
  v_lshl_add_u32 v10, v10, 4, v9
  v_add_u32 v89, 8192, v10
  v_add_u32 v94, 90112, v10
  v_add_u32 v10, 8, v8
  v_and_b32 v10, 15, v10
  v_lshl_add_u32 v10, v10, 4, v9
  v_add_u32 v90, 16384, v10
  v_add_u32 v95, 98304, v10
  v_add_u32 v10, 12, v8
  v_and_b32 v10, 15, v10
  v_lshl_add_u32 v10, v10, 4, v9
  v_add_u32 v91, 24576, v10
  v_add_u32 v96, 106496, v10
  v_add_u32 v10, 16, v8
  v_and_b32 v10, 15, v10
  v_lshl_add_u32 v10, v10, 4, v9
  v_add_u32 v92, 32768, v10
  v_add_u32 v97, 114688, v10
  s_cmp_lg_u32 s34, 0
  s_cbranch_scc1 kf_kernel_np3112
  s_mov_b64 exec, 0xff
  s_sleep 8
  s_mov_b32 s43, 400000
kf_kernel_lp113:
  buffer_load_dword v125, v124, s[68:71], s42 offen sc1
  s_waitcnt vmcnt(0)
  v_cmp_eq_u32 vcc, 0, v125
  s_cbranch_vccz kf_kernel_ld114
  s_sub_u32 s43, s43, 1
  s_cmp_lg_u32 s43, 0
  s_cbranch_scc1 kf_kernel_lp113
kf_kernel_ld114:
  s_mov_b64 exec, -1
  buffer_load_dwordx2 v[104:105], v120, s[12:15], s47 offen
  buffer_load_dwordx2 v[106:107], v121, s[12:15], s47 offen
  buffer_load_dwordx2 v[108:109], v122, s[12:15], s47 offen
kf_kernel_np3112:
  s_barrier
  s_cmp_eq_u32 s34, 7
  s_cselect_b32 s48, 0x7f000000, 0
  buffer_load_dwordx4 a[72:75], v3, s[8:11], s44 offen offset:0
  buffer_load_dwordx4 a[76:79], v3, s[8:11], s44 offen offset:1024
  buffer_load_dwordx4 a[80:83], v3, s[8:11], s44 offen offset:2048
  s_add_u32 s49, s44, s48
  buffer_load_dwordx2 a[84:85], v2, s[8:11], s49 offen offset:3072
  s_add_u32 s44, s44, 4096
  buffer_load_dwordx4 a[86:89], v3, s[8:11], s44 offen offset:0
  buffer_load_dwordx4 a[90:93], v3, s[8:11], s44 offen offset:1024
  buffer_load_dwordx4 a[94:97], v3, s[8:11], s44 offen offset:2048
  s_add_u32 s49, s44, s48
  buffer_load_dwordx2 a[98:99], v2, s[8:11], s49 offen offset:3072
  s_add_u32 s44, s44, 4096
  buffer_load_dwordx4 a[100:103], v3, s[8:11], s44 offen offset:0
  buffer_load_dwordx4 a[104:107], v3, s[8:11], s44 offen offset:1024
  buffer_load_dwordx4 a[108:111], v3, s[8:11], s44 offen offset:2048
  s_add_u32 s49, s44, s48
  buffer_load_dwordx2 a[112:113], v2, s[8:11], s49 offen offset:3072
  s_add_u32 s44, s44, 4096
  buffer_load_dwordx4 a[114:117], v3, s[8:11], s44 offen offset:0
  buffer_load_dwordx4 a[118:121], v3, s[8:11], s44 offen offset:1024
  buffer_load_dwordx4 a[122:125], v3, s[8:11], s44 offen offset:2048
  s_add_u32 s49, s44, s48
  buffer_load_dwordx2 a[126:127], v2, s[8:11], s49 offen offset:3072
  s_mov_b32 s16, s80
  s_mov_b32 s17, s81
  s_mov_b32 s18, 0x280000
  s_mov_b32 s19, 0x00020000
  s_waitcnt vmcnt(15)
  v_mfma_f32_16x16x32_bf16 v[8:11], v[40:43], a[72:75], 0
  v_mfma_f32_16x16x32_bf16 v[12:15], v[44:47], a[72:75], 0
  v_mfma_f32_16x16x32_bf16 v[16:19], v[48:51], a[72:75], 0
  v_mfma_f32_16x16x32_bf16 v[20:23], v[52:55], a[72:75], 0
  v_mfma_f32_16x16x32_bf16 v[24:27], a[16:19], a[72:75], 0
  s_waitcnt vmcnt(14)
  v_mfma_f32_16x16x32_bf16 v[8:11], a[20:23], a[76:79], v[8:11]
  v_mfma_f32_16x16x32_bf16 v[12:15], a[24:27], a[76:79], v[12:15]
  v_mfma_f32_16x16x32_bf16 v[16:19], a[28:31], a[76:79], v[16:19]
  v_mfma_f32_16x16x32_bf16 v[20:23], a[32:35], a[76:79], v[20:23]
  v_mfma_f32_16x16x32_bf16 v[24:27], a[36:39], a[76:79], v[24:27]
  s_waitcnt vmcnt(13)
  v_mfma_f32_16x16x32_bf16 v[8:11], a[40:43], a[80:83], v[8:11]
  v_mfma_f32_16x16x32_bf16 v[12:15], a[44:47], a[80:83], v[12:15]
  v_mfma_f32_16x16x32_bf16 v[16:19], a[48:51], a[80:83], v[16:19]
  v_mfma_f32_16x16x32_bf16 v[20:23], a[52:55], a[80:83], v[20:23]
  v_mfma_f32_16x16x32_bf16 v[24:27], a[56:59], a[80:83], v[24:27]
  s_waitcnt vmcnt(12)
  s_nop 0
  v_mfma_f32_16x16x16_bf16 v[8:11], a[60:61], a[84:85], v[8:11]
  v_mfma_f32_16x16x16_bf16 v[12:15], a[62:63], a[84:85], v[12:15]
  v_mfma_f32_16x16x16_bf16 v[16:19], a[64:65], a[84:85], v[16:19]
  v_mfma_f32_16x16x16_bf16 v[20:23], a[66:67], a[84:85], v[20:23]
  v_mfma_f32_16x16x16_bf16 v[24:27], a[68:69], a[84:85], v[24:27]
  s_waitcnt vmcnt(11)
  v_mfma_f32_16x16x32_bf16 v[56:59], v[40:43], a[86:89], 0
  v_mfma_f32_16x16x32_bf16 v[60:63], v[44:47], a[86:89], 0
  v_mfma_f32_16x16x32_bf16 v[64:67], v[48:51], a[86:89], 0
  ds_write_b128 v88, v[8:11] offset:0
  v_mfma_f32_16x16x32_bf16 v[68:71], v[52:55], a[86:89], 0
  v_mfma_f32_16x16x32_bf16 v[72:75], a[16:19], a[86:89], 0
  s_waitcnt vmcnt(10)
  v_mfma_f32_16x16x32_bf16 v[56:59], a[20:23], a[90:93], v[56:59]
  ds_write_b128 v89, v[12:15] offset:0
  v_mfma_f32_16x16x32_bf16 v[60:63], a[24:27], a[90:93], v[60:63]
  v_mfma_f32_16x16x32_bf16 v[64:67], a[28:31], a[90:93], v[64:67]
  v_mfma_f32_16x16x32_bf16 v[68:71], a[32:35], a[90:93], v[68:71]
  ds_write_b128 v90, v[16:19] offset:0
  v_mfma_f32_16x16x32_bf16 v[72:75], a[36:39], a[90:93], v[72:75]
  s_waitcnt vmcnt(9)
  v_mfma_f32_16x16x32_bf16 v[56:59], a[40:43], a[94:97], v[56:59]
  v_mfma_f32_16x16x32_bf16 v[60:63], a[44:47], a[94:97], v[60:63]
  ds_write_b128 v91, v[20:23] offset:0
  v_mfma_f32_16x16x32_bf16 v[64:67], a[48:51], a[94:97], v[64:67]
  v_mfma_f32_16x16x32_bf16 v[68:71], a[52:55], a[94:97], v[68:71]
  v_mfma_f32_16x16x32_bf16 v[72:75], a[56:59], a[94:97], v[72:75]
  ds_write_b128 v92, v[24:27] offset:0
  s_waitcnt vmcnt(8)
  v_mfma_f32_16x16x16_bf16 v[56:59], a[60:61], a[98:99], v[56:59]
  v_mfma_f32_16x16x16_bf16 v[60:63], a[62:63], a[98:99], v[60:63]
  v_mfma_f32_16x16x16_bf16 v[64:67], a[64:65], a[98:99], v[64:67]
  v_mfma_f32_16x16x16_bf16 v[68:71], a[66:67], a[98:99], v[68:71]
  v_mfma_f32_16x16x16_bf16 v[72:75], a[68:69], a[98:99], v[72:75]
  s_waitcnt vmcnt(7)
  v_mfma_f32_16x16x32_bf16 v[8:11], v[40:43], a[100:103], 0
  v_mfma_f32_16x16x32_bf16 v[12:15], v[44:47], a[100:103], 0
  v_mfma_f32_16x16x32_bf16 v[16:19], v[48:51], a[100:103], 0
  ds_write_b128 v88, v[56:59] offset:40960
  v_mfma_f32_16x16x32_bf16 v[20:23], v[52:55], a[100:103], 0
  v_mfma_f32_16x16x32_bf16 v[24:27], a[16:19], a[100:103], 0
  s_waitcnt vmcnt(6)
  v_mfma_f32_16x16x32_bf16 v[8:11], a[20:23], a[104:107], v[8:11]
  ds_write_b128 v89, v[60:63] offset:40960
  v_mfma_f32_16x16x32_bf16 v[12:15], a[24:27], a[104:107], v[12:15]
  v_mfma_f32_16x16x32_bf16 v[16:19], a[28:31], a[104:107], v[16:19]
  v_mfma_f32_16x16x32_bf16 v[20:23], a[32:35], a[104:107], v[20:23]
  ds_write_b128 v90, v[64:67] offset:40960
  v_mfma_f32_16x16x32_bf16 v[24:27], a[36:39], a[104:107], v[24:27]
  s_waitcnt vmcnt(5)
  v_mfma_f32_16x16x32_bf16 v[8:11], a[40:43], a[108:111], v[8:11]
  v_mfma_f32_16x16x32_bf16 v[12:15], a[44:47], a[108:111], v[12:15]
  ds_write_b128 v91, v[68:71] offset:40960
  v_mfma_f32_16x16x32_bf16 v[16:19], a[48:51], a[108:111], v[16:19]
  v_mfma_f32_16x16x32_bf16 v[20:23], a[52:55], a[108:111], v[20:23]
  v_mfma_f32_16x16x32_bf16 v[24:27], a[56:59], a[108:111], v[24:27]
  ds_write_b128 v92, v[72:75] offset:40960
  s_waitcnt vmcnt(4)
  v_mfma_f32_16x16x16_bf16 v[8:11], a[60:61], a[112:113], v[8:11]
  v_mfma_f32_16x16x16_bf16 v[12:15], a[62:63], a[112:113], v[12:15]
  v_mfma_f32_16x16x16_bf16 v[16:19], a[64:65], a[112:113], v[16:19]
  v_mfma_f32_16x16x16_bf16 v[20:23], a[66:67], a[112:113], v[20:23]
  v_mfma_f32_16x16x16_bf16 v[24:27], a[68:69], a[112:113], v[24:27]
  s_waitcnt vmcnt(3)
  v_mfma_f32_16x16x32_bf16 v[56:59], v[40:43], a[114:117], 0
  v_mfma_f32_16x16x32_bf16 v[60:63], v[44:47], a[114:117], 0
  v_mfma_f32_16x16x32_bf16 v[64:67], v[48:51], a[114:117], 0
  ds_write_b128 v93, v[8:11] offset:0
  v_mfma_f32_16x16x32_bf16 v[68:71], v[52:55], a[114:117], 0
  v_mfma_f32_16x16x32_bf16 v[72:75], a[16:19], a[114:117], 0
  s_waitcnt vmcnt(2)
  v_mfma_f32_16x16x32_bf16 v[56:59], a[20:23], a[118:121], v[56:59]
  ds_write_b128 v94, v[12:15] offset:0
  v_mfma_f32_16x16x32_bf16 v[60:63], a[24:27], a[118:121], v[60:63]
  v_mfma_f32_16x16x32_bf16 v[64:67], a[28:31], a[118:121], v[64:67]
  v_mfma_f32_16x16x32_bf16 v[68:71], a[32:35], a[118:121], v[68:71]
  ds_write_b128 v95, v[16:19] offset:0
  v_mfma_f32_16x16x32_bf16 v[72:75], a[36:39], a[118:121], v[72:75]
  s_waitcnt vmcnt(1)
  v_mfma_f32_16x16x32_bf16 v[56:59], a[40:43], a[122:125], v[56:59]
  v_mfma_f32_16x16x32_bf16 v[60:63], a[44:47], a[122:125], v[60:63]
  ds_write_b128 v96, v[20:23] offset:0
  v_mfma_f32_16x16x32_bf16 v[64:67], a[48:51], a[122:125], v[64:67]
  v_mfma_f32_16x16x32_bf16 v[68:71], a[52:55], a[122:125], v[68:71]
  v_mfma_f32_16x16x32_bf16 v[72:75], a[56:59], a[122:125], v[72:75]
  ds_write_b128 v97, v[24:27] offset:0
  s_waitcnt vmcnt(0)
  v_mfma_f32_16x16x16_bf16 v[56:59], a[60:61], a[126:127], v[56:59]
  v_mfma_f32_16x16x16_bf16 v[60:63], a[62:63], a[126:127], v[60:63]
  v_mfma_f32_16x16x16_bf16 v[64:67], a[64:65], a[126:127], v[64:67]
  v_mfma_f32_16x16x16_bf16 v[68:71], a[66:67], a[126:127], v[68:71]
  v_mfma_f32_16x16x16_bf16 v[72:75], a[68:69], a[126:127], v[72:75]
  s_nop 3
  ds_write_b128 v93, v[56:59] offset:40960
  ds_write_b128 v94, v[60:63] offset:40960
  ds_write_b128 v95, v[64:67] offset:40960
  ds_write_b128 v96, v[68:71] offset:40960
  ds_write_b128 v97, v[72:75] offset:40960
  s_waitcnt lgkmcnt(0)
  s_barrier
  ds_read_b128 v[8:11], v116 offset:0
  ds_read_b128 v[12:15], v116 offset:1024
  ds_read_b128 v[16:19], v116 offset:2048
  ds_read_b128 v[20:23], v116 offset:3072
  ds_read_b128 v[24:27], v116 offset:4096
  ds_read_b128 v[28:31], v116 offset:5120
  ds_read_b128 v[32:35], v116 offset:6144
  ds_read_b128 v[36:39], v116 offset:7168
  v_lshlrev_b32 v110, 16, v104
  v_and_b32 v104, 0xffff0000, v104
  v_lshlrev_b32 v112, 16, v106
  v_and_b32 v106, 0xffff0000, v106
  v_lshlrev_b32 v114, 16, v108
  v_and_b32 v108, 0xffff0000, v108
  ds_read_b128 v[40:43], v117 offset:0
  ds_read_b128 v[44:47], v117 offset:1024
  ds_read_b128 v[48:51], v117 offset:2048
  ds_read_b128 v[52:55], v117 offset:3072
  ds_read_b128 v[56:59], v117 offset:4096
  ds_read_b128 v[60:63], v117 offset:5120
  ds_read_b128 v[64:67], v117 offset:6144
  ds_read_b128 v[68:71], v117 offset:7168
  ds_read_b128 v[72:75], v118 offset:0
  ds_read_b128 v[76:79], v118 offset:1024
  ds_read_b128 v[80:83], v118 offset:2048
  ds_read_b128 v[84:87], v118 offset:3072
  ds_read_b128 v[88:91], v118 offset:4096
  ds_read_b128 v[92:95], v118 offset:5120
  ds_read_b128 v[96:99], v118 offset:6144
  ds_read_b128 v[100:103], v118 offset:7168
  v_pk_add_f32 v[8:9], v[8:9], v[12:13]
  v_pk_add_f32 v[10:11], v[10:11], v[14:15]
  v_pk_add_f32 v[16:17], v[16:17], v[20:21]
  v_pk_add_f32 v[18:19], v[18:19], v[22:23]
  v_pk_add_f32 v[8:9], v[8:9], v[16:17]
  v_pk_add_f32 v[10:11], v[10:11], v[18:19]
  v_pk_add_f32 v[24:25], v[24:25], v[28:29]
  v_pk_add_f32 v[26:27], v[26:27], v[30:31]
  v_pk_add_f32 v[32:33], v[32:33], v[36:37]
  v_pk_add_f32 v[34:35], v[34:35], v[38:39]
  v_pk_add_f32 v[24:25], v[24:25], v[32:33]
  v_pk_add_f32 v[26:27], v[26:27], v[34:35]
  v_pk_add_f32 v[8:9], v[8:9], v[24:25]
  v_pk_add_f32 v[10:11], v[10:11], v[26:27]
  v_lshlrev_b32 v16, 16, v105
  v_and_b32 v17, 0xffff0000, v105
  v_add_f32 v8, v8, v110
  v_add_f32 v9, v9, v104
  v_pk_add_f32 v[10:11], v[10:11], v[16:17]
  v_cvt_pk_bf16_f32 v12, v8, v9
  v_cvt_pk_bf16_f32 v13, v10, v11
  buffer_store_dwordx2 v[12:13], v120, s[16:19], s47 offen sc1
  s_waitcnt lgkmcnt(14)
  v_pk_add_f32 v[40:41], v[40:41], v[44:45]
  v_pk_add_f32 v[42:43], v[42:43], v[46:47]
  s_waitcnt lgkmcnt(12)
  v_pk_add_f32 v[48:49], v[48:49], v[52:53]
  v_pk_add_f32 v[50:51], v[50:51], v[54:55]
  v_pk_add_f32 v[40:41], v[40:41], v[48:49]
  v_pk_add_f32 v[42:43], v[42:43], v[50:51]
  s_waitcnt lgkmcnt(10)
  v_pk_add_f32 v[56:57], v[56:57], v[60:61]
  v_pk_add_f32 v[58:59], v[58:59], v[62:63]
  s_waitcnt lgkmcnt(8)
  v_pk_add_f32 v[64:65], v[64:65], v[68:69]
  v_pk_add_f32 v[66:67], v[66:67], v[70:71]
  v_pk_add_f32 v[56:57], v[56:57], v[64:65]
  v_pk_add_f32 v[58:59], v[58:59], v[66:67]
  v_pk_add_f32 v[40:41], v[40:41], v[56:57]
  v_pk_add_f32 v[42:43], v[42:43], v[58:59]
  v_lshlrev_b32 v48, 16, v107
  v_and_b32 v49, 0xffff0000, v107
  v_add_f32 v40, v40, v112
  v_add_f32 v41, v41, v106
  v_pk_add_f32 v[42:43], v[42:43], v[48:49]
  v_cvt_pk_bf16_f32 v44, v40, v41
  v_cvt_pk_bf16_f32 v45, v42, v43
  buffer_store_dwordx2 v[44:45], v121, s[16:19], s47 offen sc1
  s_waitcnt lgkmcnt(6)
  v_pk_add_f32 v[72:73], v[72:73], v[76:77]
  v_pk_add_f32 v[74:75], v[74:75], v[78:79]
  s_waitcnt lgkmcnt(4)
  v_pk_add_f32 v[80:81], v[80:81], v[84:85]
  v_pk_add_f32 v[82:83], v[82:83], v[86:87]
  v_pk_add_f32 v[72:73], v[72:73], v[80:81]
  v_pk_add_f32 v[74:75], v[74:75], v[82:83]
  s_waitcnt lgkmcnt(2)
  v_pk_add_f32 v[88:89], v[88:89], v[92:93]
  v_pk_add_f32 v[90:91], v[90:91], v[94:95]
  s_waitcnt lgkmcnt(0)
  v_pk_add_f32 v[96:97], v[96:97], v[100:101]
  v_pk_add_f32 v[98:99], v[98:99], v[102:103]
  v_pk_add_f32 v[88:89], v[88:89], v[96:97]
  v_pk_add_f32 v[90:91], v[90:91], v[98:99]
  v_pk_add_f32 v[72:73], v[72:73], v[88:89]
  v_pk_add_f32 v[74:75], v[74:75], v[90:91]
  v_lshlrev_b32 v80, 16, v109
  v_and_b32 v81, 0xffff0000, v109
  v_add_f32 v72, v72, v114
  v_add_f32 v73, v73, v108
  v_pk_add_f32 v[74:75], v[74:75], v[80:81]
  v_cvt_pk_bf16_f32 v76, v72, v73
  v_cvt_pk_bf16_f32 v77, v74, v75
  buffer_store_dwordx2 v[76:77], v122, s[16:19], s47 offen sc1
  s_cmp_lg_u32 s34, 0
  s_cbranch_scc1 kf_kernel_nc115
  s_bfe_u32 s42, s2, 0x30004
  s_lshl_b32 s42, s42, 7
  s_and_b32 s43, s2, 7
  s_lshl_b32 s43, s43, 4
  s_add_u32 s42, s42, s43
  s_lshr_b32 s43, s2, 7
  s_lshl_b32 s43, s43, 3
  s_add_u32 s42, s42, s43
  s_bfe_u32 s43, s2, 0x10003
  s_lshl_b32 s43, s43, 2
  s_add_u32 s42, s42, s43
  s_add_u32 s42, s42, 131072
  s_lshl_b32 s43, s2, 3
  s_add_u32 s43, s43, 139264
  v_lshlrev_b32 v4, 6, v3
  v_lshlrev_b32 v5, 7, v3
  v_mov_b32 v6, 0
  v_mov_b32 v7, 0
  s_mov_b64 exec, 0xff
  buffer_store_dword v6, v4, s[68:71], s42 offen sc1
  buffer_store_dwordx2 v[6:7], v5, s[68:71], s43 offen sc1
  s_mov_b64 exec, -1
kf_kernel_nc115:
kf_kernel_end1:
  s_endpgm
code_end:
.section .rodata,"a"
.p2align 6
.amdhsa_kernel kf_kernel
  .amdhsa_next_free_vgpr 256
  .amdhsa_next_free_sgpr 102
  .amdhsa_accum_offset 128
  .amdhsa_group_segment_fixed_size 0
  .amdhsa_kernarg_size 88
  .amdhsa_user_sgpr_count 2
  .amdhsa_user_sgpr_kernarg_segment_ptr 1
  .amdhsa_system_sgpr_workgroup_id_x 1
.end_amdhsa_kernel
.p2align 8
.type tab,@object
tab:
.long 0x3f803f80,0x3f803f80,0x3f803f80,0x3f803f80,0x3f733f80,0x3f163f4f,0x3e9e,0xbf16be9e
.long 0x3f4f3f80,0xbe9e3e9e,0xbf80bf4f,0xbe9ebf4f,0x3f163f80,0xbf73be9e,0xbf4f,0x3f733f4f
.long 0x3e9e3f80,0xbf4fbf4f,0x3f803e9e,0xbf4f3e9e,0x3f80,0xbf80,0x3f80,0xbf80
.long 0xbe9e3f80,0x3f4fbf4f,0xbf803e9e,0x3f4f3e9e,0xbf163f80,0x3f73be9e,0xbf4f,0xbf733f4f
.long 0xbf4f3f80,0x3e9e3e9e,0x3f80bf4f,0x3e9ebf4f,0xbf733f80,0xbf163f4f,0x3e9e,0x3f16be9e
.long 0xbf803f80,0xbf803f80,0xbf803f80,0xbf803f80,0,0,0,0
.long 0,0,0,0,0,0,0,0
.long 0,0,0,0,0,0,0,0
.long 0x3f803f80,0x3f803f80,0x3f803f80,0x3f803f80,0xbf73bf4f,0xbf73bf80,0xbf16bf4f,0xbe9e
.long 0x3f4f3e9e,0x3f4f3f80,0xbe9e3e9e,0xbf80bf4f,0xbf163e9e,0xbf16bf80,0x3f733e9e,0x3f4f
.long 0x3e9ebf4f,0x3e9e3f80,0xbf4fbf4f,0x3f803e9e,0x3f80,0xbf80,0x3f80,0xbf80
.long 0xbe9ebf4f,0xbe9e3f80,0x3f4fbf4f,0xbf803e9e,0x3f163e9e,0x3f16bf80,0xbf733e9e,0x3f4f
.long 0xbf4f3e9e,0xbf4f3f80,0x3e9e3e9e,0x3f80bf4f,0x3f73bf4f,0x3f73bf80,0x3f16bf4f,0xbe9e
.long 0xbf803f80,0xbf803f80,0xbf803f80,0xbf803f80,0,0,0,0
.long 0,0,0,0,0,0,0,0
.long 0,0,0,0,0,0,0,0
.long 0x3f803f80,0x3f803f80,0,0,0x3f163e9e,0x3f733f4f,0,0
.long 0xbe9ebf4f,0x3f4f3e9e,0,0,0xbf73bf4f,0x3f16be9e,0,0
.long 0xbf4f3e9e,0x3e9ebf4f,0,0,0x3f80,0xbf80,0,0
.long 0x3f4f3e9e,0xbe9ebf4f,0,0,0x3f73bf4f,0xbf16be9e,0,0
.long 0x3e9ebf4f,0xbf4f3e9e,0,0,0xbf163e9e,0xbf733f4f,0,0
.long 0xbf803f80,0xbf803f80,0,0,0,0,0,0
.long 0,0,0,0,0,0,0,0
.long 0,0,0,0,0,0,0,0
.long 0,0,0,0,0,0,0,0
.long 0,0,0,0,0,0,0,0
.long 0,0,0,0,0,0,0,0
.long 0,0,0,0,0,0,0,0
.long 0,0,0,0,0,0,0,0
.long 0,0,0,0,0,0,0,0
.long 0,0,0,0,0,0,0,0
.long 0,0,0,0,0,0,0,0
.long 0,0,0,0,0xbe9e0000,0xbf4fbf16,0xbf80bf73,0xbf4fbf73
.long 0xbf160000,0xbf73bf73,0xbf16,0x3f733f16,0xbf4f0000,0xbe9ebf73,0x3f803f16,0xbe9e3f16
.long 0xbf730000,0x3f16bf16,0x3f73,0xbf16bf73,0xbf800000,0x3f800000,0xbf800000,0x3f800000
.long 0xbf730000,0x3f163f16,0xbf73,0xbf163f73,0xbf4f0000,0xbe9e3f73,0x3f80bf16,0xbe9ebf16
.long 0xbf160000,0xbf733f73,0x3f16,0x3f73bf16,0xbe9e0000,0xbf4f3f16,0xbf803f73,0xbf4f3f73
.long 0,0,0,0,0,0,0,0
.long 0,0,0,0,0,0,0,0
.long 0,0,0,0,0,0,0,0
.long 0,0,0,0,0xbe9ebf16,0x3e9e0000,0x3f4f3f16,0x3f803f73
.long 0x3f163f73,0xbf160000,0xbf73bf73,0xbf16,0xbf4fbf73,0x3f4f0000,0x3e9e3f73,0xbf80bf16
.long 0x3f733f16,0xbf730000,0x3f16bf16,0x3f73,0xbf800000,0x3f800000,0xbf800000,0x3f800000
.long 0x3f73bf16,0xbf730000,0x3f163f16,0xbf73,0xbf4f3f73,0x3f4f0000,0x3e9ebf73,0xbf803f16
.long 0x3f16bf73,0xbf160000,0xbf733f73,0x3f16,0xbe9e3f16,0x3e9e0000,0x3f4fbf16,0x3f80bf73
.long 0,0,0,0,0,0,0,0
.long 0,0,0,0,0,0,0,0
.long 0,0,0,0,0,0,0,0
.long 0,0,0,0,0x3f4f3f73,0x3e9e3f16,0,0
.long 0x3f733f16,0x3f163f73,0,0,0x3e9ebf16,0x3f4f3f73,0,0
.long 0xbf16bf73,0x3f733f16,0,0,0xbf800000,0x3f800000,0,0
.long 0xbf163f73,0x3f73bf16,0,0,0x3e9e3f16,0x3f4fbf73,0,0
.long 0x3f73bf16,0x3f16bf73,0,0,0x3f4fbf73,0x3e9ebf16,0,0
.long 0,0,0,0,0,0,0,0
.long 0,0,0,0,0,0,0,0
.long 0,0,0,0,0,0,0,0
.long 0,0,0,0,0,0,0,0
.long 0,0,0,0,0,0,0,0
.long 0,0,0,0,0,0,0,0
.long 0,0,0,0,0,0,0,0
.long 0,0,0,0,0,0,0,0
.long 0,0,0,0,0,0,0,0
.long 0,0,0,0,0,0,0,0
.long 0,0,0,0,0,0,0,0
.long 0x3f800000,0x3f800000,0x3f800000,0x3f800000,0x3f800000,0x3f7ffcd7,0x3f7ff35e,0x3f7fe394
.long 0x3f800000,0x3f7ff35e,0x3f7fcd79,0x3f7f8e56,0x3f800000,0x3f7fe394,0x3f7f8e56,0x3f7f0059
.long 0x3f800000,0x3f7fcd79,0x3f7f35f9,0x3f7e39bc,0x3f800000,0x3f7fb10f,0x3f7ec46d,0x3f7d3aac
.long 0x3f800000,0x3f7f8e56,0x3f7e39bc,0x3f7c0361,0x3f800000,0x3f7f654e,0x3f7d95f4,0x3f7a9421
.long 0x3f800000,0x3f7f35f9,0x3f7cd925,0x3f78ed3c,0x3f800000,0x3f7f0059,0x3f7c0361,0x3f770f11
.long 0x3f800000,0x3f7ec46d,0x3f7b14be,0x3f74fa0b,0x3f800000,0x3f7e8238,0x3f7a0d54,0x3f72ae9e
.long 0x3f800000,0x3f7e39bc,0x3f78ed3c,0x3f702d4f,0x3f800000,0x3f7deafa,0x3f77b493,0x3f6d76aa
.long 0x3f800000,0x3f7d95f4,0x3f766377,0x3f6a8b4b,0x3f800000,0x3f7d3aac,0x3f74fa0b,0x3f676bd8
.long 0x3f800000,0x3f800000,0x3f800000,0x3f800000,0x3f7fcd79,0x3f7fb10f,0x3f7f8e56,0x3f7f654e
.long 0x3f7f35f9,0x3f7ec46d,0x3f7e39bc,0x3f7d95f4,0x3f7e39bc,0x3f7d3aac,0x3f7c0361,0x3f7a9421
.long 0x3f7cd925,0x3f7b14be,0x3f78ed3c,0x3f766377,0x3f7b14be,0x3f7853f8,0x3f74fa0b,0x3f710908
.long 0x3f78ed3c,0x3f74fa0b,0x3f702d4f,0x3f6a8b4b,0x3f766377,0x3f710908,0x3f6a8b4b,0x3f62f219
.long 0x3f737871,0x3f6c835e,0x3f641901,0x3f5a46a0,0x3f702d4f,0x3f676bd8,0x3f5cdc29,0x3f50935b
.long 0x3f6c835e,0x3f61c598,0x3f54db31,0x3f45e403,0x3f687c12,0x3f5b941a,0x3f4c1d35,0x3f3a4582
.long 0x3f641901,0x3f54db31,0x3f42a9f7,0x3f2dc5e3,0x3f5f5be6,0x3f4d9f02,0x3f3889dc,0x3f207440
.long 0x3f5a46a0,0x3f45e403,0x3f2dc5e3,0x3f1260b2,0x3f54db31,0x3f3daef9,0x3f226799,0x3f039c3d
.long 0x3f800000,0x3f800000,0x3f800000,0x3f800000,0x3f7f35f9,0x3f7f0059,0x3f7ec46d,0x3f7e8238
.long 0x3f7cd925,0x3f7c0361,0x3f7b14be,0x3f7a0d54,0x3f78ed3c,0x3f770f11,0x3f74fa0b,0x3f72ae9e
.long 0x3f737871,0x3f702d4f,0x3f6c835e,0x3f687c12,0x3f6c835e,0x3f676bd8,0x3f61c598,0x3f5b941a
.long 0x3f641901,0x3f5cdc29,0x3f54db31,0x3f4c1d35,0x3f5a46a0,0x3f50935b,0x3f45e403,0x3f3a4582
.long 0x3f4f1bbd,0x3f42a9f7,0x3f3504f3,0x3f26423a,0x3f42a9f7,0x3f333bc6,0x3f226799,0x3f104f0e
.long 0x3f3504f3,0x3f226799,0x3f0e39da,0x3ef15aea,0x3f26423a,0x3f104f0e,0x3ef15aea,0x3ebf47d7
.long 0x3f167918,0x3efa2c90,0x3ec3ef15,0x3e8afa3e,0x3f05c277,0x3ed1c759,0x3e94a031,0x3e2a1c3f
.long 0x3ee87171,0x3ea7bf25,0x3e47c5c2,0x3d712283,0x3ec3ef15,0x3e78cfcc,0x3dc8bd36,0xbd48fb30
.long 0x3f800000,0x3f800000,0x3f800000,0x3f800000,0x3f7e39bc,0x3f7deafa,0x3f7d95f4,0x3f7d3aac
.long 0x3f78ed3c,0x3f77b493,0x3f766377,0x3f74fa0b,0x3f702d4f,0x3f6d76aa,0x3f6a8b4b,0x3f676bd8
.long 0x3f641901,0x3f5f5be6,0x3f5a46a0,0x3f54db31,0x3f54db31,0x3f4d9f02,0x3f45e403,0x3f3daef9
.long 0x3f42a9f7,0x3f3889dc,0x3f2dc5e3,0x3f226799,0x3f2dc5e3,0x3f207440,0x3f1260b2,0x3f039c3d
.long 0x3f167918,0x3f05c277,0x3ee87171,0x3ec3ef15,0x3efa2c90,0x3ed1c759,0x3ea7bf25,0x3e78cfcc
.long 0x3ec3ef15,0x3e94a031,0x3e47c5c2,0x3dc8bd36,0x3e8afa3e,0x3e2a1c3f,0x3d712283,0xbd48fb30
.long 0x3e20305b,0x3d20cee7,0xbda0af2a,0xbe47c5c2,0x3d20cee7,0xbdb4b86a,0xbe5b73dc,0xbeac7cd4
.long 0xbda0af2a,0xbe5b73dc,0xbeb13641,0xbef15aea,0xbe47c5c2,0xbeac7cd4,0xbef15aea,0xbf187fc0
.long 0,0,0,0,0,0xbc20d8d2,0xbca0d6d6,0xbcf13d4c
.long 0,0xbca0d6d6,0xbd20cee7,0xbd712283,0,0xbcf13d4c,0xbd712283,0xbdb4b86a
.long 0,0xbd20cee7,0xbda0af2a,0xbdf0b772,0,0xbd48fb30,0xbdc8bd36,0xbe164083
.long 0,0xbd712283,0xbdf0b772,0xbe3403f1,0,0xbd8ca1f2,0xbe0c4cf7,0xbe519f65
.long 0,0xbda0af2a,0xbe20305b,0xbe6f0c4d,0,0xbdb4b86a,0xbe3403f1,0xbe862210
.long 0,0xbdc8bd36,0xbe47c5c2,0xbe94a031,0,0xbddcbd0d,0xbe5b73dc,0xbea2fd52
.long 0,0xbdf0b772,0xbe6f0c4d,0xbeb13641,0,0xbe0255f4,0xbe814693,0xbebf47d7
.long 0,0xbe0c4cf7,0xbe8afa3e,0xbecd2ef3,0,0xbe164083,0xbe94a031,0xbedae880
.long 0,0,0,0,0xbd20cee7,0xbd48fb30,0xbd712283,0xbd8ca1f2
.long 0xbda0af2a,0xbdc8bd36,0xbdf0b772,0xbe0c4cf7,0xbdf0b772,0xbe164083,0xbe3403f1,0xbe519f65
.long 0xbe20305b,0xbe47c5c2,0xbe6f0c4d,0xbe8afa3e,0xbe47c5c2,0xbe78cfcc,0xbe94a031,0xbeac7cd4
.long 0xbe6f0c4d,0xbe94a031,0xbeb13641,0xbecd2ef3,0xbe8afa3e,0xbeac7cd4,0xbecd2ef3,0xbeece91a
.long 0xbe9e377a,0xbec3ef15,0xbee87171,0xbf05c277,0xbeb13641,0xbedae880,0xbf0172c3,0xbf146eba
.long 0xbec3ef15,0xbef15aea,0xbf0e39da,0xbf226799,0xbed65a92,0xbf039c3d,0xbf1a82a4,0xbf2f9c32
.long 0xbee87171,0xbf0e39da,0xbf26423a,0xbf3bfc8f,0xbefa2c90,0xbf187fc0,0xbf316e2c,0xbf4779bc
.long 0xbf05c277,0xbf226799,0xbf3bfc8f,0xbf5205d4,0xbf0e39da,0xbf2beb4a,0xbf45e403,0xbf5b941a
.long 0,0,0,0,0xbda0af2a,0xbdb4b86a,0xbdc8bd36,0xbddcbd0d
.long 0xbe20305b,0xbe3403f1,0xbe47c5c2,0xbe5b73dc,0xbe6f0c4d,0xbe862210,0xbe94a031,0xbea2fd52
.long 0xbe9e377a,0xbeb13641,0xbec3ef15,0xbed65a92,0xbec3ef15,0xbedae880,0xbef15aea,0xbf039c3d
.long 0xbee87171,0xbf0172c3,0xbf0e39da,0xbf1a82a4,0xbf05c277,0xbf146eba,0xbf226799,0xbf2f9c32
.long 0xbf167918,0xbf26423a,0xbf3504f3,0xbf42a9f7,0xbf26423a,0xbf36c9a9,0xbf45e403,0xbf53731f
.long 0xbf3504f3,0xbf45e403,0xbf54db31,0xbf61c598,0xbf42a9f7,0xbf53731f,0xbf61c598,0xbf6d76aa
.long 0xbf4f1bbd,0xbf5f5be6,0xbf6c835e,0xbf766377,0xbf5a46a0,0xbf698690,0xbf74fa0b,0xbf7c7160
.long 0xbf641901,0xbf71decf,0xbf7b14be,0xbf7f8e56,0xbf6c835e,0xbf7853f8,0xbf7ec46d,0xbf7fb10f
.long 0,0,0,0,0xbdf0b772,0xbe0255f4,0xbe0c4cf7,0xbe164083
.long 0xbe6f0c4d,0xbe814693,0xbe8afa3e,0xbe94a031,0xbeb13641,0xbebf47d7,0xbecd2ef3,0xbedae880
.long 0xbee87171,0xbefa2c90,0xbf05c277,0xbf0e39da,0xbf0e39da,0xbf187fc0,0xbf226799,0xbf2beb4a
.long 0xbf26423a,0xbf316e2c,0xbf3bfc8f,0xbf45e403,0xbf3bfc8f,0xbf4779bc,0xbf5205d4,0xbf5b941a
.long 0xbf4f1bbd,0xbf5a46a0,0xbf641901,0xbf6c835e,0xbf5f5be6,0xbf698690,0xbf71decf,0xbf7853f8
.long 0xbf6c835e,0xbf74fa0b,0xbf7b14be,0xbf7ec46d,0xbf766377,0xbf7c7160,0xbf7f8e56,0xbf7fb10f
.long 0xbf7cd925,0xbf7fcd79,0xbf7f35f9,0xbf7b14be,0xbf7fcd79,0xbf7f0059,0xbf7a0d54,0xbf710908
.long 0xbf7f35f9,0xbf7a0d54,0xbf702d4f,0xbf61c598,0xbf7b14be,0xbf710908,0xbf61c598,0xbf4d9f02
.long 0x3f800000,0x3f800000,0x3f800000,0x3f800000,0x3f7cd925,0x3f7c7160,0x3f7c0361,0x3f7b8f2a
.long 0x3f737871,0x3f71decf,0x3f702d4f,0x3f6e641a,0x3f641901,0x3f609384,0x3f5cdc29,0x3f58f3c4
.long 0x3f4f1bbd,0x3f490a88,0x3f42a9f7,0x3f3bfc8f,0x3f3504f3,0x3f2beb4a,0x3f226799,0x3f187fc0
.long 0x3f167918,0x3f0a04f8,0x3efa2c90,0x3edf7108,0x3ee87171,0x3ec8917e,0x3ea7bf25,0x3e862210
.long 0x3e9e377a,0x3e6f0c4d,0x3e20305b,0x3da0af2a,0x3e20305b,0x3d8ca1f2,0xbca0d6d6,0xbddcbd0d
.long 0,0xbdc8bd36,0xbe47c5c2,0xbe94a031,0xbe20305b,0xbe862210,0xbeba9be1,0xbeece91a
.long 0xbe9e377a,0xbed65a92,0xbf05c277,0xbf1e7cf1,0xbee87171,0xbf104f0e,0xbf2a0c73,0xbf4105b8
.long 0xbf167918,0xbf316e2c,0xbf490a88,0xbf5cdc29,0xbf3504f3,0xbf4d9f02,0xbf61c598,0xbf710908
.long 0x3f800000,0x3f800000,0x3f800000,0x3f800000,0x3f7b14be,0x3f7a9421,0x3f7a0d54,0x3f79805c
.long 0x3f6c835e,0x3f6a8b4b,0x3f687c12,0x3f6655e7,0x3f54db31,0x3f50935b,0x3f4c1d35,0x3f4779bc
.long 0x3f3504f3,0x3f2dc5e3,0x3f26423a,0x3f1e7cf1,0x3f0e39da,0x3f039c3d,0x3ef15aea,0x3edae880
.long 0x3ec3ef15,0x3ea7bf25,0x3e8afa3e,0x3e5b73dc,0x3e47c5c2,0x3e0255f4,0x3d712283,0xbc20d8d2
.long 0,0xbda0af2a,0xbe20305b,0xbe6f0c4d,0xbe47c5c2,0xbe8fcefe,0xbeba9be1,0xbee3f40d
.long 0xbec3ef15,0xbef15aea,0xbf0e39da,0xbf226799,0xbf0e39da,0xbf2456f1,0xbf3889dc,0xbf4a965e
.long 0xbf3504f3,0xbf490a88,0xbf5a46a0,0xbf687c12,0xbf54db31,0xbf653a48,0xbf71decf,0xbf7a9421
.long 0xbf6c835e,0xbf77b493,0xbf7e39bc,0xbf7ff35e,0xbf7b14be,0xbf7fb10f,0xbf7ec46d,0xbf7853f8
.long 0x3f800000,0x3f800000,0x3f800000,0x3f800000,0x3f78ed3c,0x3f7853f8,0x3f77b493,0x3f770f11
.long 0x3f641901,0x3f61c598,0x3f5f5be6,0x3f5cdc29,0x3f42a9f7,0x3f3daef9,0x3f3889dc,0x3f333bc6
.long 0x3f167918,0x3f0e39da,0x3f05c277,0x3efa2c90,0x3ec3ef15,0x3eac7cd4,0x3e94a031,0x3e78cfcc
.long 0x3e20305b,0x3dc8bd36,0x3d20cee7,0xbca0d6d6,0xbda0af2a,0xbe164083,0xbe5b73dc,0xbe8fcefe
.long 0xbe9e377a,0xbec3ef15,0xbee87171,0xbf05c277,0xbf05c277,0xbf187fc0,0xbf2a0c73,0xbf3a4582
.long 0xbf3504f3,0xbf45e403,0xbf54db31,0xbf61c598,0xbf5a46a0,0xbf676bd8,0xbf71decf,0xbf79805c
.long 0xbf737871,0xbf7b14be,0xbf7f35f9,0xbf7fcd79,0xbf7f35f9,0xbf7fb10f,0xbf7c0361,0xbf743c41
.long 0xbf7cd925,0xbf74fa0b,0xbf687c12,0xbf579b8c,0xbf6c835e,0xbf5b941a,0xbf45e403,0xbf2beb4a
.long 0x3f800000,0x3f800000,0x3f800000,0x3f800000,0x3f766377,0x3f75b1c9,0x3f74fa0b,0x3f743c41
.long 0x3f5a46a0,0x3f579b8c,0x3f54db31,0x3f5205d4,0x3f2dc5e3,0x3f28296a,0x3f226799,0x3f1c81b9
.long 0x3ee87171,0x3ed65a92,0x3ec3ef15,0x3eb13641,0x3e47c5c2,0x3e164083,0x3dc8bd36,0x3d48fb30
.long 0xbda0af2a,0xbe0c4cf7,0xbe47c5c2,0xbe814693,0xbeb13641,0xbed1c759,0xbef15aea,0xbf07e565
.long 0xbf167918,0xbf26423a,0xbf3504f3,0xbf42a9f7,0xbf490a88,0xbf563e03,0xbf61c598,0xbf6b8a3d
.long 0xbf6c835e,0xbf74fa0b,0xbf7b14be,0xbf7ec46d,0xbf7e39bc,0xbf7ffcd7,0xbf7ec46d,0xbf7a9421
.long 0xbf7cd925,0xbf766377,0xbf6c835e,0xbf5f5be6,0xbf687c12,0xbf58f3c4,0xbf45e403,0xbf2f9c32
.long 0xbf42a9f7,0xbf2a0c73,0xbf0e39da,0xbedf7108,0xbf0e39da,0xbedae880,0xbe94a031,0xbe164083
.long 0,0,0,0,0xbe20305b,0xbe2a1c3f,0xbe3403f1,0xbe3de731
.long 0xbe9e377a,0xbea7bf25,0xbeb13641,0xbeba9be1,0xbee87171,0xbef5c6c5,0xbf0172c3,0xbf07e565
.long 0xbf167918,0xbf1e7cf1,0xbf26423a,0xbf2dc5e3,0xbf3504f3,0xbf3daef9,0xbf45e403,0xbf4d9f02
.long 0xbf4f1bbd,0xbf579b8c,0xbf5f5be6,0xbf6655e7,0xbf641901,0xbf6b8a3d,0xbf71decf,0xbf770f11
.long 0xbf737871,0xbf78ed3c,0xbf7cd925,0xbf7f35f9,0xbf7cd925,0xbf7f654e,0xbf7ff35e,0xbf7e8238
.long 0xbf800000,0xbf7ec46d,0xbf7b14be,0xbf74fa0b,0xbf7cd925,0xbf770f11,0xbf6e641a,0xbf62f219
.long 0xbf737871,0xbf687c12,0xbf5a46a0,0xbf490a88,0xbf641901,0xbf53731f,0xbf3f5cb5,0xbf28296a
.long 0xbf4f1bbd,0xbf3889dc,0xbf1e7cf1,0xbf0172c3,0xbf3504f3,0xbf187fc0,0xbef15aea,0xbeac7cd4
.long 0,0,0,0,0xbe47c5c2,0xbe519f65,0xbe5b73dc,0xbe6542e9
.long 0xbec3ef15,0xbecd2ef3,0xbed65a92,0xbedf7108,0xbf0e39da,0xbf146eba,0xbf1a82a4,0xbf207440
.long 0xbf3504f3,0xbf3bfc8f,0xbf42a9f7,0xbf490a88,0xbf54db31,0xbf5b941a,0xbf61c598,0xbf676bd8
.long 0xbf6c835e,0xbf71decf,0xbf766377,0xbf7a0d54,0xbf7b14be,0xbf7deafa,0xbf7f8e56,0xbf7ffcd7
.long 0xbf800000,0xbf7f35f9,0xbf7cd925,0xbf78ed3c,0xbf7b14be,0xbf75b1c9,0xbf6e641a,0xbf653a48
.long 0xbf6c835e,0xbf61c598,0xbf54db31,0xbf45e403,0xbf54db31,0xbf444969,0xbf316e2c,0xbf1c81b9
.long 0xbf3504f3,0xbf1e7cf1,0xbf05c277,0xbed65a92,0xbf0e39da,0xbee3f40d,0xbea7bf25,0xbe519f65
.long 0xbec3ef15,0xbe814693,0xbdf0b772,0x3ca0d6d6,0xbe47c5c2,0xbd48fb30,0x3dc8bd36,0x3e78cfcc
.long 0,0,0,0,0xbe6f0c4d,0xbe78cfcc,0xbe814693,0xbe862210
.long 0xbee87171,0xbef15aea,0xbefa2c90,0xbf0172c3,0xbf26423a,0xbf2beb4a,0xbf316e2c,0xbf36c9a9
.long 0xbf4f1bbd,0xbf54db31,0xbf5a46a0,0xbf5f5be6,0xbf6c835e,0xbf710908,0xbf74fa0b,0xbf7853f8
.long 0xbf7cd925,0xbf7ec46d,0xbf7fcd79,0xbf7ff35e,0xbf7f35f9,0xbf7d3aac,0xbf7a0d54,0xbf75b1c9
.long 0xbf737871,0xbf6c835e,0xbf641901,0xbf5a46a0,0xbf5a46a0,0xbf4d9f02,0xbf3f5cb5,0xbf2f9c32
.long 0xbf3504f3,0xbf226799,0xbf0e39da,0xbef15aea,0xbf05c277,0xbedae880,0xbea7bf25,0xbe6542e9
.long 0xbe9e377a,0xbe47c5c2,0xbda0af2a,0x3d20cee7,0xbda0af2a,0x3d48fb30,0x3e3403f1,0x3e996dba
.long 0x3e20305b,0x3e94a031,0x3ed65a92,0x3f0a04f8,0x3ec3ef15,0x3f039c3d,0x3f226799,0x3f3daef9
.long 0,0,0,0,0xbe8afa3e,0xbe8fcefe,0xbe94a031,0xbe996dba
.long 0xbf05c277,0xbf0a04f8,0xbf0e39da,0xbf1260b2,0xbf3bfc8f,0xbf4105b8,0xbf45e403,0xbf4a965e
.long 0xbf641901,0xbf687c12,0xbf6c835e,0xbf702d4f,0xbf7b14be,0xbf7d3aac,0xbf7ec46d,0xbf7fb10f
.long 0xbf7f35f9,0xbf7d95f4,0xbf7b14be,0xbf77b493,0xbf702d4f,0xbf698690,0xbf61c598,0xbf58f3c4
.long 0xbf4f1bbd,0xbf42a9f7,0xbf3504f3,0xbf26423a,0xbf1e7cf1,0xbf0c2124,0xbef15aea,0xbec8917e
.long 0xbec3ef15,0xbe94a031,0xbe47c5c2,0xbdc8bd36,0xbdf0b772,0xbc20d8d2,0x3dc8bd36,0x3e519f65
.long 0x3e20305b,0x3e8afa3e,0x3ec3ef15,0x3efa2c90,0x3ed65a92,0x3f07e565,0x3f226799,0x3f3a4582
.long 0x3f26423a,0x3f3f5cb5,0x3f54db31,0x3f6655e7,0x3f54db31,0x3f676bd8,0x3f74fa0b,0x3f7d3aac
.long 0x3f803f80,0x3f803f80,0x3f803f80,0x3f803f80,0x3f7b3f80,0x3f553f6d,0xbf7bbf80,0xbf55bf6d
.long 0x3f6d3f80,0x3ec43f35,0x3f6d3f80,0x3ec43f35,0x3f553f80,0xbe483ec4,0xbf55bf80,0x3e48bec4
.long 0x3f353f80,0xbf350000,0x3f353f80,0xbf350000,0x3f0e3f80,0xbf7bbec4,0xbf0ebf80,0x3f7b3ec4
.long 0x3ec43f80,0xbf6dbf35,0x3ec43f80,0xbf6dbf35,0x3e483f80,0xbf0ebf6d,0xbe48bf80,0x3f0e3f6d
.long 0x3f80,0xbf80,0x3f80,0xbf80,0xbe483f80,0x3f0ebf6d,0x3e48bf80,0xbf0e3f6d
.long 0xbec43f80,0x3f6dbf35,0xbec43f80,0x3f6dbf35,0xbf0e3f80,0x3f7bbec4,0x3f0ebf80,0xbf7b3ec4
.long 0xbf353f80,0x3f350000,0xbf353f80,0x3f350000,0xbf553f80,0x3e483ec4,0x3f55bf80,0xbe48bec4
.long 0xbf6d3f80,0xbec43f35,0xbf6d3f80,0xbec43f35,0xbf7b3f80,0xbf553f6d,0x3f7bbf80,0x3f55bf6d
.long 0x3f803f80,0x3f803f80,0x3f803f80,0x3f803f80,0x3f0e3f35,0x3e483ec4,0xbf0ebf35,0xbe48bec4
.long 0xbec40000,0xbf6dbf35,0xbec40000,0xbf6dbf35,0xbf7bbf35,0xbf0ebf6d,0x3f7b3f35,0x3f0e3f6d
.long 0xbf35bf80,0x3f350000,0xbf35bf80,0x3f350000,0x3e48bf35,0x3f553f6d,0xbe483f35,0xbf55bf6d
.long 0x3f6d0000,0xbec43f35,0x3f6d0000,0xbec43f35,0x3f553f35,0xbf7bbec4,0xbf55bf35,0x3f7b3ec4
.long 0x3f80,0xbf80,0x3f80,0xbf80,0xbf553f35,0x3f7bbec4,0x3f55bf35,0xbf7b3ec4
.long 0xbf6d0000,0x3ec43f35,0xbf6d0000,0x3ec43f35,0xbe48bf35,0xbf553f6d,0x3e483f35,0x3f55bf6d
.long 0x3f35bf80,0xbf350000,0x3f35bf80,0xbf350000,0x3f7bbf35,0x3f0ebf6d,0xbf7b3f35,0xbf0e3f6d
.long 0x3ec40000,0x3f6dbf35,0x3ec40000,0x3f6dbf35,0xbf0e3f35,0xbe483ec4,0x3f0ebf35,0x3e48bec4
.long 0x3f803f80,0x3f803f80,0x3f803f80,0x3f803f80,0xbe480000,0xbf0ebec4,0x3e480000,0x3f0e3ec4
.long 0xbf6dbf80,0xbec4bf35,0xbf6dbf80,0xbec4bf35,0x3f0e0000,0x3f7b3f6d,0xbf0e0000,0xbf7bbf6d
.long 0x3f353f80,0xbf350000,0x3f353f80,0xbf350000,0xbf550000,0xbe48bf6d,0x3f550000,0x3e483f6d
.long 0xbec4bf80,0x3f6d3f35,0xbec4bf80,0x3f6d3f35,0x3f7b0000,0xbf553ec4,0xbf7b0000,0x3f55bec4
.long 0x3f80,0xbf80,0x3f80,0xbf80,0xbf7b0000,0x3f553ec4,0x3f7b0000,0xbf55bec4
.long 0x3ec4bf80,0xbf6d3f35,0x3ec4bf80,0xbf6d3f35,0x3f550000,0x3e48bf6d,0xbf550000,0xbe483f6d
.long 0xbf353f80,0x3f350000,0xbf353f80,0x3f350000,0xbf0e0000,0xbf7b3f6d,0x3f0e0000,0x3f7bbf6d
.long 0x3f6dbf80,0x3ec4bf35,0x3f6dbf80,0x3ec4bf35,0x3e480000,0x3f0ebec4,0xbe480000,0xbf0e3ec4
.long 0x3f803f80,0x3f803f80,0x3f803f80,0x3f803f80,0xbf55bf35,0xbf7bbf6d,0x3f553f35,0x3f7b3f6d
.long 0x3ec40000,0x3f6d3f35,0x3ec40000,0x3f6d3f35,0x3e483f35,0xbf55bec4,0xbe48bf35,0x3f553ec4
.long 0xbf35bf80,0x3f350000,0xbf35bf80,0x3f350000,0x3f7b3f35,0xbf0e3ec4,0xbf7bbf35,0x3f0ebec4
.long 0xbf6d0000,0x3ec4bf35,0xbf6d0000,0x3ec4bf35,0x3f0ebf35,0xbe483f6d,0xbf0e3f35,0x3e48bf6d
.long 0x3f80,0xbf80,0x3f80,0xbf80,0xbf0ebf35,0x3e483f6d,0x3f0e3f35,0xbe48bf6d
.long 0x3f6d0000,0xbec4bf35,0x3f6d0000,0xbec4bf35,0xbf7b3f35,0x3f0e3ec4,0x3f7bbf35,0xbf0ebec4
.long 0x3f35bf80,0xbf350000,0x3f35bf80,0xbf350000,0xbe483f35,0x3f55bec4,0x3e48bf35,0xbf553ec4
.long 0xbec40000,0xbf6d3f35,0xbec40000,0xbf6d3f35,0x3f55bf35,0x3f7bbf6d,0xbf553f35,0xbf7b3f6d
.long 0,0,0,0,0xbe480000,0xbf0ebec4,0x3e480000,0x3f0e3ec4
.long 0xbec40000,0xbf6dbf35,0xbec40000,0xbf6dbf35,0xbf0e0000,0xbf7bbf6d,0x3f0e0000,0x3f7b3f6d
.long 0xbf350000,0xbf35bf80,0xbf350000,0xbf35bf80,0xbf550000,0xbe48bf6d,0x3f550000,0x3e483f6d
.long 0xbf6d0000,0x3ec4bf35,0xbf6d0000,0x3ec4bf35,0xbf7b0000,0x3f55bec4,0x3f7b0000,0xbf553ec4
.long 0xbf800000,0x3f800000,0xbf800000,0x3f800000,0xbf7b0000,0x3f553ec4,0x3f7b0000,0xbf55bec4
.long 0xbf6d0000,0x3ec43f35,0xbf6d0000,0x3ec43f35,0xbf550000,0xbe483f6d,0x3f550000,0x3e48bf6d
.long 0xbf350000,0xbf353f80,0xbf350000,0xbf353f80,0xbf0e0000,0xbf7b3f6d,0x3f0e0000,0x3f7bbf6d
.long 0xbec40000,0xbf6d3f35,0xbec40000,0xbf6d3f35,0xbe480000,0xbf0e3ec4,0x3e480000,0x3f0ebec4
.long 0,0,0,0,0xbf55bf35,0xbf7bbf6d,0x3f553f35,0x3f7b3f6d
.long 0xbf6dbf80,0xbec4bf35,0xbf6dbf80,0xbec4bf35,0xbe48bf35,0x3f553ec4,0x3e483f35,0xbf55bec4
.long 0x3f350000,0x3f353f80,0x3f350000,0x3f353f80,0x3f7b3f35,0xbf0e3ec4,0xbf7bbf35,0x3f0ebec4
.long 0x3ec43f80,0xbf6dbf35,0x3ec43f80,0xbf6dbf35,0xbf0e3f35,0x3e48bf6d,0x3f0ebf35,0xbe483f6d
.long 0xbf800000,0x3f800000,0xbf800000,0x3f800000,0xbf0ebf35,0x3e483f6d,0x3f0e3f35,0xbe48bf6d
.long 0x3ec4bf80,0xbf6d3f35,0x3ec4bf80,0xbf6d3f35,0x3f7bbf35,0xbf0ebec4,0xbf7b3f35,0x3f0e3ec4
.long 0x3f350000,0x3f35bf80,0x3f350000,0x3f35bf80,0xbe483f35,0x3f55bec4,0x3e48bf35,0xbf553ec4
.long 0xbf6d3f80,0xbec43f35,0xbf6d3f80,0xbec43f35,0xbf553f35,0xbf7b3f6d,0x3f55bf35,0x3f7bbf6d
.long 0,0,0,0,0xbf7bbf80,0xbf55bf6d,0x3f7b3f80,0x3f553f6d
.long 0x3ec40000,0x3f6d3f35,0x3ec40000,0x3f6d3f35,0x3f553f80,0xbe483ec4,0xbf55bf80,0x3e48bec4
.long 0xbf350000,0xbf35bf80,0xbf350000,0xbf35bf80,0xbf0ebf80,0x3f7b3ec4,0x3f0e3f80,0xbf7bbec4
.long 0x3f6d0000,0xbec43f35,0x3f6d0000,0xbec43f35,0x3e483f80,0xbf0ebf6d,0xbe48bf80,0x3f0e3f6d
.long 0xbf800000,0x3f800000,0xbf800000,0x3f800000,0x3e48bf80,0xbf0e3f6d,0xbe483f80,0x3f0ebf6d
.long 0x3f6d0000,0xbec4bf35,0x3f6d0000,0xbec4bf35,0xbf0e3f80,0x3f7bbec4,0x3f0ebf80,0xbf7b3ec4
.long 0xbf350000,0xbf353f80,0xbf350000,0xbf353f80,0x3f55bf80,0xbe48bec4,0xbf553f80,0x3e483ec4
.long 0x3ec40000,0x3f6dbf35,0x3ec40000,0x3f6dbf35,0xbf7b3f80,0xbf553f6d,0x3f7bbf80,0x3f55bf6d
.long 0,0,0,0,0xbf0ebf35,0xbe48bec4,0x3f0e3f35,0x3e483ec4
.long 0x3f6d3f80,0x3ec43f35,0x3f6d3f80,0x3ec43f35,0xbf7bbf35,0xbf0ebf6d,0x3f7b3f35,0x3f0e3f6d
.long 0x3f350000,0x3f353f80,0x3f350000,0x3f353f80,0xbe483f35,0xbf55bf6d,0x3e48bf35,0x3f553f6d
.long 0xbec4bf80,0x3f6d3f35,0xbec4bf80,0x3f6d3f35,0x3f553f35,0xbf7bbec4,0xbf55bf35,0x3f7b3ec4
.long 0xbf800000,0x3f800000,0xbf800000,0x3f800000,0x3f55bf35,0xbf7b3ec4,0xbf553f35,0x3f7bbec4
.long 0xbec43f80,0x3f6dbf35,0xbec43f80,0x3f6dbf35,0xbe48bf35,0xbf553f6d,0x3e483f35,0x3f55bf6d
.long 0x3f350000,0x3f35bf80,0x3f350000,0x3f35bf80,0xbf7b3f35,0xbf0e3f6d,0x3f7bbf35,0x3f0ebf6d
.long 0x3f6dbf80,0x3ec4bf35,0x3f6dbf80,0x3ec4bf35,0xbf0e3f35,0xbe483ec4,0x3f0ebf35,0x3e48bec4
.long 0x80003f80,0x80003f80,0x80003f80,0x80003f80,0x80003f80,0x3ec43f6d,0x3f353f35,0x3f6d3ec4
.long 0x80003f80,0x3f353f35,0x3f800000,0x3f35bf35,0x80003f80,0x3f6d3ec4,0x3f35bf35,0xbec4bf6d
.long 0x80003f80,0x3f800000,0x8000bf80,0xbf800000,0x80003f80,0x3f6dbec4,0xbf35bf35,0xbec43f6d
.long 0x80003f80,0x3f35bf35,0xbf800000,0x3f353f35,0x80003f80,0x3ec4bf6d,0xbf353f35,0x3f6dbec4
.long 0x80003f80,0x8000bf80,0x80003f80,0x8000bf80,0x80003f80,0xbec4bf6d,0x3f353f35,0xbf6dbec4
.long 0x80003f80,0xbf35bf35,0x3f800000,0xbf353f35,0x80003f80,0xbf6dbec4,0x3f35bf35,0x3ec43f6d
.long 0x80003f80,0xbf800000,0x8000bf80,0x3f800000,0x80003f80,0xbf6d3ec4,0xbf35bf35,0x3ec4bf6d
.long 0x80003f80,0xbf353f35,0xbf800000,0xbf35bf35,0x80003f80,0xbec43f6d,0xbf353f35,0xbf6d3ec4
.long 0x80003f80,0x80003f80,0x80003f80,0x80003f80,0x3f800000,0x3f6dbec4,0x3f35bf35,0x3ec4bf6d
.long 0x8000bf80,0xbf35bf35,0xbf800000,0xbf353f35,0xbf800000,0xbec43f6d,0x3f353f35,0x3f6dbec4
.long 0x80003f80,0x3f800000,0x8000bf80,0xbf800000,0x3f800000,0xbec4bf6d,0xbf353f35,0x3f6d3ec4
.long 0x8000bf80,0xbf353f35,0x3f800000,0xbf35bf35,0xbf800000,0x3f6d3ec4,0xbf35bf35,0x3ec43f6d
.long 0x80003f80,0x8000bf80,0x80003f80,0x8000bf80,0x3f800000,0xbf6d3ec4,0x3f35bf35,0xbec43f6d
.long 0x8000bf80,0x3f353f35,0xbf800000,0x3f35bf35,0xbf800000,0x3ec4bf6d,0x3f353f35,0xbf6d3ec4
.long 0x80003f80,0xbf800000,0x8000bf80,0x3f800000,0x3f800000,0x3ec43f6d,0xbf353f35,0xbf6dbec4
.long 0x8000bf80,0x3f35bf35,0x3f800000,0x3f353f35,0xbf800000,0xbf6dbec4,0xbf35bf35,0xbec4bf6d
.long 0x80003f80,0x80003f80,0x80003f80,0x80003f80,0x8000bf80,0xbec4bf6d,0xbf35bf35,0xbf6dbec4
.long 0x80003f80,0x3f353f35,0x3f800000,0x3f35bf35,0x8000bf80,0xbf6dbec4,0xbf353f35,0x3ec43f6d
.long 0x80003f80,0x3f800000,0x8000bf80,0xbf800000,0x8000bf80,0xbf6d3ec4,0x3f353f35,0x3ec4bf6d
.long 0x80003f80,0x3f35bf35,0xbf800000,0x3f353f35,0x8000bf80,0xbec43f6d,0x3f35bf35,0xbf6d3ec4
.long 0x80003f80,0x8000bf80,0x80003f80,0x8000bf80,0x8000bf80,0x3ec43f6d,0xbf35bf35,0x3f6d3ec4
.long 0x80003f80,0xbf35bf35,0x3f800000,0xbf353f35,0x8000bf80,0x3f6d3ec4,0xbf353f35,0xbec4bf6d
.long 0x80003f80,0xbf800000,0x8000bf80,0x3f800000,0x8000bf80,0x3f6dbec4,0x3f353f35,0xbec43f6d
.long 0x80003f80,0xbf353f35,0xbf800000,0xbf35bf35,0x8000bf80,0x3ec4bf6d,0x3f35bf35,0x3f6dbec4
.long 0x80003f80,0x80003f80,0x80003f80,0x80003f80,0xbf800000,0xbf6d3ec4,0xbf353f35,0xbec43f6d
.long 0x8000bf80,0xbf35bf35,0xbf800000,0xbf353f35,0x3f800000,0x3ec4bf6d,0xbf35bf35,0xbf6d3ec4
.long 0x80003f80,0x3f800000,0x8000bf80,0xbf800000,0xbf800000,0x3ec43f6d,0x3f35bf35,0xbf6dbec4
.long 0x8000bf80,0xbf353f35,0x3f800000,0xbf35bf35,0x3f800000,0xbf6dbec4,0x3f353f35,0xbec4bf6d
.long 0x80003f80,0x8000bf80,0x80003f80,0x8000bf80,0xbf800000,0x3f6dbec4,0xbf353f35,0x3ec4bf6d
.long 0x8000bf80,0x3f353f35,0xbf800000,0x3f35bf35,0x3f800000,0xbec43f6d,0xbf35bf35,0x3f6dbec4
.long 0x80003f80,0xbf800000,0x8000bf80,0x3f800000,0xbf800000,0xbec4bf6d,0x3f35bf35,0x3f6d3ec4
.long 0x8000bf80,0x3f35bf35,0x3f800000,0x3f353f35,0x3f800000,0x3f6d3ec4,0x3f353f35,0x3ec43f6d
.long 0x3f800000,0x3f800000,0x3f800000,0x3f800000,0x3f800000,0x3f6dbec4,0x3f35bf35,0x3ec4bf6d
.long 0x3f800000,0x3f35bf35,0xbf80,0xbf35bf35,0x3f800000,0x3ec4bf6d,0xbf35bf35,0xbf6d3ec4
.long 0x3f800000,0xbf80,0xbf800000,0x3f80,0x3f800000,0xbec4bf6d,0xbf353f35,0x3f6d3ec4
.long 0x3f800000,0xbf35bf35,0x3f80,0x3f35bf35,0x3f800000,0xbf6dbec4,0x3f353f35,0xbec4bf6d
.long 0x3f800000,0xbf800000,0x3f800000,0xbf800000,0x3f800000,0xbf6d3ec4,0x3f35bf35,0xbec43f6d
.long 0x3f800000,0xbf353f35,0xbf80,0x3f353f35,0x3f800000,0xbec43f6d,0xbf35bf35,0x3f6dbec4
.long 0x3f800000,0x3f80,0xbf800000,0xbf80,0x3f800000,0x3ec43f6d,0xbf353f35,0xbf6dbec4
.long 0x3f800000,0x3f353f35,0x3f80,0xbf353f35,0x3f800000,0x3f6d3ec4,0x3f353f35,0x3ec43f6d
.long 0x3f800000,0x3f800000,0x3f800000,0x3f800000,0xbf80,0xbec4bf6d,0xbf35bf35,0xbf6dbec4
.long 0xbf800000,0xbf353f35,0x3f80,0x3f353f35,0x3f80,0x3f6d3ec4,0x3f35bf35,0xbec4bf6d
.long 0x3f800000,0xbf80,0xbf800000,0x3f80,0xbf80,0xbf6d3ec4,0x3f353f35,0x3ec4bf6d
.long 0xbf800000,0x3f353f35,0xbf80,0xbf353f35,0x3f80,0x3ec4bf6d,0xbf353f35,0x3f6dbec4
.long 0x3f800000,0xbf800000,0x3f800000,0xbf800000,0xbf80,0x3ec43f6d,0xbf35bf35,0x3f6d3ec4
.long 0xbf800000,0x3f35bf35,0x3f80,0xbf35bf35,0x3f80,0xbf6dbec4,0x3f35bf35,0x3ec43f6d
.long 0x3f800000,0x3f80,0xbf800000,0xbf80,0xbf80,0x3f6dbec4,0x3f353f35,0xbec43f6d
.long 0xbf800000,0xbf35bf35,0xbf80,0x3f35bf35,0x3f80,0xbec43f6d,0xbf353f35,0xbf6d3ec4
.long 0x3f800000,0x3f800000,0x3f800000,0x3f800000,0xbf800000,0xbf6d3ec4,0xbf353f35,0xbec43f6d
.long 0x3f800000,0x3f35bf35,0xbf80,0xbf35bf35,0xbf800000,0xbec43f6d,0x3f353f35,0x3f6dbec4
.long 0x3f800000,0xbf80,0xbf800000,0x3f80,0xbf800000,0x3ec43f6d,0x3f35bf35,0xbf6dbec4
.long 0x3f800000,0xbf35bf35,0x3f80,0x3f35bf35,0xbf800000,0x3f6d3ec4,0xbf35bf35,0x3ec43f6d
.long 0x3f800000,0xbf800000,0x3f800000,0xbf800000,0xbf800000,0x3f6dbec4,0xbf353f35,0x3ec4bf6d
.long 0x3f800000,0xbf353f35,0xbf80,0x3f353f35,0xbf800000,0x3ec4bf6d,0x3f353f35,0xbf6d3ec4
.long 0x3f800000,0x3f80,0xbf800000,0xbf80,0xbf800000,0xbec4bf6d,0x3f35bf35,0x3f6d3ec4
.long 0x3f800000,0x3f353f35,0x3f80,0xbf353f35,0xbf800000,0xbf6dbec4,0xbf35bf35,0xbec4bf6d
.long 0x3f800000,0x3f800000,0x3f800000,0x3f800000,0x3f80,0x3ec43f6d,0x3f353f35,0x3f6d3ec4
.long 0xbf800000,0xbf353f35,0x3f80,0x3f353f35,0xbf80,0xbf6dbec4,0xbf353f35,0x3ec43f6d
.long 0x3f800000,0xbf80,0xbf800000,0x3f80,0x3f80,0x3f6dbec4,0xbf35bf35,0xbec43f6d
.long 0xbf800000,0x3f353f35,0xbf80,0xbf353f35,0xbf80,0xbec43f6d,0x3f35bf35,0xbf6d3ec4
.long 0x3f800000,0xbf800000,0x3f800000,0xbf800000,0x3f80,0xbec4bf6d,0x3f353f35,0xbf6dbec4
.long 0xbf800000,0x3f35bf35,0x3f80,0xbf35bf35,0xbf80,0x3f6d3ec4,0xbf353f35,0xbec4bf6d
.long 0x3f800000,0x3f80,0xbf800000,0xbf80,0x3f80,0xbf6d3ec4,0xbf35bf35,0x3ec4bf6d
.long 0xbf800000,0xbf35bf35,0xbf80,0x3f35bf35,0xbf80,0x3ec4bf6d,0x3f35bf35,0x3f6dbec4
.long 0x3f800000,0x3f800000,0x3f800000,0x3f800000,0x3f800000,0x3f7fec43,0x3f7fb10f,0x3f7f4e6d
.long 0x3f800000,0x3f7fb10f,0x3f7ec46d,0x3f7d3aac,0x3f800000,0x3f7f4e6d,0x3f7d3aac,0x3f79c79d
.long 0x3f800000,0x3f7ec46d,0x3f7b14be,0x3f74fa0b,0x3f800000,0x3f7e1324,0x3f7853f8,0x3f6ed89e
.long 0x3f800000,0x3f7d3aac,0x3f74fa0b,0x3f676bd8,0x3f800000,0x3f7c3b28,0x3f710908,0x3f5ebe05
.long 0x3f800000,0x3f7b14be,0x3f6c835e,0x3f54db31,0x3f800000,0x3f79c79d,0x3f676bd8,0x3f49d112
.long 0x3f800000,0x3f7853f8,0x3f61c598,0x3f3daef9,0x3f800000,0x3f76ba07,0x3f5b941a,0x3f3085bb
.long 0x3f800000,0x3f74fa0b,0x3f54db31,0x3f226799,0x3f800000,0x3f731447,0x3f4d9f02,0x3f13682a
.long 0x3f800000,0x3f710908,0x3f45e403,0x3f039c3d,0x3f800000,0x3f6ed89e,0x3f3daef9,0x3ee63375
.long 0x3f800000,0x3f800000,0x3f800000,0x3f800000,0x3f7ec46d,0x3f7e1324,0x3f7d3aac,0x3f7c3b28
.long 0x3f7b14be,0x3f7853f8,0x3f74fa0b,0x3f710908,0x3f74fa0b,0x3f6ed89e,0x3f676bd8,0x3f5ebe05
.long 0x3f6c835e,0x3f61c598,0x3f54db31,0x3f45e403,0x3f61c598,0x3f514d3d,0x3f3daef9,0x3f273656
.long 0x3f54db31,0x3f3daef9,0x3f226799,0x3f039c3d,0x3f45e403,0x3f273656,0x3f039c3d,0x3eb8442a
.long 0x3f3504f3,0x3f0e39da,0x3ec3ef15,0x3e47c5c2,0x3f226799,0x3ee63375,0x3e78cfcc,0x3cc90ab0
.long 0x3f0e39da,0x3eac7cd4,0x3dc8bd36,0xbe164083,0x3ef15aea,0x3e605c13,0xbd48fb30,0xbea09ae5
.long 0x3ec3ef15,0x3dc8bd36,0xbe47c5c2,0xbef15aea,0x3e94a031,0xbcc90ab0,0xbeac7cd4,0xbf1d7fd1
.long 0x3e47c5c2,0xbe164083,0xbef15aea,0xbf3daef9,0x3dc8bd36,0xbe888e93,0xbf187fc0,0xbf584853
.long 0x3f800000,0x3f800000,0x3f800000,0x3f800000,0x3f7b14be,0x3f79c79d,0x3f7853f8,0x3f76ba07
.long 0x3f6c835e,0x3f676bd8,0x3f61c598,0x3f5b941a,0x3f54db31,0x3f49d112,0x3f3daef9,0x3f3085bb
.long 0x3f3504f3,0x3f226799,0x3f0e39da,0x3ef15aea,0x3f0e39da,0x3ee63375,0x3eac7cd4,0x3e605c13
.long 0x3ec3ef15,0x3e78cfcc,0x3dc8bd36,0xbd48fb30,0x3e47c5c2,0x3cc90ab0,0xbe164083,0xbea09ae5
.long 0,0xbe47c5c2,0xbec3ef15,0xbf0e39da,0xbe47c5c2,0xbecf7bca,0xbf187fc0,0xbf41d870
.long 0xbec3ef15,0xbf187fc0,0xbf45e403,0xbf676bd8,0xbf0e39da,0xbf41d870,0xbf676bd8,0xbf7c3b28
.long 0xbf3504f3,0xbf61c598,0xbf7b14be,0xbf7ec46d,0xbf54db31,0xbf76ba07,0xbf7fb10f,0xbf6ed89e
.long 0xbf6c835e,0xbf7fb10f,0xbf74fa0b,0xbf4d9f02,0xbf7b14be,0xbf7c3b28,0xbf5b941a,0xbf1d7fd1
.long 0x3f800000,0x3f800000,0x3f800000,0x3f800000,0x3f74fa0b,0x3f731447,0x3f710908,0x3f6ed89e
.long 0x3f54db31,0x3f4d9f02,0x3f45e403,0x3f3daef9,0x3f226799,0x3f13682a,0x3f039c3d,0x3ee63375
.long 0x3ec3ef15,0x3e94a031,0x3e47c5c2,0x3dc8bd36,0x3dc8bd36,0xbcc90ab0,0xbe164083,0xbe888e93
.long 0xbe47c5c2,0xbeac7cd4,0xbef15aea,0xbf187fc0,0xbef15aea,0xbf1d7fd1,0xbf3daef9,0xbf584853
.long 0xbf3504f3,0xbf54db31,0xbf6c835e,0xbf7b14be,0xbf61c598,0xbf76ba07,0xbf7fb10f,0xbf7c3b28
.long 0xbf7b14be,0xbf7fb10f,0xbf74fa0b,0xbf5b941a,0xbf7ec46d,0xbf6ed89e,0xbf4d9f02,0xbf1d7fd1
.long 0xbf6c835e,0xbf45e403,0xbf0e39da,0xbe94a031,0xbf45e403,0xbf08f59b,0xbe78cfcc,0x3d96a905
.long 0xbf0e39da,0xbe78cfcc,0x3dc8bd36,0x3edae880,0xbe94a031,0x3d96a905,0x3edae880,0x3f396842
.long 0,0,0,0,0,0xbcc90ab0,0xbd48fb30,0xbd96a905
.long 0,0xbd48fb30,0xbdc8bd36,0xbe164083,0,0xbd96a905,0xbe164083,0xbe605c13
.long 0,0xbdc8bd36,0xbe47c5c2,0xbe94a031,0,0xbdfab273,0xbe78cfcc,0xbeb8442a
.long 0,0xbe164083,0xbe94a031,0xbedae880,0,0xbe2f10a2,0xbeac7cd4,0xbefc5d27
.long 0,0xbe47c5c2,0xbec3ef15,0xbf0e39da,0,0xbe605c13,0xbedae880,0xbf1d7fd1
.long 0,0xbe78cfcc,0xbef15aea,0xbf2beb4a,0,0xbe888e93,0xbf039c3d,0xbf396842
.long 0,0xbe94a031,0xbf0e39da,0xbf45e403,0,0xbea09ae5,0xbf187fc0,0xbf514d3d
.long 0,0xbeac7cd4,0xbf226799,0xbf5b941a,0,0xbeb8442a,0xbf2beb4a,0xbf64aa59
.long 0,0,0,0,0xbdc8bd36,0xbdfab273,0xbe164083,0xbe2f10a2
.long 0xbe47c5c2,0xbe78cfcc,0xbe94a031,0xbeac7cd4,0xbe94a031,0xbeb8442a,0xbedae880,0xbefc5d27
.long 0xbec3ef15,0xbef15aea,0xbf0e39da,0xbf226799,0xbef15aea,0xbf13682a,0xbf2beb4a,0xbf41d870
.long 0xbf0e39da,0xbf2beb4a,0xbf45e403,0xbf5b941a,0xbf226799,0xbf41d870,0xbf5b941a,0xbf6ed89e
.long 0xbf3504f3,0xbf54db31,0xbf6c835e,0xbf7b14be,0xbf45e403,0xbf64aa59,0xbf7853f8,0xbf7fec43
.long 0xbf54db31,0xbf710908,0xbf7ec46d,0xbf7d3aac,0xbf61c598,0xbf79c79d,0xbf7fb10f,0xbf731447
.long 0xbf6c835e,0xbf7ec46d,0xbf7b14be,0xbf61c598,0xbf74fa0b,0xbf7fec43,0xbf710908,0xbf49d112
.long 0xbf7b14be,0xbf7d3aac,0xbf61c598,0xbf2beb4a,0xbf7ec46d,0xbf76ba07,0xbf4d9f02,0xbf08f59b
.long 0,0,0,0,0xbe47c5c2,0xbe605c13,0xbe78cfcc,0xbe888e93
.long 0xbec3ef15,0xbedae880,0xbef15aea,0xbf039c3d,0xbf0e39da,0xbf1d7fd1,0xbf2beb4a,0xbf396842
.long 0xbf3504f3,0xbf45e403,0xbf54db31,0xbf61c598,0xbf54db31,0xbf64aa59,0xbf710908,0xbf79c79d
.long 0xbf6c835e,0xbf7853f8,0xbf7ec46d,0xbf7fb10f,0xbf7b14be,0xbf7fec43,0xbf7d3aac,0xbf731447
.long 0xbf800000,0xbf7b14be,0xbf6c835e,0xbf54db31,0xbf7b14be,0xbf6a09a7,0xbf4d9f02,0xbf273656
.long 0xbf6c835e,0xbf4d9f02,0xbf226799,0xbedae880,0xbf54db31,0xbf273656,0xbedae880,0xbe2f10a2
.long 0xbf3504f3,0xbef15aea,0xbe47c5c2,0x3dc8bd36,0xbf0e39da,0xbe888e93,0x3d48fb30,0x3eb8442a
.long 0xbec3ef15,0xbd48fb30,0x3e94a031,0x3f187fc0,0xbe47c5c2,0x3e2f10a2,0x3f039c3d,0x3f49d112
.long 0,0,0,0,0xbe94a031,0xbea09ae5,0xbeac7cd4,0xbeb8442a
.long 0xbf0e39da,0xbf187fc0,0xbf226799,0xbf2beb4a,0xbf45e403,0xbf514d3d,0xbf5b941a,0xbf64aa59
.long 0xbf6c835e,0xbf74fa0b,0xbf7b14be,0xbf7ec46d,0xbf7ec46d,0xbf7fec43,0xbf7d3aac,0xbf76ba07
.long 0xbf7b14be,0xbf710908,0xbf61c598,0xbf4d9f02,0xbf61c598,0xbf49d112,0xbf2beb4a,0xbf08f59b
.long 0xbf3504f3,0xbf0e39da,0xbec3ef15,0xbe47c5c2,0xbef15aea,0xbe888e93,0xbd48fb30,0x3e2f10a2
.long 0xbe47c5c2,0x3d48fb30,0x3e94a031,0x3f039c3d,0x3dc8bd36,0x3eb8442a,0x3f187fc0,0x3f49d112
.long 0x3ec3ef15,0x3f226799,0x3f54db31,0x3f74fa0b,0x3f226799,0x3f584853,0x3f7853f8,0x3f7f4e6d
.long 0x3f54db31,0x3f7853f8,0x3f7ec46d,0x3f676bd8,0x3f74fa0b,0x3f7f4e6d,0x3f676bd8,0x3f3085bb
.long 0x3f803f80,0x3f803f80,0x80008000,0x80008000,0x3f6d3f80,0x3ec43f35,0x3ec48000,0x3f6d3f35
.long 0x3f353f80,0xbf350000,0x3f358000,0x3f353f80,0x3ec43f80,0xbf6dbf35,0x3f6d8000,0xbec43f35
.long 0x3f80,0xbf80,0x3f808000,0xbf808000,0xbec43f80,0x3f6dbf35,0x3f6d8000,0xbec4bf35
.long 0xbf353f80,0x3f350000,0x3f358000,0x3f35bf80,0xbf6d3f80,0xbec43f35,0x3ec48000,0x3f6dbf35
.long 0xbf803f80,0xbf803f80,0x80008000,0x80008000,0xbf6d3f80,0xbec43f35,0xbec48000,0xbf6d3f35
.long 0xbf353f80,0x3f350000,0xbf358000,0xbf353f80,0xbec43f80,0x3f6dbf35,0xbf6d8000,0x3ec43f35
.long 0x3f80,0xbf80,0xbf808000,0x3f808000,0x3ec43f80,0xbf6dbf35,0xbf6d8000,0x3ec4bf35
.long 0x3f353f80,0xbf350000,0xbf358000,0xbf35bf80,0x3f6d3f80,0x3ec43f35,0xbec48000,0xbf6dbf35
.long 0x3f803f80,0x3f803f80,0x80008000,0x80008000,0xbec40000,0xbf6dbf35,0x3f6d3f80,0x3ec43f35
.long 0xbf35bf80,0x3f350000,0xbf358000,0xbf35bf80,0x3f6d0000,0xbec43f35,0xbec4bf80,0x3f6d3f35
.long 0x3f80,0xbf80,0x3f808000,0xbf808000,0xbf6d0000,0x3ec43f35,0xbec43f80,0x3f6dbf35
.long 0x3f35bf80,0xbf350000,0xbf358000,0xbf353f80,0x3ec40000,0x3f6dbf35,0x3f6dbf80,0x3ec4bf35
.long 0xbf803f80,0xbf803f80,0x80008000,0x80008000,0x3ec40000,0x3f6dbf35,0xbf6d3f80,0xbec43f35
.long 0x3f35bf80,0xbf350000,0x3f358000,0x3f35bf80,0xbf6d0000,0x3ec43f35,0x3ec4bf80,0xbf6d3f35
.long 0x3f80,0xbf80,0xbf808000,0x3f808000,0x3f6d0000,0xbec43f35,0x3ec43f80,0xbf6dbf35
.long 0xbf35bf80,0x3f350000,0x3f358000,0x3f353f80,0xbec40000,0xbf6dbf35,0xbf6dbf80,0xbec4bf35
.long 0x3f803f80,0x3f803f80,0x80008000,0x80008000,0xbf6dbf80,0xbec4bf35,0xbec48000,0xbf6dbf35
.long 0x3f353f80,0xbf350000,0x3f358000,0x3f353f80,0xbec4bf80,0x3f6d3f35,0xbf6d8000,0x3ec4bf35
.long 0x3f80,0xbf80,0x3f808000,0xbf808000,0x3ec4bf80,0xbf6d3f35,0xbf6d8000,0x3ec43f35
.long 0xbf353f80,0x3f350000,0x3f358000,0x3f35bf80,0x3f6dbf80,0x3ec4bf35,0xbec48000,0xbf6d3f35
.long 0xbf803f80,0xbf803f80,0x80008000,0x80008000,0x3f6dbf80,0x3ec4bf35,0x3ec48000,0x3f6dbf35
.long 0xbf353f80,0x3f350000,0xbf358000,0xbf353f80,0x3ec4bf80,0xbf6d3f35,0x3f6d8000,0xbec4bf35
.long 0x3f80,0xbf80,0xbf808000,0x3f808000,0xbec4bf80,0x3f6d3f35,0x3f6d8000,0xbec43f35
.long 0x3f353f80,0xbf350000,0xbf358000,0xbf35bf80,0xbf6dbf80,0xbec4bf35,0x3ec48000,0x3f6d3f35
.long 0x3f803f80,0x3f803f80,0x80008000,0x80008000,0x3ec40000,0x3f6d3f35,0xbf6dbf80,0xbec4bf35
.long 0xbf35bf80,0x3f350000,0xbf358000,0xbf35bf80,0xbf6d0000,0x3ec4bf35,0x3ec43f80,0xbf6dbf35
.long 0x3f80,0xbf80,0x3f808000,0xbf808000,0x3f6d0000,0xbec4bf35,0x3ec4bf80,0xbf6d3f35
.long 0x3f35bf80,0xbf350000,0xbf358000,0xbf353f80,0xbec40000,0xbf6d3f35,0xbf6d3f80,0xbec43f35
.long 0xbf803f80,0xbf803f80,0x80008000,0x80008000,0xbec40000,0xbf6d3f35,0x3f6dbf80,0x3ec4bf35
.long 0x3f35bf80,0xbf350000,0x3f358000,0x3f35bf80,0x3f6d0000,0xbec4bf35,0xbec43f80,0x3f6dbf35
.long 0x3f80,0xbf80,0xbf808000,0x3f808000,0xbf6d0000,0x3ec4bf35,0xbec4bf80,0x3f6d3f35
.long 0xbf35bf80,0x3f350000,0x3f358000,0x3f353f80,0x3ec40000,0x3f6d3f35,0x3f6d3f80,0x3ec43f35
.long 0,0,0x3f803f80,0x3f803f80,0xbec40000,0xbf6dbf35,0x3f6d3f80,0x3ec43f35
.long 0xbf350000,0xbf35bf80,0x3f353f80,0xbf350000,0xbf6d0000,0x3ec4bf35,0x3ec43f80,0xbf6dbf35
.long 0xbf800000,0x3f800000,0x3f80,0xbf80,0xbf6d0000,0x3ec43f35,0xbec43f80,0x3f6dbf35
.long 0xbf350000,0xbf353f80,0xbf353f80,0x3f350000,0xbec40000,0xbf6d3f35,0xbf6d3f80,0xbec43f35
.long 0,0,0xbf803f80,0xbf803f80,0x3ec40000,0x3f6dbf35,0xbf6d3f80,0xbec43f35
.long 0x3f350000,0x3f35bf80,0xbf353f80,0x3f350000,0x3f6d0000,0xbec4bf35,0xbec43f80,0x3f6dbf35
.long 0x3f800000,0xbf800000,0x3f80,0xbf80,0x3f6d0000,0xbec43f35,0x3ec43f80,0xbf6dbf35
.long 0x3f350000,0x3f353f80,0x3f353f80,0xbf350000,0x3ec40000,0x3f6d3f35,0x3f6d3f80,0x3ec43f35
.long 0,0,0x3f803f80,0x3f803f80,0xbf6dbf80,0xbec4bf35,0xbec40000,0xbf6dbf35
.long 0x3f350000,0x3f353f80,0xbf35bf80,0x3f350000,0x3ec43f80,0xbf6dbf35,0x3f6d0000,0xbec43f35
.long 0xbf800000,0x3f800000,0x3f80,0xbf80,0x3ec4bf80,0xbf6d3f35,0xbf6d0000,0x3ec43f35
.long 0x3f350000,0x3f35bf80,0x3f35bf80,0xbf350000,0xbf6d3f80,0xbec43f35,0x3ec40000,0x3f6dbf35
.long 0,0,0xbf803f80,0xbf803f80,0x3f6dbf80,0x3ec4bf35,0x3ec40000,0x3f6dbf35
.long 0xbf350000,0xbf353f80,0x3f35bf80,0xbf350000,0xbec43f80,0x3f6dbf35,0xbf6d0000,0x3ec43f35
.long 0x3f800000,0xbf800000,0x3f80,0xbf80,0xbec4bf80,0x3f6d3f35,0x3f6d0000,0xbec43f35
.long 0xbf350000,0xbf35bf80,0xbf35bf80,0x3f350000,0x3f6d3f80,0x3ec43f35,0xbec40000,0xbf6dbf35
.long 0,0,0x3f803f80,0x3f803f80,0x3ec40000,0x3f6d3f35,0xbf6dbf80,0xbec4bf35
.long 0xbf350000,0xbf35bf80,0x3f353f80,0xbf350000,0x3f6d0000,0xbec43f35,0xbec4bf80,0x3f6d3f35
.long 0xbf800000,0x3f800000,0x3f80,0xbf80,0x3f6d0000,0xbec4bf35,0x3ec4bf80,0xbf6d3f35
.long 0xbf350000,0xbf353f80,0xbf353f80,0x3f350000,0x3ec40000,0x3f6dbf35,0x3f6dbf80,0x3ec4bf35
.long 0,0,0xbf803f80,0xbf803f80,0xbec40000,0xbf6d3f35,0x3f6dbf80,0x3ec4bf35
.long 0x3f350000,0x3f35bf80,0xbf353f80,0x3f350000,0xbf6d0000,0x3ec43f35,0x3ec4bf80,0xbf6d3f35
.long 0x3f800000,0xbf800000,0x3f80,0xbf80,0xbf6d0000,0x3ec4bf35,0xbec4bf80,0x3f6d3f35
.long 0x3f350000,0x3f353f80,0x3f353f80,0xbf350000,0xbec40000,0xbf6dbf35,0xbf6dbf80,0xbec4bf35
.long 0,0,0x3f803f80,0x3f803f80,0x3f6d3f80,0x3ec43f35,0x3ec40000,0x3f6d3f35
.long 0x3f350000,0x3f353f80,0xbf35bf80,0x3f350000,0xbec4bf80,0x3f6d3f35,0xbf6d0000,0x3ec4bf35
.long 0xbf800000,0x3f800000,0x3f80,0xbf80,0xbec43f80,0x3f6dbf35,0x3f6d0000,0xbec4bf35
.long 0x3f350000,0x3f35bf80,0x3f35bf80,0xbf350000,0x3f6dbf80,0x3ec4bf35,0xbec40000,0xbf6d3f35
.long 0,0,0xbf803f80,0xbf803f80,0xbf6d3f80,0xbec43f35,0xbec40000,0xbf6d3f35
.long 0xbf350000,0xbf353f80,0x3f35bf80,0xbf350000,0x3ec4bf80,0xbf6d3f35,0x3f6d0000,0xbec4bf35
.long 0x3f800000,0xbf800000,0x3f80,0xbf80,0x3ec43f80,0xbf6dbf35,0xbf6d0000,0x3ec4bf35
.long 0xbf350000,0xbf35bf80,0xbf35bf80,0x3f350000,0xbf6dbf80,0xbec4bf35,0x3ec40000,0x3f6d3f35
.long 0x3f803f80,0x3f803f80,0,0,0x3f6d3f80,0x3ec43f35,0xbec40000,0xbf6dbf35
.long 0x3f353f80,0xbf350000,0xbf350000,0xbf35bf80,0x3ec43f80,0xbf6dbf35,0xbf6d0000,0x3ec4bf35
.long 0x3f80,0xbf80,0xbf800000,0x3f800000,0xbec43f80,0x3f6dbf35,0xbf6d0000,0x3ec43f35
.long 0xbf353f80,0x3f350000,0xbf350000,0xbf353f80,0xbf6d3f80,0xbec43f35,0xbec40000,0xbf6d3f35
.long 0xbf803f80,0xbf803f80,0,0,0xbf6d3f80,0xbec43f35,0x3ec40000,0x3f6dbf35
.long 0xbf353f80,0x3f350000,0x3f350000,0x3f35bf80,0xbec43f80,0x3f6dbf35,0x3f6d0000,0xbec4bf35
.long 0x3f80,0xbf80,0x3f800000,0xbf800000,0x3ec43f80,0xbf6dbf35,0x3f6d0000,0xbec43f35
.long 0x3f353f80,0xbf350000,0x3f350000,0x3f353f80,0x3f6d3f80,0x3ec43f35,0x3ec40000,0x3f6d3f35
.long 0x3f803f80,0x3f803f80,0,0,0xbec40000,0xbf6dbf35,0xbf6dbf80,0xbec4bf35
.long 0xbf35bf80,0x3f350000,0x3f350000,0x3f353f80,0x3f6d0000,0xbec43f35,0x3ec43f80,0xbf6dbf35
.long 0x3f80,0xbf80,0xbf800000,0x3f800000,0xbf6d0000,0x3ec43f35,0x3ec4bf80,0xbf6d3f35
.long 0x3f35bf80,0xbf350000,0x3f350000,0x3f35bf80,0x3ec40000,0x3f6dbf35,0xbf6d3f80,0xbec43f35
.long 0xbf803f80,0xbf803f80,0,0,0x3ec40000,0x3f6dbf35,0x3f6dbf80,0x3ec4bf35
.long 0x3f35bf80,0xbf350000,0xbf350000,0xbf353f80,0xbf6d0000,0x3ec43f35,0xbec43f80,0x3f6dbf35
.long 0x3f80,0xbf80,0x3f800000,0xbf800000,0x3f6d0000,0xbec43f35,0xbec4bf80,0x3f6d3f35
.long 0xbf35bf80,0x3f350000,0xbf350000,0xbf35bf80,0xbec40000,0xbf6dbf35,0x3f6d3f80,0x3ec43f35
.long 0x3f803f80,0x3f803f80,0,0,0xbf6dbf80,0xbec4bf35,0x3ec40000,0x3f6d3f35
.long 0x3f353f80,0xbf350000,0xbf350000,0xbf35bf80,0xbec4bf80,0x3f6d3f35,0x3f6d0000,0xbec43f35
.long 0x3f80,0xbf80,0xbf800000,0x3f800000,0x3ec4bf80,0xbf6d3f35,0x3f6d0000,0xbec4bf35
.long 0xbf353f80,0x3f350000,0xbf350000,0xbf353f80,0x3f6dbf80,0x3ec4bf35,0x3ec40000,0x3f6dbf35
.long 0xbf803f80,0xbf803f80,0,0,0x3f6dbf80,0x3ec4bf35,0xbec40000,0xbf6d3f35
.long 0xbf353f80,0x3f350000,0x3f350000,0x3f35bf80,0x3ec4bf80,0xbf6d3f35,0xbf6d0000,0x3ec43f35
.long 0x3f80,0xbf80,0x3f800000,0xbf800000,0xbec4bf80,0x3f6d3f35,0xbf6d0000,0x3ec4bf35
.long 0x3f353f80,0xbf350000,0x3f350000,0x3f353f80,0xbf6dbf80,0xbec4bf35,0xbec40000,0xbf6dbf35
.long 0x3f803f80,0x3f803f80,0,0,0x3ec40000,0x3f6d3f35,0x3f6d3f80,0x3ec43f35
.long 0xbf35bf80,0x3f350000,0x3f350000,0x3f353f80,0xbf6d0000,0x3ec4bf35,0xbec4bf80,0x3f6d3f35
.long 0x3f80,0xbf80,0xbf800000,0x3f800000,0x3f6d0000,0xbec4bf35,0xbec43f80,0x3f6dbf35
.long 0x3f35bf80,0xbf350000,0x3f350000,0x3f35bf80,0xbec40000,0xbf6d3f35,0x3f6dbf80,0x3ec4bf35
.long 0xbf803f80,0xbf803f80,0,0,0xbec40000,0xbf6d3f35,0xbf6d3f80,0xbec43f35
.long 0x3f35bf80,0xbf350000,0xbf350000,0xbf353f80,0x3f6d0000,0xbec4bf35,0x3ec4bf80,0xbf6d3f35
.long 0x3f80,0xbf80,0x3f800000,0xbf800000,0xbf6d0000,0x3ec4bf35,0x3ec43f80,0xbf6dbf35
.long 0xbf35bf80,0x3f350000,0xbf350000,0xbf35bf80,0x3ec40000,0x3f6d3f35,0xbf6dbf80,0xbec4bf35
.long 0x80008000,0x80008000,0x3f803f80,0x3f803f80,0x3ec48000,0x3f6d3f35,0x3f6d3f80,0x3ec43f35
.long 0x3f358000,0x3f353f80,0x3f353f80,0xbf350000,0x3f6d8000,0xbec43f35,0x3ec43f80,0xbf6dbf35
.long 0x3f808000,0xbf808000,0x3f80,0xbf80,0x3f6d8000,0xbec4bf35,0xbec43f80,0x3f6dbf35
.long 0x3f358000,0x3f35bf80,0xbf353f80,0x3f350000,0x3ec48000,0x3f6dbf35,0xbf6d3f80,0xbec43f35
.long 0x80008000,0x80008000,0xbf803f80,0xbf803f80,0xbec48000,0xbf6d3f35,0xbf6d3f80,0xbec43f35
.long 0xbf358000,0xbf353f80,0xbf353f80,0x3f350000,0xbf6d8000,0x3ec43f35,0xbec43f80,0x3f6dbf35
.long 0xbf808000,0x3f808000,0x3f80,0xbf80,0xbf6d8000,0x3ec4bf35,0x3ec43f80,0xbf6dbf35
.long 0xbf358000,0xbf35bf80,0x3f353f80,0xbf350000,0xbec48000,0xbf6dbf35,0x3f6d3f80,0x3ec43f35
.long 0x80008000,0x80008000,0x3f803f80,0x3f803f80,0x3f6d3f80,0x3ec43f35,0xbec40000,0xbf6dbf35
.long 0xbf358000,0xbf35bf80,0xbf35bf80,0x3f350000,0xbec4bf80,0x3f6d3f35,0x3f6d0000,0xbec43f35
.long 0x3f808000,0xbf808000,0x3f80,0xbf80,0xbec43f80,0x3f6dbf35,0xbf6d0000,0x3ec43f35
.long 0xbf358000,0xbf353f80,0x3f35bf80,0xbf350000,0x3f6dbf80,0x3ec4bf35,0x3ec40000,0x3f6dbf35
.long 0x80008000,0x80008000,0xbf803f80,0xbf803f80,0xbf6d3f80,0xbec43f35,0x3ec40000,0x3f6dbf35
.long 0x3f358000,0x3f35bf80,0x3f35bf80,0xbf350000,0x3ec4bf80,0xbf6d3f35,0xbf6d0000,0x3ec43f35
.long 0xbf808000,0x3f808000,0x3f80,0xbf80,0x3ec43f80,0xbf6dbf35,0x3f6d0000,0xbec43f35
.long 0x3f358000,0x3f353f80,0xbf35bf80,0x3f350000,0xbf6dbf80,0xbec4bf35,0xbec40000,0xbf6dbf35
.long 0x80008000,0x80008000,0x3f803f80,0x3f803f80,0xbec48000,0xbf6dbf35,0xbf6dbf80,0xbec4bf35
.long 0x3f358000,0x3f353f80,0x3f353f80,0xbf350000,0xbf6d8000,0x3ec4bf35,0xbec4bf80,0x3f6d3f35
.long 0x3f808000,0xbf808000,0x3f80,0xbf80,0xbf6d8000,0x3ec43f35,0x3ec4bf80,0xbf6d3f35
.long 0x3f358000,0x3f35bf80,0xbf353f80,0x3f350000,0xbec48000,0xbf6d3f35,0x3f6dbf80,0x3ec4bf35
.long 0x80008000,0x80008000,0xbf803f80,0xbf803f80,0x3ec48000,0x3f6dbf35,0x3f6dbf80,0x3ec4bf35
.long 0xbf358000,0xbf353f80,0xbf353f80,0x3f350000,0x3f6d8000,0xbec4bf35,0x3ec4bf80,0xbf6d3f35
.long 0xbf808000,0x3f808000,0x3f80,0xbf80,0x3f6d8000,0xbec43f35,0xbec4bf80,0x3f6d3f35
.long 0xbf358000,0xbf35bf80,0x3f353f80,0xbf350000,0x3ec48000,0x3f6d3f35,0xbf6dbf80,0xbec4bf35
.long 0x80008000,0x80008000,0x3f803f80,0x3f803f80,0xbf6dbf80,0xbec4bf35,0x3ec40000,0x3f6d3f35
.long 0xbf358000,0xbf35bf80,0xbf35bf80,0x3f350000,0x3ec43f80,0xbf6dbf35,0xbf6d0000,0x3ec4bf35
.long 0x3f808000,0xbf808000,0x3f80,0xbf80,0x3ec4bf80,0xbf6d3f35,0x3f6d0000,0xbec4bf35
.long 0xbf358000,0xbf353f80,0x3f35bf80,0xbf350000,0xbf6d3f80,0xbec43f35,0xbec40000,0xbf6d3f35
.long 0x80008000,0x80008000,0xbf803f80,0xbf803f80,0x3f6dbf80,0x3ec4bf35,0xbec40000,0xbf6d3f35
.long 0x3f358000,0x3f35bf80,0x3f35bf80,0xbf350000,0xbec43f80,0x3f6dbf35,0x3f6d0000,0xbec4bf35
.long 0xbf808000,0x3f808000,0x3f80,0xbf80,0xbec4bf80,0x3f6d3f35,0xbf6d0000,0x3ec4bf35
.long 0x3f358000,0x3f353f80,0xbf35bf80,0x3f350000,0x3f6d3f80,0x3ec43f35,0x3ec40000,0x3f6d3f35
.long 0x3f80,0x3f80,0x3f80,0x3f80,0x3f80,0xbe483f7b,0xbec43f6d,0xbf0e3f55
.long 0x3f80,0xbec43f6d,0xbf353f35,0xbf6d3ec4,0x3f80,0xbf0e3f55,0xbf6d3ec4,0xbf7bbe48
.long 0x3f80,0xbf800000,0xbf80,0x3f800000,0x3f80,0xbf7bbe48,0x3ec4bf6d,0x3f553f0e
.long 0x3f80,0xbf6dbec4,0x3f35bf35,0x3ec43f6d,0x3f80,0xbf55bf0e,0x3f6dbec4,0xbe483f7b
.long 0x3f80,0xbf80,0x3f80,0xbf80,0x3f80,0x3e48bf7b,0xbec43f6d,0x3f0ebf55
.long 0x3f80,0x3ec4bf6d,0xbf353f35,0x3f6dbec4,0x3f80,0x3f0ebf55,0xbf6d3ec4,0x3f7b3e48
.long 0x3f80,0x3f800000,0xbf80,0xbf800000,0x3f80,0x3f7b3e48,0x3ec4bf6d,0xbf55bf0e
.long 0x3f80,0x3f6d3ec4,0x3f35bf35,0xbec4bf6d,0x3f80,0x3f553f0e,0x3f6dbec4,0x3e48bf7b
.long 0x3f80,0x3f80,0x3f80,0x3f80,0xbf353f35,0xbf553f0e,0xbf6d3ec4,0xbf7b3e48
.long 0xbf800000,0xbf6dbec4,0xbf35bf35,0xbec4bf6d,0xbf35bf35,0xbe48bf7b,0x3ec4bf6d,0x3f55bf0e
.long 0x3f80,0xbf800000,0xbf80,0x3f800000,0xbf353f35,0xbf0ebf55,0x3f6dbec4,0x3e483f7b
.long 0xbf800000,0x3ec4bf6d,0x3f353f35,0xbf6d3ec4,0xbf35bf35,0x3f7bbe48,0xbec43f6d,0xbf0ebf55
.long 0x3f80,0xbf80,0x3f80,0xbf80,0xbf353f35,0x3f55bf0e,0xbf6d3ec4,0x3f7bbe48
.long 0xbf800000,0x3f6d3ec4,0xbf35bf35,0x3ec43f6d,0xbf35bf35,0x3e483f7b,0x3ec4bf6d,0xbf553f0e
.long 0x3f80,0x3f800000,0xbf80,0xbf800000,0xbf353f35,0x3f0e3f55,0x3f6dbec4,0xbe48bf7b
.long 0xbf800000,0xbec43f6d,0x3f353f35,0x3f6dbec4,0xbf35bf35,0xbf7b3e48,0xbec43f6d,0x3f0e3f55
.long 0x3f80,0x3f80,0x3f80,0x3f80,0xbf800000,0xbf7bbe48,0xbf6dbec4,0xbf55bf0e
.long 0xbf80,0x3ec4bf6d,0x3f35bf35,0x3f6dbec4,0x3f800000,0x3f553f0e,0x3ec43f6d,0xbe483f7b
.long 0x3f80,0xbf800000,0xbf80,0x3f800000,0xbf800000,0x3e48bf7b,0x3f6d3ec4,0xbf0e3f55
.long 0xbf80,0x3f6d3ec4,0xbf353f35,0xbec4bf6d,0x3f800000,0xbf0e3f55,0xbec4bf6d,0x3f7b3e48
.long 0x3f80,0xbf80,0x3f80,0xbf80,0xbf800000,0x3f7b3e48,0xbf6dbec4,0x3f553f0e
.long 0xbf80,0xbec43f6d,0x3f35bf35,0xbf6d3ec4,0x3f800000,0xbf55bf0e,0x3ec43f6d,0x3e48bf7b
.long 0x3f80,0x3f800000,0xbf80,0xbf800000,0xbf800000,0xbe483f7b,0x3f6d3ec4,0x3f0ebf55
.long 0xbf80,0xbf6dbec4,0xbf353f35,0x3ec43f6d,0x3f800000,0x3f0ebf55,0xbec4bf6d,0xbf7bbe48
.long 0x3f80,0x3f80,0x3f80,0x3f80,0xbf35bf35,0xbf0ebf55,0xbec4bf6d,0xbe48bf7b
.long 0x3f800000,0x3f6d3ec4,0x3f353f35,0x3ec43f6d,0xbf353f35,0xbf7b3e48,0xbf6dbec4,0xbf0ebf55
.long 0x3f80,0xbf800000,0xbf80,0x3f800000,0xbf35bf35,0x3f55bf0e,0x3ec43f6d,0xbf7b3e48
.long 0x3f800000,0xbec43f6d,0xbf35bf35,0x3f6dbec4,0xbf353f35,0xbe48bf7b,0x3f6d3ec4,0xbf553f0e
.long 0x3f80,0xbf80,0x3f80,0xbf80,0xbf35bf35,0x3f0e3f55,0xbec4bf6d,0x3e483f7b
.long 0x3f800000,0xbf6dbec4,0x3f353f35,0xbec4bf6d,0xbf353f35,0x3f7bbe48,0xbf6dbec4,0x3f0e3f55
.long 0x3f80,0x3f800000,0xbf80,0xbf800000,0xbf35bf35,0xbf553f0e,0x3ec43f6d,0x3f7bbe48
.long 0x3f800000,0x3ec4bf6d,0xbf35bf35,0xbf6d3ec4,0xbf353f35,0x3e483f7b,0x3f6d3ec4,0x3f55bf0e
.long 0x3f808000,0x3f808000,0x3f808000,0x3f808000,0x3f808000,0x3f7b3e48,0x3f6d3ec4,0x3f553f0e
.long 0x3f808000,0x3f6d3ec4,0x3f353f35,0x3ec43f6d,0x3f808000,0x3f553f0e,0x3ec43f6d,0xbe483f7b
.long 0x3f808000,0x3f80,0xbf808000,0xbf80,0x3f808000,0xbe483f7b,0xbf6dbec4,0x3f0ebf55
.long 0x3f808000,0xbec43f6d,0xbf35bf35,0x3f6dbec4,0x3f808000,0xbf0e3f55,0xbec4bf6d,0x3f7b3e48
.long 0x3f808000,0xbf808000,0x3f808000,0xbf808000,0x3f808000,0xbf7bbe48,0x3f6d3ec4,0xbf55bf0e
.long 0x3f808000,0xbf6dbec4,0x3f353f35,0xbec4bf6d,0x3f808000,0xbf55bf0e,0x3ec43f6d,0x3e48bf7b
.long 0x3f808000,0xbf80,0xbf808000,0x3f80,0x3f808000,0x3e48bf7b,0xbf6dbec4,0xbf0e3f55
.long 0x3f808000,0x3ec4bf6d,0xbf35bf35,0xbf6d3ec4,0x3f808000,0x3f0ebf55,0xbec4bf6d,0xbf7bbe48
.long 0x3f808000,0x3f808000,0x3f808000,0x3f808000,0x3f353f35,0x3f0e3f55,0x3ec43f6d,0x3e483f7b
.long 0x3f80,0xbec43f6d,0xbf353f35,0xbf6d3ec4,0xbf353f35,0xbf7b3e48,0xbf6dbec4,0xbf0ebf55
.long 0x3f808000,0x3f80,0xbf808000,0xbf80,0x3f353f35,0xbf553f0e,0xbec4bf6d,0x3f7bbe48
.long 0x3f80,0xbf6dbec4,0x3f35bf35,0x3ec43f6d,0xbf353f35,0xbe48bf7b,0x3f6d3ec4,0xbf553f0e
.long 0x3f808000,0xbf808000,0x3f808000,0xbf808000,0x3f353f35,0xbf0ebf55,0x3ec43f6d,0xbe48bf7b
.long 0x3f80,0x3ec4bf6d,0xbf353f35,0x3f6dbec4,0xbf353f35,0x3f7bbe48,0xbf6dbec4,0x3f0e3f55
.long 0x3f808000,0xbf80,0xbf808000,0x3f80,0x3f353f35,0x3f55bf0e,0xbec4bf6d,0xbf7b3e48
.long 0x3f80,0x3f6d3ec4,0x3f35bf35,0xbec4bf6d,0xbf353f35,0x3e483f7b,0x3f6d3ec4,0x3f55bf0e
.long 0x3f808000,0x3f808000,0x3f808000,0x3f808000,0x3f80,0xbe483f7b,0xbec43f6d,0xbf0e3f55
.long 0xbf808000,0xbf6dbec4,0xbf35bf35,0xbec4bf6d,0xbf80,0x3f0ebf55,0x3f6dbec4,0x3f7b3e48
.long 0x3f808000,0x3f80,0xbf808000,0xbf80,0x3f80,0xbf7bbe48,0x3ec4bf6d,0x3f553f0e
.long 0xbf808000,0x3ec4bf6d,0x3f353f35,0xbf6d3ec4,0xbf80,0x3f553f0e,0xbf6d3ec4,0x3e48bf7b
.long 0x3f808000,0xbf808000,0x3f808000,0xbf808000,0x3f80,0x3e48bf7b,0xbec43f6d,0x3f0ebf55
.long 0xbf808000,0x3f6d3ec4,0xbf35bf35,0x3ec43f6d,0xbf80,0xbf0e3f55,0x3f6dbec4,0xbf7bbe48
.long 0x3f808000,0xbf80,0xbf808000,0x3f80,0x3f80,0x3f7b3e48,0x3ec4bf6d,0xbf55bf0e
.long 0xbf808000,0xbec43f6d,0x3f353f35,0x3f6dbec4,0xbf80,0xbf55bf0e,0xbf6d3ec4,0xbe483f7b
.long 0x3f808000,0x3f808000,0x3f808000,0x3f808000,0xbf353f35,0xbf553f0e,0xbf6d3ec4,0xbf7b3e48
.long 0xbf80,0x3ec4bf6d,0x3f35bf35,0x3f6dbec4,0x3f353f35,0x3e483f7b,0xbec43f6d,0xbf553f0e
.long 0x3f808000,0x3f80,0xbf808000,0xbf80,0xbf353f35,0xbf0ebf55,0x3f6dbec4,0x3e483f7b
.long 0xbf80,0x3f6d3ec4,0xbf353f35,0xbec4bf6d,0x3f353f35,0xbf7b3e48,0x3ec4bf6d,0x3f0e3f55
.long 0x3f808000,0xbf808000,0x3f808000,0xbf808000,0xbf353f35,0x3f55bf0e,0xbf6d3ec4,0x3f7bbe48
.long 0xbf80,0xbec43f6d,0x3f35bf35,0xbf6d3ec4,0x3f353f35,0xbe48bf7b,0xbec43f6d,0x3f55bf0e
.long 0x3f808000,0xbf80,0xbf808000,0x3f80,0xbf353f35,0x3f0e3f55,0x3f6dbec4,0xbe48bf7b
.long 0xbf80,0xbf6dbec4,0xbf353f35,0x3ec43f6d,0x3f353f35,0x3f7bbe48,0x3ec4bf6d,0xbf0ebf55
.long 0x3f80,0xbf353f35,0xbf800000,0xbf35bf35,0x3f80,0xbf553f0e,0xbf6dbec4,0xbe48bf7b
.long 0x3f80,0xbf6d3ec4,0xbf35bf35,0x3ec4bf6d,0x3f80,0xbf7b3e48,0xbec4bf6d,0x3f55bf0e
.long 0x3f80,0xbf35bf35,0x3f800000,0xbf353f35,0x3f80,0xbf0ebf55,0x3f6d3ec4,0xbf7b3e48
.long 0x3f80,0xbec4bf6d,0x3f353f35,0xbf6dbec4,0x3f80,0xbe48bf7b,0x3ec43f6d,0xbf0ebf55
.long 0x3f80,0x3f35bf35,0xbf800000,0x3f353f35,0x3f80,0x3f55bf0e,0xbf6dbec4,0x3e483f7b
.long 0x3f80,0x3f6dbec4,0xbf35bf35,0xbec43f6d,0x3f80,0x3f7bbe48,0xbec4bf6d,0xbf553f0e
.long 0x3f80,0x3f353f35,0x3f800000,0x3f35bf35,0x3f80,0x3f0e3f55,0x3f6d3ec4,0x3f7bbe48
.long 0x3f80,0x3ec43f6d,0x3f353f35,0x3f6d3ec4,0x3f80,0x3e483f7b,0x3ec43f6d,0x3f0e3f55
.long 0xbf80,0x3f35bf35,0x3f800000,0x3f353f35,0x3f35bf35,0x3f7b3e48,0x3ec43f6d,0xbf0e3f55
.long 0x3f800000,0x3ec43f6d,0xbf353f35,0xbf6dbec4,0x3f353f35,0xbf0e3f55,0xbf6dbec4,0x3e48bf7b
.long 0xbf80,0x3f353f35,0xbf800000,0x3f35bf35,0x3f35bf35,0xbe483f7b,0xbec4bf6d,0x3f553f0e
.long 0x3f800000,0xbf6d3ec4,0x3f35bf35,0xbec43f6d,0x3f353f35,0xbf55bf0e,0x3f6d3ec4,0xbf7bbe48
.long 0xbf80,0xbf353f35,0x3f800000,0xbf35bf35,0x3f35bf35,0xbf7bbe48,0x3ec43f6d,0x3f0ebf55
.long 0x3f800000,0xbec4bf6d,0xbf353f35,0x3f6d3ec4,0x3f353f35,0x3f0ebf55,0xbf6dbec4,0xbe483f7b
.long 0xbf80,0xbf35bf35,0xbf800000,0xbf353f35,0x3f35bf35,0x3e48bf7b,0xbec4bf6d,0xbf55bf0e
.long 0x3f800000,0x3f6dbec4,0x3f35bf35,0x3ec4bf6d,0x3f353f35,0x3f553f0e,0x3f6d3ec4,0x3f7b3e48
.long 0x3f80,0xbf353f35,0xbf800000,0xbf35bf35,0xbf800000,0xbf0ebf55,0x3ec4bf6d,0x3f7bbe48
.long 0xbf80,0x3f6dbec4,0x3f353f35,0xbec43f6d,0x3f800000,0x3e483f7b,0xbf6d3ec4,0xbf0ebf55
.long 0x3f80,0xbf35bf35,0x3f800000,0xbf353f35,0xbf800000,0x3f55bf0e,0xbec43f6d,0xbe48bf7b
.long 0xbf80,0x3ec43f6d,0xbf35bf35,0x3f6d3ec4,0x3f800000,0xbf7b3e48,0x3f6dbec4,0xbf553f0e
.long 0x3f80,0x3f35bf35,0xbf800000,0x3f353f35,0xbf800000,0x3f0e3f55,0x3ec4bf6d,0xbf7b3e48
.long 0xbf80,0xbf6d3ec4,0x3f353f35,0x3ec4bf6d,0x3f800000,0xbe48bf7b,0xbf6d3ec4,0x3f0e3f55
.long 0x3f80,0x3f353f35,0x3f800000,0x3f35bf35,0xbf800000,0xbf553f0e,0xbec43f6d,0x3e483f7b
.long 0xbf80,0xbec4bf6d,0xbf35bf35,0xbf6dbec4,0x3f800000,0x3f7bbe48,0x3f6dbec4,0x3f55bf0e
.long 0xbf80,0x3f35bf35,0x3f800000,0x3f353f35,0x3f353f35,0xbe483f7b,0xbf6d3ec4,0xbf55bf0e
.long 0xbf800000,0xbec4bf6d,0x3f35bf35,0x3f6d3ec4,0x3f35bf35,0x3f553f0e,0xbec43f6d,0xbf7bbe48
.long 0xbf80,0x3f353f35,0xbf800000,0x3f35bf35,0x3f353f35,0xbf7bbe48,0x3f6dbec4,0xbf0e3f55
.long 0xbf800000,0x3f6dbec4,0xbf353f35,0x3ec4bf6d,0x3f35bf35,0xbf0e3f55,0x3ec4bf6d,0xbe483f7b
.long 0xbf80,0xbf353f35,0x3f800000,0xbf35bf35,0x3f353f35,0x3e48bf7b,0xbf6d3ec4,0x3f553f0e
.long 0xbf800000,0x3ec43f6d,0x3f35bf35,0xbf6dbec4,0x3f35bf35,0xbf55bf0e,0xbec43f6d,0x3f7b3e48
.long 0xbf80,0xbf35bf35,0xbf800000,0xbf353f35,0x3f353f35,0x3f7b3e48,0x3f6dbec4,0x3f0ebf55
.long 0xbf800000,0xbf6d3ec4,0xbf353f35,0xbec43f6d,0x3f35bf35,0x3f0ebf55,0x3ec4bf6d,0x3e48bf7b
.long 0x3f808000,0x3f353f35,0x3f80,0xbf353f35,0x3f808000,0x3f0e3f55,0xbec43f6d,0xbf7b3e48
.long 0x3f808000,0x3ec43f6d,0xbf353f35,0xbf6dbec4,0x3f808000,0x3e483f7b,0xbf6d3ec4,0xbf0ebf55
.long 0x3f808000,0xbf353f35,0xbf80,0x3f353f35,0x3f808000,0xbf553f0e,0x3ec4bf6d,0x3e483f7b
.long 0x3f808000,0xbf6d3ec4,0x3f35bf35,0xbec43f6d,0x3f808000,0xbf7b3e48,0x3f6dbec4,0xbf553f0e
.long 0x3f808000,0xbf35bf35,0x3f80,0x3f35bf35,0x3f808000,0xbf0ebf55,0xbec43f6d,0x3f7bbe48
.long 0x3f808000,0xbec4bf6d,0xbf353f35,0x3f6d3ec4,0x3f808000,0xbe48bf7b,0xbf6d3ec4,0x3f0e3f55
.long 0x3f808000,0x3f35bf35,0xbf80,0xbf35bf35,0x3f808000,0x3f55bf0e,0x3ec4bf6d,0xbe48bf7b
.long 0x3f808000,0x3f6dbec4,0x3f35bf35,0x3ec4bf6d,0x3f808000,0x3f7bbe48,0x3f6dbec4,0x3f55bf0e
.long 0xbf808000,0xbf35bf35,0xbf80,0x3f35bf35,0xbf35bf35,0x3e48bf7b,0x3f6dbec4,0x3f553f0e
.long 0xbf80,0x3f6dbec4,0x3f353f35,0xbec43f6d,0x3f35bf35,0x3f553f0e,0xbec43f6d,0xbf7bbe48
.long 0xbf808000,0x3f35bf35,0x3f80,0xbf35bf35,0xbf35bf35,0x3f7b3e48,0xbf6d3ec4,0x3f0ebf55
.long 0xbf80,0x3ec43f6d,0xbf35bf35,0x3f6d3ec4,0x3f35bf35,0xbf0e3f55,0x3ec4bf6d,0xbe483f7b
.long 0xbf808000,0x3f353f35,0xbf80,0xbf353f35,0xbf35bf35,0xbe483f7b,0x3f6dbec4,0xbf55bf0e
.long 0xbf80,0xbf6d3ec4,0x3f353f35,0x3ec4bf6d,0x3f35bf35,0xbf55bf0e,0xbec43f6d,0x3f7b3e48
.long 0xbf808000,0xbf353f35,0x3f80,0x3f353f35,0xbf35bf35,0xbf7bbe48,0xbf6d3ec4,0xbf0e3f55
.long 0xbf80,0xbec4bf6d,0xbf35bf35,0xbf6dbec4,0x3f35bf35,0x3f0ebf55,0x3ec4bf6d,0x3e48bf7b
.long 0x3f808000,0x3f353f35,0x3f80,0xbf353f35,0x3f80,0xbf553f0e,0xbf6dbec4,0xbe48bf7b
.long 0xbf808000,0xbec4bf6d,0x3f35bf35,0x3f6d3ec4,0xbf80,0x3f7bbe48,0x3ec43f6d,0xbf553f0e
.long 0x3f808000,0xbf353f35,0xbf80,0x3f353f35,0x3f80,0xbf0ebf55,0x3f6d3ec4,0xbf7b3e48
.long 0xbf808000,0x3f6dbec4,0xbf353f35,0x3ec4bf6d,0xbf80,0x3e483f7b,0xbec4bf6d,0x3f0e3f55
.long 0x3f808000,0xbf35bf35,0x3f80,0x3f35bf35,0x3f80,0x3f55bf0e,0xbf6dbec4,0x3e483f7b
.long 0xbf808000,0x3ec43f6d,0x3f35bf35,0xbf6dbec4,0xbf80,0xbf7b3e48,0x3ec43f6d,0x3f55bf0e
.long 0x3f808000,0x3f35bf35,0xbf80,0xbf35bf35,0x3f80,0x3f0e3f55,0x3f6d3ec4,0x3f7bbe48
.long 0xbf808000,0xbf6d3ec4,0xbf353f35,0xbec43f6d,0xbf80,0xbe48bf7b,0xbec4bf6d,0xbf0ebf55
.long 0xbf808000,0xbf35bf35,0xbf80,0x3f35bf35,0x3f35bf35,0x3f7b3e48,0x3ec43f6d,0xbf0e3f55
.long 0x3f80,0xbf6d3ec4,0xbf35bf35,0x3ec4bf6d,0xbf35bf35,0x3f0ebf55,0x3f6d3ec4,0xbe483f7b
.long 0xbf808000,0x3f35bf35,0x3f80,0xbf35bf35,0x3f35bf35,0xbe483f7b,0xbec4bf6d,0x3f553f0e
.long 0x3f80,0xbec4bf6d,0x3f353f35,0xbf6dbec4,0xbf35bf35,0x3f553f0e,0xbf6dbec4,0x3f7b3e48
.long 0xbf808000,0x3f353f35,0xbf80,0xbf353f35,0x3f35bf35,0xbf7bbe48,0x3ec43f6d,0x3f0ebf55
.long 0x3f80,0x3f6dbec4,0xbf35bf35,0xbec43f6d,0xbf35bf35,0xbf0e3f55,0x3f6d3ec4,0x3e48bf7b
.long 0xbf808000,0xbf353f35,0x3f80,0x3f353f35,0x3f35bf35,0x3e48bf7b,0xbec4bf6d,0xbf55bf0e
.long 0x3f80,0x3ec43f6d,0x3f353f35,0x3f6d3ec4,0xbf35bf35,0xbf55bf0e,0xbf6dbec4,0xbf7bbe48
.long 0x354ccccd,0x354ccccd,0x354ccccd,0x354ccccd,0x354ccccd,0x354cca46,0x354cc2b2,0x354cb610
.long 0x354ccccd,0x354cc2b2,0x354ca461,0x354c71de,0x354ccccd,0x354cb610,0x354c71de,0x354c0047
.long 0x354ccccd,0x354c2b2e,0x354a4751,0x35472430,0x354ccccd,0x354c0047,0x35499c4e,0x3545a5a8
.long 0x354ccccd,0x354bd057,0x3548dd65,0x3543fb3c,0x354ccccd,0x354b9b60,0x35480aaa,0x3542254b
.long 0x354ccccd,0x354a4751,0x3542c6c0,0x35367a67,0x354ccccd,0x3549f44d,0x35417f0c,0x3533a936
.long 0x354ccccd,0x35499c4e,0x3540243f,0x3530b021,0x354ccccd,0x35493f55,0x353eb67b,0x352d8fd0
.long 0x354ccccd,0x35472430,0x35367a67,0x351bbb2c,0x354ccccd,0x3546a993,0x35349e13,0x3517bf2e
.long 0x354ccccd,0x35462a0f,0x3532afeb,0x3513a17d,0x354ccccd,0x3545a5a8,0x3530b021,0x350f6305
.long 0x354ccccd,0x354ccccd,0x354ccccd,0x354ccccd,0x354ca461,0x354c8da6,0x354c71de,0x354c510b
.long 0x354c2b2e,0x354bd057,0x354b6163,0x354ade5d,0x354b6163,0x354a9556,0x35499c4e,0x35487681
.long 0x3542c6c0,0x353d35e5,0x35367a67,0x352e9ee7,0x3540243f,0x35392313,0x3530b021,0x3526dc49
.long 0x353d35e5,0x35349e13,0x352a48f4,0x351e5003,0x3539fcdb,0x352fa9af,0x35234a91,0x35150468
.long 0x3525afca,0x3510d0c3,0x34f0c1c0,0x34b9f45b,0x3520d539,0x35098908,0x34dcd4c0,0x34a07465
.long 0x351bbb2c,0x3501ec7b,0x34c823a7,0x34863284,0x351663a6,0x34f3ff99,0x34b2c0d3,0x34569ce7
.long 0x34f0c1c0,0x349cbf44,0x340026af,0xb3808c21,0x34e38fc3,0x3489fd76,0x33a0975e,0xb3f06739
.long 0x34d603f2,0x346dcd1c,0x3300a585,0xb42f8fe3,0x34c823a7,0x34470ca3,0xb280abdf,0xb46617fd
.long 0x354ccccd,0x354ccccd,0x354ccccd,0x354ccccd,0x354c2b2e,0x354c0047,0x354bd057,0x354b9b60
.long 0x354a4751,0x35499c4e,0x3548dd65,0x35480aaa,0x35472430,0x3545a5a8,0x3543fb3c,0x3542254b
.long 0x3525afca,0x351bbb2c,0x3510d0c3,0x350501c8,0x351bbb2c,0x350f6305,0x3501ec7b,0x34e6e4e3
.long 0x3510d0c3,0x3501ec7b,0x34e38fc3,0x34c11588,0x350501c8,0x34e6e4e3,0x34c11588,0x34990646
.long 0x347d2590,0x340026af,0,0xb40026af,0x343f3d0b,0x3361031c,0xb3a0975e,0xb4569ce7
.long 0x340026af,0xb280abdf,0xb41fd168,0xb4954980,0x33808c21,0xb3b0973e,0xb46dcd1c,0xb4bd8748
.long 0xb47d2590,0xb4d603f2,0xb510d0c3,0xb52e9ee7,0xb49cbf44,0xb4f3ff99,0xb51e5003,0xb5392313
.long 0xb4b9f45b,0xb50809f5,0xb52a48f4,0xb5417f0c,0xb4d603f2,0xb5150468,0xb5349e13,0xb54799e3
.long 0x354ccccd,0x354ccccd,0x354ccccd,0x354ccccd,0x354b6163,0x354b2261,0x354ade5d,0x354a9556
.long 0x35472430,0x35462a0f,0x35451c60,0x3543fb3c,0x3540243f,0x353df888,0x353ba2a3,0x35392313
.long 0x34f0c1c0,0x34d603f2,0x34b9f45b,0x349cbf44,0x34c823a7,0x34a7d2ae,0x34863284,0x34470ca3
.long 0x349cbf44,0x346dcd1c,0x341fd168,0x33a0975e,0x345e5d30,0x34081699,0x3340e869,0xb320c8f3
.long 0xb47d2590,0xb4b9f45b,0xb4f0c1c0,0xb510d0c3,0xb4ab7ba8,0xb4e6e4e3,0xb50df1bd,0xb5247f35
.long 0xb4d603f2,0xb50809f5,0xb520d539,0xb5349e13,0xb4fd94b5,0xb51a6af9,0xb530b021,0xb540d407
.long 0xb542c6c0,0xb54c2b2e,0xb54a4751,0xb53d35e5,0xb548dd65,0xb54c8da6,0xb543fb3c,0xb52fa9af
.long 0xb54c2b2e,0xb5499c4e,0xb539fcdb,0xb51e5003,0xb54ca461,0xb5436367,0xb52c7c70,0xb5098908
.long 0x80000000,0x80000000,0x80000000,0x80000000,0x80000000,0x3200ad75,0x3280abdf,0x32c0fdd6
.long 0x80000000,0x3280abdf,0x3300a585,0x3340e869,0x80000000,0x32c0fdd6,0x3340e869,0x33909388
.long 0x80000000,0x33808c21,0x340026af,0x343f3d0b,0x80000000,0x33909388,0x34100327,0x34569ce7
.long 0x80000000,0x33a0975e,0x341fd168,0x346dcd1c,0x80000000,0x33b0973e,0x342f8fe3,0x34826442
.long 0x80000000,0x340026af,0x347d2590,0x34b9f45b,0x80000000,0x34081699,0x34863284,0x34c49f04
.long 0x80000000,0x34100327,0x348dc501,0x34cf1e05,0x80000000,0x3417ec27,0x34954980,0x34d96f08
.long 0x80000000,0x343f3d0b,0x34b9f45b,0x350501c8,0x80000000,0x34470ca3,0x34c11588,0x35098908
.long 0x80000000,0x344ed752,0x34c823a7,0x350df1bd,0x80000000,0x34569ce7,0x34cf1e05,0x35123aee
.long 0x80000000,0x80000000,0x80000000,0x80000000,0x3300a585,0x3320c8f3,0x3340e869,0x3361031c
.long 0x33808c21,0x33a0975e,0x33c092c2,0x33e07b24,0x33c092c2,0x33f06739,0x34100327,0x3427b2b7
.long 0x347d2590,0x349cbf44,0x34b9f45b,0x34d603f2,0x348dc501,0x34af2067,0x34cf1e05,0x34ed7df6
.long 0x349cbf44,0x34c11588,0x34e38fc3,0x3501ec7b,0x34ab7ba8,0x34d29394,0x34f7376d,0x350c7cf5
.long 0x34f0c1c0,0x3510d0c3,0x3525afca,0x35367a67,0x34fd94b5,0x3517bf2e,0x352c7c70,0x353c6e97
.long 0x350501c8,0x351e5003,0x3532afeb,0x35417f0c,0x350b04b5,0x35247f35,0x353844b9,0x3545a5a8
.long 0x3525afca,0x353d35e5,0x354a4751,0x354c2b2e,0x352a48f4,0x3540d407,0x354bd057,0x354a9556
.long 0x352e9ee7,0x3543fb3c,0x354ca461,0x35480aaa,0x3532afeb,0x3546a993,0x354cc2b2,0x35448e3a
.long 0x80000000,0x80000000,0x80000000,0x80000000,0x33808c21,0x33909388,0x33a0975e,0x33b0973e
.long 0x340026af,0x34100327,0x341fd168,0x342f8fe3,0x343f3d0b,0x34569ce7,0x346dcd1c,0x34826442
.long 0x34f0c1c0,0x350501c8,0x3510d0c3,0x351bbb2c,0x350501c8,0x35123aee,0x351e5003,0x352928e5
.long 0x3510d0c3,0x351e5003,0x352a48f4,0x35349e13,0x351bbb2c,0x352928e5,0x35349e13,0x353df888
.long 0x3542c6c0,0x354a4751,0x354ccccd,0x354a4751,0x35472430,0x354c510b,0x354bd057,0x3545a5a8
.long 0x354a4751,0x354cc2b2,0x3548dd65,0x353eb67b,0x354c2b2e,0x354b9b60,0x3543fb3c,0x35358e7a
.long 0x3542c6c0,0x352e9ee7,0x3510d0c3,0x34d603f2,0x353d35e5,0x35247f35,0x3501ec7b,0x34af2067
.long 0x35367a67,0x351916f7,0x34e38fc3,0x34863284,0x352e9ee7,0x350c7cf5,0x34c11588,0x343768ba
.long 0x80000000,0x80000000,0x80000000,0x80000000,0x33c092c2,0x33d08986,0x33e07b24,0x33f06739
.long 0x343f3d0b,0x344ed752,0x345e5d30,0x346dcd1c,0x348dc501,0x34990646,0x34a42590,0x34af2067
.long 0x3525afca,0x352e9ee7,0x35367a67,0x353d35e5,0x3532afeb,0x353ad20d,0x35417f0c,0x3546a993
.long 0x353d35e5,0x3543fb3c,0x3548dd65,0x354bd057,0x35451c60,0x3549f44d,0x354c71de,0x354c8da6
.long 0x3542c6c0,0x35367a67,0x3525afca,0x3510d0c3,0x3539fcdb,0x352928e5,0x3513a17d,0x34f3ff99
.long 0x352e9ee7,0x351916f7,0x34fd94b5,0x34c11588,0x3520d539,0x35068788,0x34cf1e05,0x3489fd76
.long 0x347d2590,0x33808c21,0xb40026af,0xb49cbf44,0x341fd168,0xb320c8f3,0xb46dcd1c,0xb4d29394
.long 0x33808c21,0xb4100327,0xb4ab7ba8,0xb501ec7b,0xb300a585,0xb4757c5d,0xb4dcd4c0,0xb517bf2e
.long 0x354ccccd,0x354ca461,0x354c2b2e,0x354b6163,0x354ccccd,0x354c8da6,0x354bd057,0x354a9556
.long 0x354ccccd,0x354c71de,0x354b6163,0x35499c4e,0x354ccccd,0x354c510b,0x354ade5d,0x35487681
.long 0x354ccccd,0x354b6163,0x35472430,0x3540243f,0x354ccccd,0x354b2261,0x35462a0f,0x353df888
.long 0x354ccccd,0x354ade5d,0x35451c60,0x353ba2a3,0x354ccccd,0x354a9556,0x3543fb3c,0x35392313
.long 0x354ccccd,0x3548dd65,0x353d35e5,0x352a48f4,0x354ccccd,0x35487681,0x353ba2a3,0x3526dc49
.long 0x354ccccd,0x35480aaa,0x3539fcdb,0x35234a91,0x354ccccd,0x354799e3,0x353844b9,0x351f9496
.long 0x354ccccd,0x35451c60,0x352e9ee7,0x350b04b5,0x354ccccd,0x35448e3a,0x352c7c70,0x35068788
.long 0x354ccccd,0x3543fb3c,0x352a48f4,0x3501ec7b,0x354ccccd,0x35436367,0x352804aa,0x34fa6928
.long 0x354a4751,0x3548dd65,0x35472430,0x35451c60,0x3548dd65,0x3546a993,0x3543fb3c,0x3540d407
.long 0x35472430,0x3543fb3c,0x3540243f,0x353ba2a3,0x35451c60,0x3540d407,0x353ba2a3,0x35358e7a
.long 0x35367a67,0x352a48f4,0x351bbb2c,0x350b04b5,0x3532afeb,0x35247f35,0x3513a17d,0x35005d00
.long 0x352e9ee7,0x351e5003,0x350b04b5,0x34ea3450,0x352a48f4,0x3517bf2e,0x3501ec7b,0x34d29394
.long 0x3510d0c3,0x34e38fc3,0x349cbf44,0x341fd168,0x350b04b5,0x34d29394,0x34863284,0x33d08986
.long 0x350501c8,0x34c11588,0x345e5d30,0x3340e869,0x34fd94b5,0x34af2067,0x342f8fe3,0xb200ad75
.long 0x34b9f45b,0x341fd168,0xb3808c21,0xb48dc501,0x34ab7ba8,0x33f06739,0xb3e07b24,0xb4a7d2ae
.long 0x349cbf44,0x33a0975e,0xb41fd168,0xb4c11588,0x348dc501,0x3320c8f3,0xb44ed752,0xb4d96f08
.long 0x3542c6c0,0x3540243f,0x353d35e5,0x3539fcdb,0x353d35e5,0x35392313,0x35349e13,0x352fa9af
.long 0x35367a67,0x3530b021,0x352a48f4,0x35234a91,0x352e9ee7,0x3526dc49,0x351e5003,0x35150468
.long 0x34f0c1c0,0x34c823a7,0x349cbf44,0x345e5d30,0x34d603f2,0x34a7d2ae,0x346dcd1c,0x34081699
.long 0x34b9f45b,0x34863284,0x341fd168,0x3340e869,0x349cbf44,0x34470ca3,0x33a0975e,0xb320c8f3
.long 0,0xb41fd168,0xb49cbf44,0xb4e38fc3,0xb3808c21,0xb46617fd,0xb4c11588,0xb50378c1
.long 0xb40026af,0xb4954980,0xb4e38fc3,0xb513a17d,0xb43f3d0b,0xb4b65cd7,0xb501ec7b,0xb52211e5
.long 0xb4f0c1c0,0xb520d539,0xb53d35e5,0xb54b6163,0xb50501c8,0xb52b64d0,0xb543fb3c,0xb54cca46
.long 0xb510d0c3,0xb5349e13,0xb548dd65,0xb54bd057,0xb51bbb2c,0xb53c6e97,0xb54bd057,0xb5487681
.long 0x35367a67,0x3532afeb,0x352e9ee7,0x352a48f4,0x352a48f4,0x35247f35,0x351e5003,0x3517bf2e
.long 0x351bbb2c,0x3513a17d,0x350b04b5,0x3501ec7b,0x350b04b5,0x35005d00,0x34ea3450,0x34d29394
.long 0x340026af,0x3300a585,0xb3808c21,0xb41fd168,0x3300a585,0xb3909388,0xb42f8fe3,0xb489fd76
.long 0xb3808c21,0xb42f8fe3,0xb48dc501,0xb4c11588,0xb41fd168,0xb489fd76,0xb4c11588,0xb4f3ff99
.long 0xb510d0c3,0xb52a48f4,0xb53d35e5,0xb548dd65,0xb520d539,0xb53761d3,0xb5462a0f,0xb54c8da6
.long 0xb52e9ee7,0xb5417f0c,0xb54b6163,0xb54bd057,0xb539fcdb,0xb5487681,0xb54cc2b2,0xb546a993
.long 0xb54a4751,0xb539fcdb,0xb51bbb2c,0xb4e38fc3,0xb5451c60,0xb52d8fd0,0xb50809f5,0xb4af2067
.long 0xb53d35e5,0xb51e5003,0xb4e38fc3,0xb46dcd1c,0xb532afeb,0xb50c7cf5,0xb4b2c0d3,0xb3f06739
.long 0x80000000,0x3300a585,0x33808c21,0x33c092c2,0x80000000,0x3320c8f3,0x33a0975e,0x33f06739
.long 0x80000000,0x3340e869,0x33c092c2,0x34100327,0x80000000,0x3361031c,0x33e07b24,0x3427b2b7
.long 0x80000000,0x33c092c2,0x343f3d0b,0x348dc501,0x80000000,0x33d08986,0x344ed752,0x34990646
.long 0x80000000,0x33e07b24,0x345e5d30,0x34a42590,0x80000000,0x33f06739,0x346dcd1c,0x34af2067
.long 0x80000000,0x341fd168,0x349cbf44,0x34e38fc3,0x80000000,0x3427b2b7,0x34a42590,0x34ed7df6
.long 0x80000000,0x342f8fe3,0x34ab7ba8,0x34f7376d,0x80000000,0x343768ba,0x34b2c0d3,0x35005d00
.long 0x80000000,0x345e5d30,0x34d603f2,0x351663a6,0x80000000,0x346617fd,0x34dcd4c0,0x351a6af9
.long 0x80000000,0x346dcd1c,0x34e38fc3,0x351e5003,0x80000000,0x34757c5d,0x34ea3450,0x352211e5
.long 0x340026af,0x341fd168,0x343f3d0b,0x345e5d30,0x341fd168,0x34470ca3,0x346dcd1c,0x3489fd76
.long 0x343f3d0b,0x346dcd1c,0x348dc501,0x34a42590,0x345e5d30,0x3489fd76,0x34a42590,0x34bd8748
.long 0x34b9f45b,0x34e38fc3,0x350501c8,0x351663a6,0x34c823a7,0x34f3ff99,0x350df1bd,0x351f9496
.long 0x34d603f2,0x3501ec7b,0x351663a6,0x352804aa,0x34e38fc3,0x35098908,0x351e5003,0x352fa9af
.long 0x3510d0c3,0x352a48f4,0x353d35e5,0x3548dd65,0x351663a6,0x352fa9af,0x35417f0c,0x354b2261
.long 0x351bbb2c,0x35349e13,0x35451c60,0x354c71de,0x3520d539,0x35392313,0x35480aaa,0x354cca46
.long 0x35367a67,0x3548dd65,0x354c2b2e,0x3540243f,0x3539fcdb,0x354a9556,0x354ade5d,0x353ad20d
.long 0x353d35e5,0x354bd057,0x3548dd65,0x35349e13,0x3540243f,0x354c8da6,0x35462a0f,0x352d8fd0
.long 0x347d2590,0x348dc501,0x349cbf44,0x34ab7ba8,0x349cbf44,0x34af2067,0x34c11588,0x34d29394
.long 0x34b9f45b,0x34cf1e05,0x34e38fc3,0x34f7376d,0x34d603f2,0x34ed7df6,0x3501ec7b,0x350c7cf5
.long 0x3525afca,0x3532afeb,0x353d35e5,0x35451c60,0x352e9ee7,0x353ad20d,0x3543fb3c,0x3549f44d
.long 0x35367a67,0x35417f0c,0x3548dd65,0x354c71de,0x353d35e5,0x3546a993,0x354bd057,0x354c8da6
.long 0x354ccccd,0x3548dd65,0x353d35e5,0x352a48f4,0x354c2b2e,0x35448e3a,0x35349e13,0x351d0787
.long 0x354a4751,0x353eb67b,0x352a48f4,0x350df1bd,0x35472430,0x353761d3,0x351e5003,0x34fa6928
.long 0x3525afca,0x34fd94b5,0x349cbf44,0x33c092c2,0x351bbb2c,0x34e03506,0x346dcd1c,0x3200ad75
.long 0x3510d0c3,0x34c11588,0x341fd168,0xb3a0975e,0x350501c8,0x34a07465,0x33a0975e,0xb427b2b7
.long 0x34b9f45b,0x34c823a7,0x34d603f2,0x34e38fc3,0x34e38fc3,0x34f3ff99,0x3501ec7b,0x35098908
.long 0x350501c8,0x350df1bd,0x351663a6,0x351e5003,0x351663a6,0x351f9496,0x352804aa,0x352fa9af
.long 0x354a4751,0x354ca461,0x354c2b2e,0x3548dd65,0x354ca461,0x354c0047,0x35480aaa,0x3540d407
.long 0x354c2b2e,0x35480aaa,0x3540243f,0x35349e13,0x3548dd65,0x3540d407,0x35349e13,0x35247f35
.long 0x3510d0c3,0x34e38fc3,0x349cbf44,0x341fd168,0x34fd94b5,0x34b65cd7,0x344ed752,0x3320c8f3
.long 0x34d603f2,0x34863284,0x33c092c2,0xb3a0975e,0x34ab7ba8,0x3427b2b7,0xb280abdf,0xb4470ca3
.long 0xb40026af,0xb4ab7ba8,0xb50501c8,0xb52a48f4,0xb45e5d30,0xb4d96f08,0xb51916f7,0xb5392313
.long 0xb49cbf44,0xb501ec7b,0xb52a48f4,0xb543fb3c,0xb4c823a7,0xb5150468,0xb53844b9,0xb54a9556
.long 0x40003f80,0x40004000,0,0,0x3ff33f80,0x3f963fcf,0xbf1e0000,0xbfcfbf96
.long 0x3fcf3f80,0xbf1e3f1e,0xbf960000,0xbff3bff3,0x3f963f80,0xbff3bf1e,0xbfcf0000,0xbf1ebff3
.long 0x3f1e3f80,0xbfcfbfcf,0xbff30000,0x3f96bf96,0x3f80,0xc000,0xc0000000,0x40000000
.long 0xbf1e3f80,0x3fcfbfcf,0xbff30000,0x3f963f96,0xbf963f80,0x3ff3bf1e,0xbfcf0000,0xbf1e3ff3
.long 0xbfcf3f80,0x3f1e3f1e,0xbf960000,0xbff33ff3,0xbff33f80,0xbf963fcf,0xbf1e0000,0xbfcf3f96
.long 0xc0003f80,0xc0004000,0,0,0xbff33f80,0xbf963fcf,0x3f1e0000,0x3fcfbf96
.long 0xbfcf3f80,0x3f1e3f1e,0x3f960000,0x3ff3bff3,0xbf963f80,0x3ff3bf1e,0x3fcf0000,0x3f1ebff3
.long 0xbf1e3f80,0x3fcfbfcf,0x3ff30000,0xbf96bf96,0x3f80,0xc000,0x40000000,0xc0000000
.long 0x40004000,0x40004000,0,0,0x3f1e,0xbf96bf1e,0xc000bff3,0xbfcfbff3
.long 0xc000bfcf,0xbf1ebfcf,0xbf96,0x3ff33f96,0xbfcf,0x3ff33fcf,0x40003f96,0xbf1e3f96
.long 0x40003f1e,0xbfcf3f1e,0x3ff3,0xbf96bff3,0x4000,0xc000,0xc0000000,0x40000000
.long 0xc0003f1e,0x3fcf3f1e,0xbff3,0xbf963ff3,0xbfcf,0xbff33fcf,0x4000bf96,0xbf1ebf96
.long 0x4000bfcf,0x3f1ebfcf,0x3f96,0x3ff3bf96,0x3f1e,0x3f96bf1e,0xc0003ff3,0xbfcf3ff3
.long 0xc0004000,0xc0004000,0,0,0x3f1e,0x3f96bf1e,0x4000bff3,0x3fcfbff3
.long 0x4000bfcf,0x3f1ebfcf,0xbf96,0xbff33f96,0xbfcf,0xbff33fcf,0xc0003f96,0x3f1e3f96
.long 0xc0003f1e,0x3fcf3f1e,0x3ff3,0x3f96bff3,0x4000,0xc000,0x40000000,0xc0000000
.long 0x40004000,0x3f80,0,0,0xbff3bfcf,0xbf80,0xbf1ebf96,0
.long 0x3fcf3f1e,0x3f80,0x3f963ff3,0,0xbf963f1e,0xbf80,0xbfcfbff3,0
.long 0x3f1ebfcf,0x3f80,0x3ff33f96,0,0x4000,0xbf80,0xc0000000,0
.long 0xbf1ebfcf,0x3f80,0x3ff3bf96,0,0x3f963f1e,0xbf80,0xbfcf3ff3,0
.long 0xbfcf3f1e,0x3f80,0x3f96bff3,0,0x3ff3bfcf,0xbf80,0xbf1e3f96,0
.long 0xc0004000,0x3f80,0,0,0x3ff3bfcf,0xbf80,0x3f1ebf96,0
.long 0xbfcf3f1e,0x3f80,0xbf963ff3,0,0x3f963f1e,0xbf80,0x3fcfbff3,0
.long 0xbf1ebfcf,0x3f80,0xbff33f96,0,0x4000,0xbf80,0x40000000,0
.long 0,0,0,0,0,0,0,0
.long 0,0,0,0,0,0,0,0
.long 0,0,0,0,0,0,0,0
.long 0,0,0,0,0,0,0,0
.long 0,0,0,0,0,0,0,0
.long 0,0,0,0,0,0,0,0
.long 0,0,0,0,0,0,0,0
.long 0,0,0,0,0,0,0,0
.long 0x3f1e3f80,0xbfcfbfcf,0x3ff30000,0xbf963f96,0x3f963f80,0xbff3bf1e,0x3fcf0000,0x3f1e3ff3
.long 0x3fcf3f80,0xbf1e3f1e,0x3f960000,0x3ff33ff3,0x3ff33f80,0x3f963fcf,0x3f1e0000,0x3fcf3f96
.long 0,0,0,0,0,0,0,0
.long 0,0,0,0,0,0,0,0
.long 0,0,0,0,0,0,0,0
.long 0,0,0,0,0,0,0,0
.long 0,0,0,0,0,0,0,0
.long 0,0,0,0,0,0,0,0
.long 0x40003f1e,0xbfcf3f1e,0xbff3,0x3f963ff3,0xbfcf,0x3ff33fcf,0xc000bf96,0x3f1ebf96
.long 0xc000bfcf,0xbf1ebfcf,0x3f96,0xbff3bf96,0x3f1e,0xbf96bf1e,0x40003ff3,0x3fcf3ff3
.long 0,0,0,0,0,0,0,0
.long 0,0,0,0,0,0,0,0
.long 0,0,0,0,0,0,0,0
.long 0,0,0,0,0,0,0,0
.long 0,0,0,0,0,0,0,0
.long 0,0,0,0,0,0,0,0
.long 0x3f1ebfcf,0x3f80,0xbff3bf96,0,0xbf963f1e,0xbf80,0x3fcf3ff3,0
.long 0x3fcf3f1e,0x3f80,0xbf96bff3,0,0xbff3bfcf,0xbf80,0x3f1e3f96,0
.long 0,0,0,0,0,0,0,0
.long 0,0,0,0,0,0,0,0
.long 0,0,0,0,0,0,0,0
.long 0,0,0,0,0,0,0,0
.long 0,0,0,0,0,0,0,0
.long 0,0,0,0,0,0,0,0
.long 0,0,0,0,0,0,0,0
.long 0,0,0,0,0,0,0,0
.long 0,0,0,0,0,0,0,0
.long 0,0,0,0,0,0,0,0
.long 0,0,0,0,0,0,0,0
.long 0,0,0,0,0,0,0,0
.long 0,0,0,0,0,0,0,0
.long 0,0,0,0,0,0,0,0
.long 0,0,0,0,0,0,0,0
.long 0,0,0,0,0,0,0,0
.long 0,0,0,0,0,0,0,0
.long 0,0,0,0,0,0,0,0
.long 0,0,0,0,0,0,0,0
.long 0,0,0,0,0,0,0,0
.long 0,0,0,0,0,0,0,0
.long 0,0,0,0,0,0,0,0
.long 0,0,0,0,0,0,0,0
.long 0,0,0,0,0,0,0,0
.long 0,0,0,0,0,0,0,0
.long 0,0,0,0,0,0,0,0
.long 0,0,0,0,0,0,0,0
.long 0,0,0,0,0,0,0,0
.long 0,0,0,0,0,0,0,0
.long 0,0,0,0,0,0,0,0
.long 0,0,0,0,0,0,0,0
.long 0,0,0,0,0,0,0,0
.long 0,0,0,0,0,0,0,0
.long 0,0,0,0,0,0,0,0
.long 0,0,0,0,0,0,0,0
.long 0,0,0,0,0,0,0,0
.long 0,0,0,0,0,0,0,0
.long 0,0,0,0,0,0,0,0
.long 0,0,0,0,0,0,0,0
.long 0,0,0,0,0,0,0,0
.long 0,0,0,0,0,0,0,0
.long 0,0,0,0,0,0,0,0
.long 0,0,0,0,0,0,0,0
.long 0,0,0,0,0,0,0,0
.long 0,0,0,0,0,0,0,0
.long 0,0,0,0,0,0,0,0
.long 0,0,0,0,0,0,0,0
.long 0,0,0,0,0,0,0,0
.long 0,0,0,0,0,0,0,0
.long 0,0,0,0,0,0,0,0
.long 0,0,0,0,0,0,0,0
.long 0,0,0,0,0,0,0,0
.long 0,0,0,0,0,0,0,0
.long 0,0,0,0,0,0,0,0
.long 0,0,0,0,0,0,0,0
.long 0,0,0,0,0,0,0,0
.long 0,0,0,0,0,0,0,0
.long 0,0,0,0,0,0,0,0
.long 0,0,0,0,0,0,0,0
.long 0,0,0,0,0,0,0,0
.long 0,0,0,0,0,0,0,0
.long 0,0,0,0,0,0,0,0
.long 0,0,0,0,0,0,0,0
.long 0,0,0,0,0,0,0,0
.long 0,0,0,0,0,0,0,0
.long 0,0,0,0,0,0,0,0
.long 0,0,0,0,0,0,0,0
.long 0,0,0,0,0,0,0,0
.long 0,0,0,0,0,0,0,0
.long 0,0,0,0,0,0,0,0
.long 0,0,0,0,0,0,0,0
.long 0,0,0,0,0,0,0,0
.long 0,0,0,0,0,0,0,0
.long 0,0,0,0,0,0,0,0
.long 0,0,0,0,0,0,0,0
.long 0,0,0,0,0,0,0,0
.long 0,0,0,0,0,0,0,0
.long 0,0,0,0,0,0,0,0
.long 0,0,0,0,0,0,0,0
.long 0,0,0,0,0,0,0,0
.long 0,0,0,0,0,0,0,0
.long 0,0,0,0,0,0,0,0
.long 0,0,0,0,0,0,0,0
.long 0,0,0,0,0,0,0,0
.long 0,0,0,0,0,0,0,0
.long 0,0,0,0,0,0,0,0
.long 0,0,0,0,0,0,0,0
.long 0,0,0,0,0,0,0,0
.long 0,0,0,0,0,0,0,0
.long 0,0,0,0,0,0,0,0
.long 0,0,0,0,0,0,0,0
.long 0,0,0,0,0,0,0,0
.long 0,0,0,0,0,0,0,0
.long 0,0,0,0,0,0,0,0
.long 0,0,0,0,0,0,0,0
.long 0,0,0,0,0,0,0,0
.long 0,0,0,0,0,0,0,0
.long 0,0,0,0,0,0,0,0
.long 0,0,0,0,0,0,0,0
.long 0,0,0,0,0,0,0,0
.long 0,0,0,0,0,0,0,0
.long 0,0,0,0,0,0,0,0
.long 0,0,0,0,0,0,0,0
.long 0,0,0,0,0,0,0,0
.long 0,0,0,0,0,0,0,0
.long 0,0,0,0,0,0,0,0
.long 0,0,0,0,0,0,0,0
.long 0,0,0,0,0,0,0,0
.long 0,0,0,0,0,0,0,0
.long 0,0,0,0,0,0,0,0
.long 0,0,0,0,0,0,0,0
.long 0,0,0,0,0,0,0,0
.long 0,0,0,0,0,0,0,0
.long 0,0,0,0,0,0,0,0
.long 0,0,0,0,0,0,0,0
.long 0,0,0,0,0,0,0,0
.long 0,0,0,0,0,0,0,0
.long 0,0,0,0,0,0,0,0
.long 0,0,0,0,0,0,0,0
.long 0,0,0,0,0,0,0,0
.long 0,0,0,0,0,0,0,0
.long 0,0,0,0,0,0,0,0
.long 0,0,0,0,0,0,0,0
.long 0,0,0,0,0,0,0,0
.long 0,0,0,0,0,0,0,0
.long 0,0,0,0,0,0,0,0
.long 0,0,0,0,0,0,0,0
.long 0,0,0,0,0,0,0,0
.long 0,0,0,0,0,0,0,0
.long 0,0,0,0,0,0,0,0
.long 0,0,0,0,0,0,0,0
.long 0,0,0,0,0,0,0,0
.long 0,0,0,0,0,0,0,0
.long 0,0,0,0,0,0,0,0
.long 0,0,0,0,0,0,0,0
.long 0,0,0,0,0,0,0,0
.long 0,0,0,0,0,0,0,0
.long 0,0,0,0,0,0,0,0
.long 0,0,0,0,0,0,0,0
.long 0,0,0,0,0,0,0,0
.long 0,0,0,0,0,0,0,0
.long 0,0,0,0,0,0,0,0
.long 0,0,0,0,0,0,0,0
.long 0,0,0,0,0,0,0,0
.long 0,0,0,0,0,0,0,0
.long 0,0,0,0,0,0,0,0
.long 0,0,0,0,0,0,0,0
.long 0,0,0,0,0,0,0,0
.long 0,0,0,0,0,0,0,0
.long 0,0,0,0,0,0,0,0
.long 0,0,0,0,0,0,0,0
.long 0,0,0,0,0,0,0,0
.long 0,0,0,0,0,0,0,0
.long 0,0,0,0,0,0,0,0
.long 0,0,0,0,0,0,0,0
.long 0,0,0,0,0,0,0,0
.long 0,0,0,0,0,0,0,0
.long 0,0,0,0,0,0,0,0
.long 0,0,0,0,0,0,0,0
.long 0,0,0,0,0,0,0,0
.long 0,0,0,0,0,0,0,0
.long 0,0,0,0,0,0,0,0
.long 0,0,0,0,0,0,0,0
.long 0,0,0,0,0,0,0,0
.long 0,0,0,0,0,0,0,0
.long 0,0,0,0,0,0,0,0
.long 0,0,0,0,0,0,0,0
.long 0,0,0,0,0,0,0,0
.long 0,0,0,0,0,0,0,0
.long 0,0,0,0,0,0,0,0
.long 0,0,0,0,0,0,0,0
.long 0,0,0,0,0,0,0,0
.long 0,0,0,0,0,0,0,0
.long 0,0,0,0,0,0,0,0
.long 0,0,0,0,0,0,0,0
.long 0,0,0,0,0,0,0,0
.long 0,0,0,0,0,0,0,0
.long 0,0,0,0,0,0,0,0
.long 0,0,0,0,0,0,0,0
.long 0,0,0,0,0,0,0,0
.long 0,0,0,0,0,0,0,0
.long 0,0,0,0,0,0,0,0
.long 0,0,0,0,0,0,0,0
.long 0,0,0,0,0,0,0,0
.long 0,0,0,0,0,0,0,0
.long 0,0,0,0,0,0,0,0
.long 0,0,0,0,0,0,0,0
.long 0,0,0,0,0,0,0,0
.long 0,0,0,0,0,0,0,0
.long 0,0,0,0,0,0,0,0
.long 0,0,0,0,0,0,0,0
.long 0,0,0,0,0,0,0,0
.long 0,0,0,0,0,0,0,0
.long 0,0,0,0,0,0,0,0
.long 0,0,0,0,0,0,0,0
.long 0,0,0,0,0,0,0,0
.long 0,0,0,0,0,0,0,0
.long 0,0,0,0,0,0,0,0
.long 0,0,0,0,0,0,0,0
.long 0,0,0,0,0,0,0,0
.long 0,0,0,0,0,0,0,0
.long 0,0,0,0,0,0,0,0
.long 0,0,0,0,0,0,0,0
.long 0,0,0,0,0,0,0,0
.long 0,0,0,0,0,0,0,0
.long 0,0,0,0,0,0,0,0
.long 0x3f800000,0,0x3f800000,0,0x3f800000,0,0x3f800000,0
.long 0x3f800000,0,0x3f800000,0,0x3f800000,0,0x3f800000,0
.long 0x3f800000,0,0x3f7fffb1,0xbb490fc6,0x3f7ffec4,0xbbc90f88,0x3f7ffd39,0xbc16cb58
.long 0x3f7ffb11,0xbc490e90,0x3f7ff84a,0xbc7b514b,0x3f7ff4e6,0xbc96c9b6,0x3f7ff0e3,0xbcafea69
.long 0x3f800000,0,0x3f7ffec4,0xbbc90f88,0x3f7ffb11,0xbc490e90,0x3f7ff4e6,0xbc96c9b6
.long 0x3f7fec43,0xbcc90ab0,0x3f7fe129,0xbcfb49ba,0x3f7fd397,0xbd16c32c,0x3f7fc38f,0xbd2fe007
.long 0x3f800000,0,0x3f7ffd39,0xbc16cb58,0x3f7ff4e6,0xbc96c9b6,0x3f7fe705,0xbce22a7a
.long 0x3f7fd397,0xbd16c32c,0x3f7fba9e,0xbd3c6dd5,0x3f7f9c18,0xbd621469,0x3f7f7808,0xbd83db0a
.long 0x3f800000,0,0x3f7ffb11,0xbc490e90,0x3f7fec43,0xbcc90ab0,0x3f7fd397,0xbd16c32c
.long 0x3f7fb10f,0xbd48fb30,0x3f7f84ab,0xbd7b2b74,0x3f7f4e6d,0xbd96a905,0x3f7f0e58,0xbdafb680
.long 0x3f800000,0,0x3f7ff84a,0xbc7b514b,0x3f7fe129,0xbcfb49ba,0x3f7fba9e,0xbd3c6dd5
.long 0x3f7f84ab,0xbd7b2b74,0x3f7f3f54,0xbd9cecf9,0x3f7eea9d,0xbdbc3ac3,0x3f7e868b,0xbddb7d37
.long 0x3f800000,0,0x3f7ff4e6,0xbc96c9b6,0x3f7fd397,0xbd16c32c,0x3f7f9c18,0xbd621469
.long 0x3f7f4e6d,0xbd96a905,0x3f7eea9d,0xbdbc3ac3,0x3f7e70b0,0xbde1bc2e,0x3f7de0b1,0xbe039502
.long 0x3f800000,0,0x3f7ff0e3,0xbcafea69,0x3f7fc38f,0xbd2fe007,0x3f7f7808,0xbd83db0a
.long 0x3f7f0e58,0xbdafb680,0x3f7e868b,0xbddb7d37,0x3f7de0b1,0xbe039502,0x3f7d1cdd,0xbe195be0
.long 0x3f800000,0,0x3f7fec43,0xbcc90ab0,0x3f7fb10f,0xbd48fb30,0x3f7f4e6d,0xbd96a905
.long 0x3f7ec46d,0xbdc8bd36,0x3f7e1324,0xbdfab273,0x3f7d3aac,0xbe164083,0x3f7c3b28,0xbe2f10a2
.long 0x3f800000,0,0x3f7fe705,0xbce22a7a,0x3f7f9c18,0xbd621469,0x3f7f1f49,0xbda973ba
.long 0x3f7e70b0,0xbde1bc2e,0x3f7d906e,0xbe0cec4a,0x3f7c7eb0,0xbe28defc,0x3f7b3bab,0xbe44b0b9
.long 0x3f800000,0,0x3f7fe129,0xbcfb49ba,0x3f7f84ab,0xbd7b2b74,0x3f7eea9d,0xbdbc3ac3
.long 0x3f7e1324,0xbdfab273,0x3f7cfe73,0xbe1c76de,0x3f7baccd,0xbe3b6ecf,0x3f7a1e84,0xbe5a3997
.long 0x3f800000,0,0x3f7fdaaf,0xbd0a342f,0x3f7f6ac7,0xbd8a200a,0x3f7eb069,0xbdcefdb7
.long 0x3f7dabcc,0xbe09cf86,0x3f7c5d3a,0xbe2bf804,0x3f7ac516,0xbe4dee60,0x3f78e3d6,0xbe6fa8b2
.long 0x3f800000,0,0x3f7fd397,0xbd16c32c,0x3f7f4e6d,0xbd96a905,0x3f7e70b0,0xbde1bc2e
.long 0x3f7d3aac,0xbe164083,0x3f7baccd,0xbe3b6ecf,0x3f79c79d,0xbe605c13,0x3f778bc5,0xbe827dc0
.long 0x3f800000,0,0x3f7fcbe2,0xbd2351cb,0x3f7f2f9d,0xbda3308c,0x3f7e2b72,0xbdf475c0
.long 0x3f7cbfc9,0xbe22abb6,0x3f7aed37,0xbe4ada4f,0x3f78b47b,0xbe72b651,0x3f76167a,0xbe8d17c0
.long 0x3f800000,0,0x3f7fc38f,0xbd2fe007,0x3f7f0e58,0xbdafb680,0x3f7de0b1,0xbe039502
.long 0x3f7c3b28,0xbe2f10a2,0x3f7a1e84,0xbe5a3997,0x3f778bc5,0xbe827dc0,0x3f748422,0xbe97a117
.long 0x3f800000,0,0x3f7fba9e,0xbd3c6dd5,0x3f7eea9d,0xbdbc3ac3,0x3f7d906e,0xbe0cec4a
.long 0x3f7baccd,0xbe3b6ecf,0x3f7940c0,0xbe698bba,0x3f764d97,0xbe8b9507,0x3f72d4eb,0xbea21887
.long 0x3f800000,0,0x3f7fb10f,0xbd48fb30,0x3f7ec46d,0xbdc8bd36,0x3f7d3aac,0xbe164083
.long 0x3f7b14be,0xbe47c5c2,0x3f7853f8,0xbe78cfcc,0x3f74fa0b,0xbe94a031,0x3f710908,0xbeac7cd4
.long 0x3f800000,0,0x3f7fa6e3,0xbd55880e,0x3f7e9bc9,0xbdd53db9,0x3f7cdf6c,0xbe1f917b
.long 0x3f7a7302,0xbe541501,0x3f77583a,0xbe840270,0x3f73913f,0xbe9d9e78,0x3f6f20b0,0xbeb6ccc3
.long 0x3f800000,0,0x3f7f9c18,0xbd621469,0x3f7e70b0,0xbde1bc2e,0x3f7c7eb0,0xbe28defc
.long 0x3f79c79d,0xbe605c13,0x3f764d97,0xbe8b9507,0x3f721352,0xbea68f12,0x3f6d1c1d,0xbec1071e
.long 0x3f800000,0,0x3f7f90b1,0xbd6ea038,0x3f7e4323,0xbdee3876,0x3f7c187a,0xbe3228d4
.long 0x3f791298,0xbe6c9a7f,0x3f75341d,0xbe931f35,0x3f708066,0xbeaf713a,0x3f6afb8c,0xbecb2aae
.long 0x3f800000,0,0x3f7f84ab,0xbd7b2b74,0x3f7e1324,0xbdfab273,0x3f7baccd,0xbe3b6ecf
.long 0x3f7853f8,0xbe78cfcc,0x3f740bdd,0xbe9aa086,0x3f6ed89e,0xbeb8442a,0x3f68bf3c,0xbed53641
.long 0x3f800000,0,0x3f7f7808,0xbd83db0a,0x3f7de0b1,0xbe039502,0x3f7b3bab,0xbe44b0b9
.long 0x3f778bc5,0xbe827dc0,0x3f72d4eb,0xbea21887,0x3f6d1c1d,0xbec1071e,0x3f666771,0xbedf28a9
.long 0x3f800000,0,0x3f7f6ac7,0xbd8a200a,0x3f7dabcc,0xbe09cf86,0x3f7ac516,0xbe4dee60
.long 0x3f76ba07,0xbe888e93,0x3f718f57,0xbea986c4,0x3f6b4b0c,0xbec9b953,0x3f63f473,0xbee900b7
.long 0x3f800000,0,0x3f7f5ce9,0xbd9064b4,0x3f7d7474,0xbe1008b7,0x3f7a4910,0xbe57278f
.long 0x3f75dec6,0xbe8e9a22,0x3f703b37,0xbeb0eacb,0x3f696591,0xbed25a09,0x3f61668a,0xbef2bd43
.long 0x3f800000,0,0x3f7f4e6d,0xbd96a905,0x3f7d3aac,0xbe164083,0x3f79c79d,0xbe605c13
.long 0x3f74fa0b,0xbe94a031,0x3f6ed89e,0xbeb8442a,0x3f676bd8,0xbedae880,0x3f5ebe05,0xbefc5d27
.long 0x3f800000,0,0x3f7f3f54,0xbd9cecf9,0x3f7cfe73,0xbe1c76de,0x3f7940c0,0xbe698bba
.long 0x3f740bdd,0xbe9aa086,0x3f6d67a1,0xbebf926f,0x3f655e0b,0xbee363fa,0x3f5bfb34,0xbf02ef9f
.long 0x3f800000,0,0x3f7f2f9d,0xbda3308c,0x3f7cbfc9,0xbe22abb6,0x3f78b47b,0xbe72b651
.long 0x3f731447,0xbea09ae5,0x3f6be858,0xbec6d529,0x3f633c5a,0xbeebcbbb,0x3f591e6a,0xbf07a136
.long 0x3f800000,0,0x3f7f1f49,0xbda973ba,0x3f7c7eb0,0xbe28defc,0x3f7822d1,0xbe7bdba4
.long 0x3f721352,0xbea68f12,0x3f6a5ad9,0xbece0bea,0x3f6106f2,0xbef41f07,0x3f5627fe,0xbf0c42c9
.long 0x3f800000,0,0x3f7f0e58,0xbdafb680,0x3f7c3b28,0xbe2f10a2,0x3f778bc5,0xbe827dc0
.long 0x3f710908,0xbeac7cd4,0x3f68bf3c,0xbed53641,0x3f5ebe05,0xbefc5d27,0x3f531849,0xbf10d3cd
.long 0x3f800000,0,0x3f7efcc9,0xbdb5f8da,0x3f7bf531,0xbe354098,0x3f76ef5b,0xbe870ada
.long 0x3f6ff573,0xbeb263ef,0x3f671599,0xbedc53c1,0x3f5c61c7,0xbf0242b1,0x3f4fefa8,0xbf1553b7
.long 0x3f800000,0,0x3f7eea9d,0xbdbc3ac3,0x3f7baccd,0xbe3b6ecf,0x3f764d97,0xbe8b9507
.long 0x3f6ed89e,0xbeb8442a,0x3f655e0b,0xbee363fa,0x3f59f26a,0xbf064b82,0x3f4cae79,0xbf19c200
.long 0x3f800000,0,0x3f7ed7d4,0xbdc27c39,0x3f7b61fc,0xbe419b37,0x3f75a67b,0xbe901c2c
.long 0x3f6db293,0xbebe1d4a,0x3f6398ac,0xbeea6681,0x3f577026,0xbf0a48ad,0x3f495521,0xbf1e1e22
.long 0x3f800000,0,0x3f7ec46d,0xbdc8bd36,0x3f7b14be,0xbe47c5c2,0x3f74fa0b,0xbe94a031
.long 0x3f6c835e,0xbec3ef15,0x3f61c598,0xbef15aea,0x3f54db31,0xbf0e39da,0x3f45e403,0xbf226799
.long 0x3f800000,0,0x3f7eb069,0xbdcefdb7,0x3f7ac516,0xbe4dee60,0x3f74484b,0xbe9920fe
.long 0x3f6b4b0c,0xbec9b953,0x3f5fe4e9,0xbef840c8,0x3f5233c6,0xbf121eb0,0x3f425b89,0xbf269de3
.long 0x3f800000,0,0x3f7e9bc9,0xbdd53db9,0x3f7a7302,0xbe541501,0x3f73913f,0xbe9d9e78
.long 0x3f6a09a7,0xbecf7bca,0x3f5df6be,0xbeff17b2,0x3f4f7a1f,0xbf15f6d9,0x3f3ebc1b,0xbf2ac082
.long 0x3f800000,0,0x3f7e868b,0xbddb7d37,0x3f7a1e84,0xbe5a3997,0x3f72d4eb,0xbea21887
.long 0x3f68bf3c,0xbed53641,0x3f5bfb34,0xbf02ef9f,0x3f4cae79,0xbf19c200,0x3f3b0629,0xbf2ecef7
.long 0x3f800000,0,0x3f7e70b0,0xbde1bc2e,0x3f79c79d,0xbe605c13,0x3f721352,0xbea68f12
.long 0x3f676bd8,0xbedae880,0x3f59f26a,0xbf064b82,0x3f49d112,0xbf1d7fd1,0x3f373a23,0xbf32c8c9
.long 0x3f800000,0,0x3f7e5a38,0xbde7fa9a,0x3f796e4e,0xbe667c66,0x3f714c7a,0xbeab0201
.long 0x3f660f88,0xbee0924f,0x3f57dc7f,0xbf099f4e,0x3f46e22a,0xbf212ff9,0x3f33587a,0xbf36ad7f
.long 0x3f800000,0,0x3f7e4323,0xbdee3876,0x3f791298,0xbe6c9a7f,0x3f708066,0xbeaf713a
.long 0x3f64aa59,0xbee63375,0x3f55b993,0xbf0cead0,0x3f43e200,0xbf24d225,0x3f2f61a5,0xbf3a7ca4
.long 0x3f800000,0,0x3f7e2b72,0xbdf475c0,0x3f78b47b,0xbe72b651,0x3f6faf1b,0xbeb3dca5
.long 0x3f633c5a,0xbeebcbbb,0x3f5389c7,0xbf102dd5,0x3f40d0da,0xbf286605,0x3f2b561b,0xbf3e35c5
.long 0x3f800000,0,0x3f7e1324,0xbdfab273,0x3f7853f8,0xbe78cfcc,0x3f6ed89e,0xbeb8442a
.long 0x3f61c598,0xbef15aea,0x3f514d3d,0xbf13682a,0x3f3daef9,0xbf2beb4a,0x3f273656,0xbf41d870
.long 0x3f800000,0,0x3f7dfa38,0xbe007745,0x3f77f110,0xbe7ee6e1,0x3f6dfcf2,0xbebca7af
.long 0x3f604621,0xbef6e0cb,0x3f4f0417,0xbf16999f,0x3f3a7ca4,0xbf2f61a5,0x3f2302d3,0xbf456439
.long 0x3f800000,0,0x3f7de0b1,0xbe039502,0x3f778bc5,0xbe827dc0,0x3f6d1c1d,0xbec1071e
.long 0x3f5ebe05,0xbefc5d27,0x3f4cae79,0xbf19c200,0x3f373a23,0xbf32c8c9,0x3f1ebc12,0xbf48d8b3
.long 0x3f800000,0,0x3f7dc68c,0xbe06b26e,0x3f772417,0xbe8586ce,0x3f6c3624,0xbec5625c
.long 0x3f5d2d53,0xbf00e7e4,0x3f4a4c87,0xbf1ce11f,0x3f33e7bc,0xbf36206c,0x3f1a6293,0xbf4c3578
.long 0x3f800000,0,0x3f7dabcc,0xbe09cf86,0x3f76ba07,0xbe888e93,0x3f6b4b0c,0xbec9b953
.long 0x3f5b941a,0xbf039c3d,0x3f47de65,0xbf1ff6cb,0x3f3085bb,0xbf396842,0x3f15f6d9,0xbf4f7a1f
.long 0x3f800000,0,0x3f7d906e,0xbe0cec4a,0x3f764d97,0xbe8b9507,0x3f6a5ad9,0xbece0bea
.long 0x3f59f26a,0xbf064b82,0x3f456439,0xbf2302d3,0x3f2d1469,0xbf3ca003,0x3f11796b,0xbf52a649
.long 0x3f800000,0,0x3f7d7474,0xbe1008b7,0x3f75dec6,0xbe8e9a22,0x3f696591,0xbed25a09
.long 0x3f584853,0xbf08f59b,0x3f42de29,0xbf26050a,0x3f299415,0xbf3fc767,0x3f0cead0,0xbf55b993
.long 0x3f800000,0,0x3f7d57de,0xbe1324ca,0x3f756d97,0xbe919ddd,0x3f686b39,0xbed6a399
.long 0x3f5695e5,0xbf0b9a6b,0x3f404c5c,0xbf28fd41,0x3f26050a,0xbf42de29,0x3f084b92,0xbf58b3a1
.long 0x3f800000,0,0x3f7d3aac,0xbe164083,0x3f74fa0b,0xbe94a031,0x3f676bd8,0xbedae880
.long 0x3f54db31,0xbf0e39da,0x3f3daef9,0xbf2beb4a,0x3f226799,0xbf45e403,0x3f039c3d,0xbf5b941a
.long 0x3f800000,0,0x3f7d1cdd,0xbe195be0,0x3f748422,0xbe97a117,0x3f666771,0xbedf28a9
.long 0x3f531849,0xbf10d3cd,0x3f3b0629,0xbf2ecef7,0x3f1ebc12,0xbf48d8b3,0x3efdbabb,0xbf5e5aa6
.long 0x3f800000,0,0x3f7cfe73,0xbe1c76de,0x3f740bdd,0xbe9aa086,0x3f655e0b,0xbee363fa
.long 0x3f514d3d,0xbf13682a,0x3f385216,0xbf31a81d,0x3f1b02c6,0xbf4bbbf8,0x3ef41f07,0xbf6106f2
.long 0x3f800000,0,0x3f7cdf6c,0xbe1f917b,0x3f73913f,0xbe9d9e78,0x3f644fac,0xbee79a5d
.long 0x3f4f7a1f,0xbf15f6d9,0x3f3592e7,0xbf34768f,0x3f173c07,0xbf4e8d90,0x3eea6681,0xbf6398ac
.long 0x3f800000,0,0x3f7cbfc9,0xbe22abb6,0x3f731447,0xbea09ae5,0x3f633c5a,0xbeebcbbb
.long 0x3f4d9f02,0xbf187fc0,0x3f32c8c9,0xbf373a23,0x3f13682a,0xbf514d3d,0x3ee0924f,0xbf660f88
.long 0x3f800000,0,0x3f7c9f8a,0xbe25c58c,0x3f7294f8,0xbea395c5,0x3f62241a,0xbeeff7fb
.long 0x3f4bbbf8,0xbf1b02c6,0x3f2ff3e6,0xbf39f2ac,0x3f0f8784,0xbf53fac3,0x3ed6a399,0xbf686b39
.long 0x3f800000,0,0x3f7c7eb0,0xbe28defc,0x3f721352,0xbea68f12,0x3f6106f2,0xbef41f07
.long 0x3f49d112,0xbf1d7fd1,0x3f2d1469,0xbf3ca003,0x3f0b9a6b,0xbf5695e5,0x3ecc9b8b,0xbf6aab7b
.long 0x3f800000,0,0x3f7c5d3a,0xbe2bf804,0x3f718f57,0xbea986c4,0x3f5fe4e9,0xbef840c8
.long 0x3f47de65,0xbf1ff6cb,0x3f2a2a80,0xbf3f41fc,0x3f07a136,0xbf591e6a,0x3ec27b55,0xbf6cd007
.long 0x3f800000,0,0x3f7c3b28,0xbe2f10a2,0x3f710908,0xbeac7cd4,0x3f5ebe05,0xbefc5d27
.long 0x3f45e403,0xbf226799,0x3f273656,0xbf41d870,0x3f039c3d,0xbf5b941a,0x3eb8442a,0xbf6ed89e
.long 0x3f800000,0,0x3f7c187a,0xbe3228d4,0x3f708066,0xbeaf713a,0x3f5d924d,0xbf003a06
.long 0x3f43e200,0xbf24d225,0x3f24381a,0xbf446337,0x3eff17b2,0xbf5df6be,0x3eadf73c,0xbf70c501
.long 0x3f800000,0,0x3f7bf531,0xbe354098,0x3f6ff573,0xbeb263ef,0x3f5c61c7,0xbf0242b1
.long 0x3f41d870,0xbf273656,0x3f212ff9,0xbf46e22a,0x3ef6e0cb,0xbf604621,0x3ea395c5,0xbf7294f8
.long 0x3f800000,0,0x3f7bd14d,0xbe3857ec,0x3f6f6830,0xbeb554ec,0x3f5b2c79,0xbf044889
.long 0x3f3fc767,0xbf299415,0x3f1e1e22,0xbf495521,0x3eee9479,0xbf628210,0x3e9920fe,0xbf74484b
.long 0x3f800000,0,0x3f7baccd,0xbe3b6ecf,0x3f6ed89e,0xbeb8442a,0x3f59f26a,0xbf064b82
.long 0x3f3daef9,0xbf2beb4a,0x3f1b02c6,0xbf4bbbf8,0x3ee63375,0xbf64aa59,0x3e8e9a22,0xbf75dec6
.long 0x3f800000,0,0x3f7b87b2,0xbe3e853e,0x3f6e46be,0xbebb31a0,0x3f58b3a1,0xbf084b92
.long 0x3f3b8f3b,0xbf2e3bde,0x3f17de12,0xbf4e1689,0x3eddbe79,0xbf66becc,0x3e840270,0xbf77583a
.long 0x3f800000,0,0x3f7b61fc,0xbe419b37,0x3f6db293,0xbebe1d4a,0x3f577026,0xbf0a48ad
.long 0x3f396842,0xbf3085bb,0x3f14b039,0xbf5064af,0x3ed53641,0xbf68bf3c,0x3e72b651,0xbf78b47b
.long 0x3f800000,0,0x3f7b3bab,0xbe44b0b9,0x3f6d1c1d,0xbec1071e,0x3f5627fe,0xbf0c42c9
.long 0x3f373a23,0xbf32c8c9,0x3f11796b,0xbf52a649,0x3ecc9b8b,0xbf6aab7b,0x3e5d4b1a,0xbf79f35e
.long 0x3f800000,0,0x3f7b14be,0xbe47c5c2,0x3f6c835e,0xbec3ef15,0x3f54db31,0xbf0e39da
.long 0x3f3504f3,0xbf3504f3,0x3f0e39da,0xbf54db31,0x3ec3ef15,0xbf6c835e,0x3e47c5c2,0xbf7b14be
.long 0x3f800000,0,0x3f7aed37,0xbe4ada4f,0x3f6be858,0xbec6d529,0x3f5389c7,0xbf102dd5
.long 0x3f32c8c9,0xbf373a23,0x3f0af1b7,0xbf570348,0x3ebb31a0,0xbf6e46be,0x3e3228d4,0xbf7c187a
.long 0x3f800000,0,0x3f7ac516,0xbe4dee60,0x3f6b4b0c,0xbec9b953,0x3f5233c6,0xbf121eb0
.long 0x3f3085bb,0xbf396842,0x3f07a136,0xbf591e6a,0x3eb263ef,0xbf6ff573,0x3e1c76de,0xbf7cfe73
.long 0x3f800000,0,0x3f7a9c59,0xbe5101f1,0x3f6aab7b,0xbecc9b8b,0x3f50d937,0xbf140c5f
.long 0x3f2e3bde,0xbf3b8f3b,0x3f044889,0xbf5b2c79,0x3ea986c4,0xbf718f57,0x3e06b26e,0xbf7dc68c
.long 0x3f800000,0,0x3f7a7302,0xbe541501,0x3f6a09a7,0xbecf7bca,0x3f4f7a1f,0xbf15f6d9
.long 0x3f2beb4a,0xbf3daef9,0x3f00e7e4,0xbf5d2d53,0x3ea09ae5,0xbf731447,0x3de1bc2e,0xbf7e70b0
.long 0x3f800000,0,0x3f7a4910,0xbe57278f,0x3f696591,0xbed25a09,0x3f4e1689,0xbf17de12
.long 0x3f299415,0xbf3fc767,0x3efafef7,0xbf5f20db,0x3e97a117,0xbf748422,0x3db5f8da,0xbf7efcc9
.long 0x3f800000,0,0x3f7a1e84,0xbe5a3997,0x3f68bf3c,0xbed53641,0x3f4cae79,0xbf19c200
.long 0x3f273656,0xbf41d870,0x3ef41f07,0xbf6106f2,0x3e8e9a22,0xbf75dec6,0x3d8a200a,0xbf7f6ac7
.long 0x3f800000,0,0x3f79f35e,0xbe5d4b1a,0x3f6816a8,0xbed8106b,0x3f4b41fa,0xbf1ba299
.long 0x3f24d225,0xbf43e200,0x3eed3063,0xbf62df7b,0x3e8586ce,0xbf772417,0x3d3c6dd5,0xbf7fba9e
.long 0x3f800000,0,0x3f79c79d,0xbe605c13,0x3f676bd8,0xbedae880,0x3f49d112,0xbf1d7fd1
.long 0x3f226799,0xbf45e403,0x3ee63375,0xbf64aa59,0x3e78cfcc,0xbf7853f8,0x3cc90ab0,0xbf7fec43
.long 0x3f800000,0,0x3f799b43,0xbe636c83,0x3f66becc,0xbeddbe79,0x3f485bca,0xbf1f599f
.long 0x3f1ff6cb,0xbf47de65,0x3edf28a9,0xbf666771,0x3e667c66,0xbf796e4e,0x3b490fc6,0xbf7fffb1
.long 0x3f800000,0,0x3f796e4e,0xbe667c66,0x3f660f88,0xbee0924f,0x3f46e22a,0xbf212ff9
.long 0x3f1d7fd1,0xbf49d112,0x3ed8106b,0xbf6816a8,0x3e541501,0xbf7a7302,0xbc96c9b6,0xbf7ff4e6
.long 0x3f800000,0,0x3f7940c0,0xbe698bba,0x3f655e0b,0xbee363fa,0x3f456439,0xbf2302d3
.long 0x3f1b02c6,0xbf4bbbf8,0x3ed0eb2a,0xbf69b7e4,0x3e419b37,0xbf7b61fc,0xbd2351cb,0xbf7fcbe2
.long 0x3f800000,0,0x3f791298,0xbe6c9a7f,0x3f64aa59,0xbee63375,0x3f43e200,0xbf24d225
.long 0x3f187fc0,0xbf4d9f02,0x3ec9b953,0xbf6b4b0c,0x3e2f10a2,0xbf7c3b28,0xbd7b2b74,0xbf7f84ab
.long 0x3f800000,0,0x3f78e3d6,0xbe6fa8b2,0x3f63f473,0xbee900b7,0x3f425b89,0xbf269de3
.long 0x3f15f6d9,0xbf4f7a1f,0x3ec27b55,0xbf6cd007,0x3e1c76de,0xbf7cfe73,0xbda973ba,0xbf7f1f49
.long 0x3f800000,0,0x3f78b47b,0xbe72b651,0x3f633c5a,0xbeebcbbb,0x3f40d0da,0xbf286605
.long 0x3f13682a,0xbf514d3d,0x3ebb31a0,0xbf6e46be,0x3e09cf86,0xbf7dabcc,0xbdd53db9,0xbf7e9bc9
.long 0x3f800000,0,0x3f788486,0xbe75c35a,0x3f628210,0xbeee9479,0x3f3f41fc,0xbf2a2a80
.long 0x3f10d3cd,0xbf531849,0x3eb3dca5,0xbf6faf1b,0x3dee3876,0xbf7e4323,0xbe007745,0xbf7dfa38
.long 0x3f800000,0,0x3f7853f8,0xbe78cfcc,0x3f61c598,0xbef15aea,0x3f3daef9,0xbf2beb4a
.long 0x3f0e39da,0xbf54db31,0x3eac7cd4,0xbf710908,0x3dc8bd36,0xbf7ec46d,0xbe164083,0xbf7d3aac
.long 0x3f800000,0,0x3f7822d1,0xbe7bdba4,0x3f6106f2,0xbef41f07,0x3f3c17d9,0xbf2da859
.long 0x3f0b9a6b,0xbf5695e5,0x3ea5129f,0xbf725470,0x3da3308c,0xbf7f2f9d,0xbe2bf804,0xbf7c5d3a
.long 0x3f800000,0,0x3f77f110,0xbe7ee6e1,0x3f604621,0xbef6e0cb,0x3f3a7ca4,0xbf2f61a5
.long 0x3f08f59b,0xbf584853,0x3e9d9e78,0xbf73913f,0x3d7b2b74,0xbf7f84ab,0xbe419b37,0xbf7b61fc
.long 0x3f800000,0,0x3f77beb7,0xbe80f8c0,0x3f5f8327,0xbef9a02d,0x3f38dd65,0xbf311722
.long 0x3f064b82,0xbf59f26a,0x3e9620d2,0xbf74bf62,0x3d2fe007,0xbf7fc38f,0xbe57278f,0xbf7a4910
.long 0x3f800000,0,0x3f778bc5,0xbe827dc0,0x3f5ebe05,0xbefc5d27,0x3f373a23,0xbf32c8c9
.long 0x3f039c3d,0xbf5b941a,0x3e8e9a22,0xbf75dec6,0x3cc90ab0,0xbf7fec43,0xbe6c9a7f,0xbf791298
.long 0x3f800000,0,0x3f77583a,0xbe840270,0x3f5df6be,0xbeff17b2,0x3f3592e7,0xbf34768f
.long 0x3f00e7e4,0xbf5d2d53,0x3e870ada,0xbf76ef5b,0x3bc90f88,0xbf7ffec4,0xbe80f8c0,0xbf77beb7
.long 0x3f800000,0,0x3f772417,0xbe8586ce,0x3f5d2d53,0xbf00e7e4,0x3f33e7bc,0xbf36206c
.long 0x3efc5d27,0xbf5ebe05,0x3e7ee6e1,0xbf77f110,0xbc490e90,0xbf7ffb11,0xbe8b9507,0xbf764d97
.long 0x3f800000,0,0x3f76ef5b,0xbe870ada,0x3f5c61c7,0xbf0242b1,0x3f3238aa,0xbf37c655
.long 0x3ef6e0cb,0xbf604621,0x3e6fa8b2,0xbf78e3d6,0xbcfb49ba,0xbf7fe129,0xbe9620d2,0xbf74bf62
.long 0x3f800000,0,0x3f76ba07,0xbe888e93,0x3f5b941a,0xbf039c3d,0x3f3085bb,0xbf396842
.long 0x3ef15aea,0xbf61c598,0x3e605c13,0xbf79c79d,0xbd48fb30,0xbf7fb10f,0xbea09ae5,0xbf731447
.long 0x3f800000,0,0x3f76841b,0xbe8a11f7,0x3f5ac450,0xbf04f484,0x3f2ecef7,0xbf3b0629
.long 0x3eebcbbb,0xbf633c5a,0x3e5101f1,0xbf7a9c59,0xbd8a200a,0xbf7f6ac7,0xbeab0201,0xbf714c7a
.long 0x3f800000,0,0x3f764d97,0xbe8b9507,0x3f59f26a,0xbf064b82,0x3f2d1469,0xbf3ca003
.long 0x3ee63375,0xbf64aa59,0x3e419b37,0xbf7b61fc,0xbdafb680,0xbf7f0e58,0xbeb554ec,0xbf6f6830
.long 0x3f800000,0,0x3f76167a,0xbe8d17c0,0x3f591e6a,0xbf07a136,0x3f2b561b,0xbf3e35c5
.long 0x3ee0924f,0xbf660f88,0x3e3228d4,0xbf7c187a,0xbdd53db9,0xbf7e9bc9,0xbebf926f,0xbf6d67a1
.long 0x3f800000,0,0x3f75dec6,0xbe8e9a22,0x3f584853,0xbf08f59b,0x3f299415,0xbf3fc767
.long 0x3edae880,0xbf676bd8,0x3e22abb6,0xbf7cbfc9,0xbdfab273,0xbf7e1324,0xbec9b953,0xbf6b4b0c
.long 0x3f800000,0,0x3f75a67b,0xbe901c2c,0x3f577026,0xbf0a48ad,0x3f27ce61,0xbf4154e1
.long 0x3ed53641,0xbf68bf3c,0x3e1324ca,0xbf7d57de,0xbe1008b7,0xbf7d7474,0xbed3c867,0xbf6912ae
.long 0x3f800000,0,0x3f756d97,0xbe919ddd,0x3f5695e5,0xbf0b9a6b,0x3f26050a,0xbf42de29
.long 0x3ecf7bca,0xbf6a09a7,0x3e039502,0xbf7de0b1,0xbe22abb6,0xbf7cbfc9,0xbeddbe79,0xbf66becc
.long 0x3f800000,0,0x3f75341d,0xbe931f35,0x3f55b993,0xbf0cead0,0x3f24381a,0xbf446337
.long 0x3ec9b953,0xbf6b4b0c,0x3de7fa9a,0xbf7e5a38,0xbe354098,0xbf7bf531,0xbee79a5d,0xbf644fac
.long 0x3f800000,0,0x3f74fa0b,0xbe94a031,0x3f54db31,0xbf0e39da,0x3f226799,0xbf45e403
.long 0x3ec3ef15,0xbf6c835e,0x3dc8bd36,0xbf7ec46d,0xbe47c5c2,0xbf7b14be,0xbef15aea,0xbf61c598
.long 0x3f800000,0,0x3f74bf62,0xbe9620d2,0x3f53fac3,0xbf0f8784,0x3f209393,0xbf476085
.long 0x3ebe1d4a,0xbf6db293,0x3da973ba,0xbf7f1f49,0xbe5a3997,0xbf7a1e84,0xbefafef7,0xbf5f20db
.long 0x3f800000,0,0x3f748422,0xbe97a117,0x3f531849,0xbf10d3cd,0x3f1ebc12,0xbf48d8b3
.long 0x3eb8442a,0xbf6ed89e,0x3d8a200a,0xbf7f6ac7,0xbe6c9a7f,0xbf791298,0xbf0242b1,0xbf5c61c7
.long 0x3f800000,0,0x3f74484b,0xbe9920fe,0x3f5233c6,0xbf121eb0,0x3f1ce11f,0xbf4a4c87
.long 0x3eb263ef,0xbf6ff573,0x3d55880e,0xbf7fa6e3,0xbe7ee6e1,0xbf77f110,0xbf06f686,0xbf5988ad
.long 0x3f800000,0,0x3f740bdd,0xbe9aa086,0x3f514d3d,0xbf13682a,0x3f1b02c6,0xbf4bbbf8
.long 0x3eac7cd4,0xbf710908,0x3d16c32c,0xbf7fd397,0xbe888e93,0xbf76ba07,0xbf0b9a6b,0xbf5695e5
.long 0x3f800000,0,0x3f73ced9,0xbe9c1faf,0x3f5064af,0xbf14b039,0x3f19210f,0xbf4d26fd
.long 0x3ea68f12,0xbf721352,0x3cafea69,0xbf7ff0e3,0xbe919ddd,0xbf756d97,0xbf102dd5,0xbf5389c7
.long 0x3f800000,0,0x3f73913f,0xbe9d9e78,0x3f4f7a1f,0xbf15f6d9,0x3f173c07,0xbf4e8d90
.long 0x3ea09ae5,0xbf731447,0x3bc90f88,0xbf7ffec4,0xbe9aa086,0xbf740bdd,0xbf14b039,0xbf5064af
.long 0x3f800000,0,0x3f73530e,0xbe9f1cdf,0x3f4e8d90,0xbf173c07,0x3f1553b7,0xbf4fefa8
.long 0x3e9aa086,0xbf740bdd,0xbc16cb58,0xbf7ffd39,0xbea395c5,0xbf7294f8,0xbf19210f,0xbf4d26fd
.long 0x3f800000,0,0x3f731447,0xbea09ae5,0x3f4d9f02,0xbf187fc0,0x3f13682a,0xbf514d3d
.long 0x3e94a031,0xbf74fa0b,0xbcc90ab0,0xbf7fec43,0xbeac7cd4,0xbf710908,0xbf1d7fd1,0xbf49d112
.long 0x3f800000,0,0x3f72d4eb,0xbea21887,0x3f4cae79,0xbf19c200,0x3f11796b,0xbf52a649
.long 0x3e8e9a22,0xbf75dec6,0xbd2351cb,0xbf7fcbe2,0xbeb554ec,0xbf6f6830,0xbf21cbfb,0xbf466354
.long 0x3f800000,0,0x3f7294f8,0xbea395c5,0x3f4bbbf8,0xbf1b02c6,0x3f0f8784,0xbf53fac3
.long 0x3e888e93,0xbf76ba07,0xbd621469,0xbf7f9c18,0xbebe1d4a,0xbf6db293,0xbf26050a,0xbf42de29
.long 0x3f800000,0,0x3f725470,0xbea5129f,0x3f4ac77f,0xbf1c420c,0x3f0d9281,0xbf554aa4
.long 0x3e827dc0,0xbf778bc5,0xbd9064b4,0xbf7f5ce9,0xbec6d529,0xbf6be858,0xbf2a2a80,0xbf3f41fc
.long 0x3f800000,0,0x3f721352,0xbea68f12,0x3f49d112,0xbf1d7fd1,0x3f0b9a6b,0xbf5695e5
.long 0x3e78cfcc,0xbf7853f8,0xbdafb680,0xbf7f0e58,0xbecf7bca,0xbf6a09a7,0xbf2e3bde,0xbf3b8f3b
.long 0x3f800000,0,0x3f71d19f,0xbea80b1f,0x3f48d8b3,0xbf1ebc12,0x3f099f4e,0xbf57dc7f
.long 0x3e6c9a7f,0xbf791298,0xbdcefdb7,0xbf7eb069,0xbed8106b,0xbf6816a8,0xbf3238aa,0xbf37c655
.long 0x3f800000,0,0x3f718f57,0xbea986c4,0x3f47de65,0xbf1ff6cb,0x3f07a136,0xbf591e6a
.long 0x3e605c13,0xbf79c79d,0xbdee3876,0xbf7e4323,0xbee0924f,0xbf660f88,0xbf36206c,0xbf33e7bc
.long 0x3f800000,0,0x3f714c7a,0xbeab0201,0x3f46e22a,0xbf212ff9,0x3f05a02c,0xbf5a5ba0
.long 0x3e541501,0xbf7a7302,0xbe06b26e,0xbf7dc68c,0xbee900b7,0xbf63f473,0xbf39f2ac,0xbf2ff3e6
.long 0x3f800000,0,0x3f710908,0xbeac7cd4,0x3f45e403,0xbf226799,0x3f039c3d,0xbf5b941a
.long 0x3e47c5c2,0xbf7b14be,0xbe164083,0xbf7d3aac,0xbef15aea,0xbf61c598,0xbf3daef9,0xbf2beb4a
.long 0x3f800000,0,0x3f70c501,0xbeadf73c,0x3f44e3f5,0xbf239da9,0x3f019573,0xbf5cc7d1
.long 0x3e3b6ecf,0xbf7baccd,0xbe25c58c,0xbf7c9f8a,0xbef9a02d,0xbf5f8327,0xbf4154e1,0xbf27ce61
.long 0x3f800000,0,0x3f708066,0xbeaf713a,0x3f43e200,0xbf24d225,0x3eff17b2,0xbf5df6be
.long 0x3e2f10a2,0xbf7c3b28,0xbe354098,0xbf7bf531,0xbf00e7e4,0xbf5d2d53,0xbf44e3f5,0xbf239da9
.long 0x3f800000,0,0x3f703b37,0xbeb0eacb,0x3f42de29,0xbf26050a,0x3efafef7,0xbf5f20db
.long 0x3e22abb6,0xbf7cbfc9,0xbe44b0b9,0xbf7b3bab,0xbf04f484,0xbf5ac450,0xbf485bca,0xbf1f599f
.long 0x3f800000,0,0x3f6ff573,0xbeb263ef,0x3f41d870,0xbf273656,0x3ef6e0cb,0xbf604621
.long 0x3e164083,0xbf7d3aac,0xbe541501,0xbf7a7302,0xbf08f59b,0xbf584853,0xbf4bbbf8,0xbf1b02c6
.long 0x3f800000,0,0x3f6faf1b,0xbeb3dca5,0x3f40d0da,0xbf286605,0x3ef2bd43,0xbf61668a
.long 0x3e09cf86,0xbf7dabcc,0xbe636c83,0xbf799b43,0xbf0cead0,0xbf55b993,0xbf4f0417,0xbf16999f
.long 0x3f800000,0,0x3f6f6830,0xbeb554ec,0x3f3fc767,0xbf299415,0x3eee9479,0xbf628210
.long 0x3dfab273,0xbf7e1324,0xbe72b651,0xbf78b47b,0xbf10d3cd,0xbf531849,0xbf5233c6,0xbf121eb0
.long 0x3f800000,0,0x3f6f20b0,0xbeb6ccc3,0x3f3ebc1b,0xbf2ac082,0x3eea6681,0xbf6398ac
.long 0x3de1bc2e,0xbf7e70b0,0xbe80f8c0,0xbf77beb7,0xbf14b039,0xbf5064af,0xbf554aa4,0xbf0d9281
.long 0x3f800000,0,0x3f6ed89e,0xbeb8442a,0x3f3daef9,0xbf2beb4a,0x3ee63375,0xbf64aa59
.long 0x3dc8bd36,0xbf7ec46d,0xbe888e93,0xbf76ba07,0xbf187fc0,0xbf4d9f02,0xbf584853,0xbf08f59b
.long 0x3f800000,0,0x3f6e8ff8,0xbeb9bb1e,0x3f3ca003,0xbf2d1469,0x3ee1fb6a,0xbf65b710
.long 0x3dafb680,0xbf7f0e58,0xbe901c2c,0xbf75a67b,0xbf1c420c,0xbf4ac77f,0xbf5b2c79,0xbf044889
.long 0x3f800000,0,0x3f6e46be,0xbebb31a0,0x3f3b8f3b,0xbf2e3bde,0x3eddbe79,0xbf66becc
.long 0x3d96a905,0xbf7f4e6d,0xbe97a117,0xbf748422,0xbf1ff6cb,0xbf47de65,0xbf5df6be,0xbeff17b2
.long 0x3f800000,0,0x3f6dfcf2,0xbebca7af,0x3f3a7ca4,0xbf2f61a5,0x3ed97cb9,0xbf67c187
.long 0x3d7b2b74,0xbf7f84ab,0xbe9f1cdf,0xbf73530e,0xbf239da9,0xbf44e3f5,0xbf60a6cf,0xbef58035
.long 0x3f800000,0,0x3f6db293,0xbebe1d4a,0x3f396842,0xbf3085bb,0x3ed53641,0xbf68bf3c
.long 0x3d48fb30,0xbf7fb10f,0xbea68f12,0xbf721352,0xbf273656,0xbf41d870,0xbf633c5a,0xbeebcbbb
.long 0x3f800000,0,0x3f6d67a1,0xbebf926f,0x3f385216,0xbf31a81d,0x3ed0eb2a,0xbf69b7e4
.long 0x3d16c32c,0xbf7fd397,0xbeadf73c,0xbf70c501,0xbf2ac082,0xbf3ebc1b,0xbf65b710,0xbee1fb6a
.long 0x3f800000,0,0x3f6d1c1d,0xbec1071e,0x3f373a23,0xbf32c8c9,0x3ecc9b8b,0xbf6aab7b
.long 0x3cc90ab0,0xbf7fec43,0xbeb554ec,0xbf6f6830,0xbf2e3bde,0xbf3b8f3b,0xbf6816a8,0xbed8106b
.long 0x3f800000,0,0x3f6cd007,0xbec27b55,0x3f36206c,0xbf33e7bc,0x3ec8477c,0xbf6b99fb
.long 0x3c490e90,0xbf7ffb11,0xbebca7af,0xbf6dfcf2,0xbf31a81d,0xbf385216,0xbf6a5ad9,0xbece0bea
.long 0x3f800000,0,0x3f6c835e,0xbec3ef15,0x3f3504f3,0xbf3504f3,0x3ec3ef15,0xbf6c835e
.long 0,0xbf800000,0xbec3ef15,0xbf6c835e,0xbf3504f3,0xbf3504f3,0xbf6c835e,0xbec3ef15
.long 0x3f800000,0,0x3f6c3624,0xbec5625c,0x3f33e7bc,0xbf36206c,0x3ebf926f,0xbf6d67a1
.long 0xbc490e90,0xbf7ffb11,0xbecb2aae,0xbf6afb8c,0xbf385216,0xbf31a81d,0xbf6e8ff8,0xbeb9bb1e
.long 0x3f800000,0,0x3f6be858,0xbec6d529,0x3f32c8c9,0xbf373a23,0x3ebb31a0,0xbf6e46be
.long 0xbcc90ab0,0xbf7fec43,0xbed25a09,0xbf696591,0xbf3b8f3b,0xbf2e3bde,0xbf708066,0xbeaf713a
.long 0x3f800000,0,0x3f6b99fb,0xbec8477c,0x3f31a81d,0xbf385216,0x3eb6ccc3,0xbf6f20b0
.long 0xbd16c32c,0xbf7fd397,0xbed97cb9,0xbf67c187,0xbf3ebc1b,0xbf2ac082,0xbf725470,0xbea5129f
.long 0x3f800000,0,0x3f6b4b0c,0xbec9b953,0x3f3085bb,0xbf396842,0x3eb263ef,0xbf6ff573
.long 0xbd48fb30,0xbf7fb10f,0xbee0924f,0xbf660f88,0xbf41d870,0xbf273656,0xbf740bdd,0xbe9aa086
.long 0x3f800000,0,0x3f6afb8c,0xbecb2aae,0x3f2f61a5,0xbf3a7ca4,0x3eadf73c,0xbf70c501
.long 0xbd7b2b74,0xbf7f84ab,0xbee79a5d,0xbf644fac,0xbf44e3f5,0xbf239da9,0xbf75a67b,0xbe901c2c
.long 0x3f800000,0,0x3f6aab7b,0xbecc9b8b,0x3f2e3bde,0xbf3b8f3b,0x3ea986c4,0xbf718f57
.long 0xbd96a905,0xbf7f4e6d,0xbeee9479,0xbf628210,0xbf47de65,0xbf1ff6cb,0xbf772417,0xbe8586ce
.long 0x3f800000,0,0x3f6a5ad9,0xbece0bea,0x3f2d1469,0xbf3ca003,0x3ea5129f,0xbf725470
.long 0xbdafb680,0xbf7f0e58,0xbef58035,0xbf60a6cf,0xbf4ac77f,0xbf1c420c,0xbf788486,0xbe75c35a
.long 0x3f800000,0,0x3f6a09a7,0xbecf7bca,0x3f2beb4a,0xbf3daef9,0x3ea09ae5,0xbf731447
.long 0xbdc8bd36,0xbf7ec46d,0xbefc5d27,0xbf5ebe05,0xbf4d9f02,0xbf187fc0,0xbf79c79d,0xbe605c13
.long 0x3f800000,0,0x3f69b7e4,0xbed0eb2a,0x3f2ac082,0xbf3ebc1b,0x3e9c1faf,0xbf73ced9
.long 0xbde1bc2e,0xbf7e70b0,0xbf019573,0xbf5cc7d1,0xbf5064af,0xbf14b039,0xbf7aed37,0xbe4ada4f
.long 0x3f800000,0,0x3f696591,0xbed25a09,0x3f299415,0xbf3fc767,0x3e97a117,0xbf748422
.long 0xbdfab273,0xbf7e1324,0xbf04f484,0xbf5ac450,0xbf531849,0xbf10d3cd,0xbf7bf531,0xbe354098
.long 0x3f800000,0,0x3f6912ae,0xbed3c867,0x3f286605,0xbf40d0da,0x3e931f35,0xbf75341d
.long 0xbe09cf86,0xbf7dabcc,0xbf084b92,0xbf58b3a1,0xbf55b993,0xbf0cead0,0xbf7cdf6c,0xbe1f917b
.long 0x3f800000,0,0x3f68bf3c,0xbed53641,0x3f273656,0xbf41d870,0x3e8e9a22,0xbf75dec6
.long 0xbe164083,0xbf7d3aac,0xbf0b9a6b,0xbf5695e5,0xbf584853,0xbf08f59b,0xbf7dabcc,0xbe09cf86
.long 0x3f800000,0,0x3f686b39,0xbed6a399,0x3f26050a,0xbf42de29,0x3e8a11f7,0xbf76841b
.long 0xbe22abb6,0xbf7cbfc9,0xbf0ee0db,0xbf546b3b,0xbf5ac450,0xbf04f484,0xbf7e5a38,0xbde7fa9a
.long 0x3f800000,0,0x3f6816a8,0xbed8106b,0x3f24d225,0xbf43e200,0x3e8586ce,0xbf772417
.long 0xbe2f10a2,0xbf7c3b28,0xbf121eb0,0xbf5233c6,0xbf5d2d53,0xbf00e7e4,0xbf7eea9d,0xbdbc3ac3
.long 0x3f800000,0,0x3f67c187,0xbed97cb9,0x3f239da9,0xbf44e3f5,0x3e80f8c0,0xbf77beb7
.long 0xbe3b6ecf,0xbf7baccd,0xbf1553b7,0xbf4fefa8,0xbf5f8327,0xbef9a02d,0xbf7f5ce9,0xbd9064b4
.long 0x3f800000,0,0x3f676bd8,0xbedae880,0x3f226799,0xbf45e403,0x3e78cfcc,0xbf7853f8
.long 0xbe47c5c2,0xbf7b14be,0xbf187fc0,0xbf4d9f02,0xbf61c598,0xbef15aea,0xbf7fb10f,0xbd48fb30
.long 0x3f800000,0,0x3f671599,0xbedc53c1,0x3f212ff9,0xbf46e22a,0x3e6fa8b2,0xbf78e3d6
.long 0xbe541501,0xbf7a7302,0xbf1ba299,0xbf4b41fa,0xbf63f473,0xbee900b7,0xbf7fe705,0xbce22a7a
.long 0x3f800000,0,0x3f66becc,0xbeddbe79,0x3f1ff6cb,0xbf47de65,0x3e667c66,0xbf796e4e
.long 0xbe605c13,0xbf79c79d,0xbf1ebc12,0xbf48d8b3,0xbf660f88,0xbee0924f,0xbf7ffec4,0xbbc90f88
.long 0x3f800000,0,0x3f666771,0xbedf28a9,0x3f1ebc12,0xbf48d8b3,0x3e5d4b1a,0xbf79f35e
.long 0xbe6c9a7f,0xbf791298,0xbf21cbfb,0xbf466354,0xbf6816a8,0xbed8106b,0xbf7ff84a,0x3c7b514b
.long 0x3f800000,0,0x3f660f88,0xbee0924f,0x3f1d7fd1,0xbf49d112,0x3e541501,0xbf7a7302
.long 0xbe78cfcc,0xbf7853f8,0xbf24d225,0xbf43e200,0xbf6a09a7,0xbecf7bca,0xbf7fd397,0x3d16c32c
.long 0x3f800000,0,0x3f65b710,0xbee1fb6a,0x3f1c420c,0xbf4ac77f,0x3e4ada4f,0xbf7aed37
.long 0xbe827dc0,0xbf778bc5,0xbf27ce61,0xbf4154e1,0xbf6be858,0xbec6d529,0xbf7f90b1,0x3d6ea038
.long 0x3f800000,0,0x3f655e0b,0xbee363fa,0x3f1b02c6,0xbf4bbbf8,0x3e419b37,0xbf7b61fc
.long 0xbe888e93,0xbf76ba07,0xbf2ac082,0xbf3ebc1b,0xbf6db293,0xbebe1d4a,0xbf7f2f9d,0x3da3308c
.long 0x3f800000,0,0x3f650479,0xbee4cbfe,0x3f19c200,0xbf4cae79,0x3e3857ec,0xbf7bd14d
.long 0xbe8e9a22,0xbf75dec6,0xbf2da859,0xbf3c17d9,0xbf6f6830,0xbeb554ec,0xbf7eb069,0x3dcefdb7
.long 0x3f800000,0,0x3f64aa59,0xbee63375,0x3f187fc0,0xbf4d9f02,0x3e2f10a2,0xbf7c3b28
.long 0xbe94a031,0xbf74fa0b,0xbf3085bb,0xbf396842,0xbf710908,0xbeac7cd4,0xbf7e1324,0x3dfab273
.long 0x3f800000,0,0x3f644fac,0xbee79a5d,0x3f173c07,0xbf4e8d90,0x3e25c58c,0xbf7c9f8a
.long 0xbe9aa086,0xbf740bdd,0xbf33587a,0xbf36ad7f,0xbf7294f8,0xbea395c5,0xbf7d57de,0x3e1324ca
.long 0x3f800000,0,0x3f63f473,0xbee900b7,0x3f15f6d9,0xbf4f7a1f,0x3e1c76de,0xbf7cfe73
.long 0xbea09ae5,0xbf731447,0xbf36206c,0xbf33e7bc,0xbf740bdd,0xbe9aa086,0xbf7c7eb0,0x3e28defc
.long 0x3f800000,0,0x3f6398ac,0xbeea6681,0x3f14b039,0xbf5064af,0x3e1324ca,0xbf7d57de
.long 0xbea68f12,0xbf721352,0xbf38dd65,0xbf311722,0xbf756d97,0xbe919ddd,0xbf7b87b2,0x3e3e853e
.long 0x3f800000,0,0x3f633c5a,0xbeebcbbb,0x3f13682a,0xbf514d3d,0x3e09cf86,0xbf7dabcc
.long 0xbeac7cd4,0xbf710908,0xbf3b8f3b,0xbf2e3bde,0xbf76ba07,0xbe888e93,0xbf7a7302,0x3e541501
.long 0x3f800000,0,0x3f62df7b,0xbeed3063,0x3f121eb0,0xbf5233c6,0x3e007745,0xbf7dfa38
.long 0xbeb263ef,0xbf6ff573,0xbf3e35c5,0xbf2b561b,0xbf77f110,0xbe7ee6e1,0xbf7940c0,0x3e698bba
.long 0x3f800000,0,0x3f628210,0xbeee9479,0x3f10d3cd,0xbf531849,0x3dee3876,0xbf7e4323
.long 0xbeb8442a,0xbf6ed89e,0xbf40d0da,0xbf286605,0xbf791298,0xbe6c9a7f,0xbf77f110,0x3e7ee6e1
.long 0x3f800000,0,0x3f62241a,0xbeeff7fb,0x3f0f8784,0xbf53fac3,0x3ddb7d37,0xbf7e868b
.long 0xbebe1d4a,0xbf6db293,0xbf436051,0xbf256bcb,0xbf7a1e84,0xbe5a3997,0xbf76841b,0x3e8a11f7
.long 0x3f800000,0,0x3f61c598,0xbef15aea,0x3f0e39da,0xbf54db31,0x3dc8bd36,0xbf7ec46d
.long 0xbec3ef15,0xbf6c835e,0xbf45e403,0xbf226799,0xbf7b14be,0xbe47c5c2,0xbf74fa0b,0x3e94a031
.long 0x3f800000,0,0x3f61668a,0xbef2bd43,0x3f0cead0,0xbf55b993,0x3db5f8da,0xbf7efcc9
.long 0xbec9b953,0xbf6b4b0c,0xbf485bca,0xbf1f599f,0xbf7bf531,0xbe354098,0xbf73530e,0x3e9f1cdf
.long 0x3f800000,0,0x3f6106f2,0xbef41f07,0x3f0b9a6b,0xbf5695e5,0x3da3308c,0xbf7f2f9d
.long 0xbecf7bca,0xbf6a09a7,0xbf4ac77f,0xbf1c420c,0xbf7cbfc9,0xbe22abb6,0xbf718f57,0x3ea986c4
.long 0x3f800000,0,0x3f60a6cf,0xbef58035,0x3f0a48ad,0xbf577026,0x3d9064b4,0xbf7f5ce9
.long 0xbed53641,0xbf68bf3c,0xbf4d26fd,0xbf19210f,0xbf7d7474,0xbe1008b7,0xbf6faf1b,0x3eb3dca5
.long 0x3f800000,0,0x3f604621,0xbef6e0cb,0x3f08f59b,0xbf584853,0x3d7b2b74,0xbf7f84ab
.long 0xbedae880,0xbf676bd8,0xbf4f7a1f,0xbf15f6d9,0xbf7e1324,0xbdfab273,0xbf6db293,0x3ebe1d4a
.long 0x3f800000,0,0x3f5fe4e9,0xbef840c8,0x3f07a136,0xbf591e6a,0x3d55880e,0xbf7fa6e3
.long 0xbee0924f,0xbf660f88,0xbf51c0c2,0xbf12c39a,0xbf7e9bc9,0xbdd53db9,0xbf6b99fb,0x3ec8477c
.long 0x3f800000,0,0x3f5f8327,0xbef9a02d,0x3f064b82,0xbf59f26a,0x3d2fe007,0xbf7fc38f
.long 0xbee63375,0xbf64aa59,0xbf53fac3,0xbf0f8784,0xbf7f0e58,0xbdafb680,0xbf696591,0x3ed25a09
.long 0x3f800000,0,0x3f5f20db,0xbefafef7,0x3f04f484,0xbf5ac450,0x3d0a342f,0xbf7fdaaf
.long 0xbeebcbbb,0xbf633c5a,0xbf5627fe,0xbf0c42c9,0xbf7f6ac7,0xbd8a200a,0xbf671599,0x3edc53c1
.long 0x3f800000,0,0x3f5ebe05,0xbefc5d27,0x3f039c3d,0xbf5b941a,0x3cc90ab0,0xbf7fec43
.long 0xbef15aea,0xbf61c598,0xbf584853,0xbf08f59b,0xbf7fb10f,0xbd48fb30,0xbf64aa59,0x3ee63375
.long 0x3f800000,0,0x3f5e5aa6,0xbefdbabb,0x3f0242b1,0xbf5c61c7,0x3c7b514b,0xbf7ff84a
.long 0xbef6e0cb,0xbf604621,0xbf5a5ba0,0xbf05a02c,0xbf7fe129,0xbcfb49ba,0xbf62241a,0x3eeff7fb
.long 0x3f800000,0,0x3f5df6be,0xbeff17b2,0x3f00e7e4,0xbf5d2d53,0x3bc90f88,0xbf7ffec4
.long 0xbefc5d27,0xbf5ebe05,0xbf5c61c7,0xbf0242b1,0xbf7ffb11,0xbc490e90,0xbf5f8327,0x3ef9a02d
.long 0x3f800000,0,0x3f5d924d,0xbf003a06,0x3eff17b2,0xbf5df6be,0xbb490fc6,0xbf7fffb1
.long 0xbf00e7e4,0xbf5d2d53,0xbf5e5aa6,0xbefdbabb,0xbf7ffec4,0x3bc90f88,0xbf5cc7d1,0x3f019573
.long 0x3f800000,0,0x3f5d2d53,0xbf00e7e4,0x3efc5d27,0xbf5ebe05,0xbc490e90,0xbf7ffb11
.long 0xbf039c3d,0xbf5b941a,0xbf604621,0xbef6e0cb,0xbf7fec43,0x3cc90ab0,0xbf59f26a,0x3f064b82
.long 0x3f800000,0,0x3f5cc7d1,0xbf019573,0x3ef9a02d,0xbf5f8327,0xbcafea69,0xbf7ff0e3
.long 0xbf064b82,0xbf59f26a,0xbf62241a,0xbeeff7fb,0xbf7fc38f,0x3d2fe007,0xbf570348,0x3f0af1b7
.long 0x3f800000,0,0x3f5c61c7,0xbf0242b1,0x3ef6e0cb,0xbf604621,0xbcfb49ba,0xbf7fe129
.long 0xbf08f59b,0xbf584853,0xbf63f473,0xbee900b7,0xbf7f84ab,0x3d7b2b74,0xbf53fac3,0x3f0f8784
.long 0x3f800000,0,0x3f5bfb34,0xbf02ef9f,0x3ef41f07,0xbf6106f2,0xbd2351cb,0xbf7fcbe2
.long 0xbf0b9a6b,0xbf5695e5,0xbf65b710,0xbee1fb6a,0xbf7f2f9d,0x3da3308c,0xbf50d937,0x3f140c5f
.long 0x3f800000,0,0x3f5b941a,0xbf039c3d,0x3ef15aea,0xbf61c598,0xbd48fb30,0xbf7fb10f
.long 0xbf0e39da,0xbf54db31,0xbf676bd8,0xbedae880,0xbf7ec46d,0x3dc8bd36,0xbf4d9f02,0x3f187fc0
.long 0x3f800000,0,0x3f5b2c79,0xbf044889,0x3eee9479,0xbf628210,0xbd6ea038,0xbf7f90b1
.long 0xbf10d3cd,0xbf531849,0xbf6912ae,0xbed3c867,0xbf7e4323,0x3dee3876,0xbf4a4c87,0x3f1ce11f
.long 0x3f800000,0,0x3f5ac450,0xbf04f484,0x3eebcbbb,0xbf633c5a,0xbd8a200a,0xbf7f6ac7
.long 0xbf13682a,0xbf514d3d,0xbf6aab7b,0xbecc9b8b,0xbf7dabcc,0x3e09cf86,0xbf46e22a,0x3f212ff9
.long 0x3f800000,0,0x3f5a5ba0,0xbf05a02c,0x3ee900b7,0xbf63f473,0xbd9cecf9,0xbf7f3f54
.long 0xbf15f6d9,0xbf4f7a1f,0xbf6c3624,0xbec5625c,0xbf7cfe73,0x3e1c76de,0xbf436051,0x3f256bcb
.long 0x3f800000,0,0x3f59f26a,0xbf064b82,0x3ee63375,0xbf64aa59,0xbdafb680,0xbf7f0e58
.long 0xbf187fc0,0xbf4d9f02,0xbf6db293,0xbebe1d4a,0xbf7c3b28,0x3e2f10a2,0xbf3fc767,0x3f299415
.long 0x3f800000,0,0x3f5988ad,0xbf06f686,0x3ee363fa,0xbf655e0b,0xbdc27c39,0xbf7ed7d4
.long 0xbf1b02c6,0xbf4bbbf8,0xbf6f20b0,0xbeb6ccc3,0xbf7b61fc,0x3e419b37,0xbf3c17d9,0x3f2da859
.long 0x3f800000,0,0x3f591e6a,0xbf07a136,0x3ee0924f,0xbf660f88,0xbdd53db9,0xbf7e9bc9
.long 0xbf1d7fd1,0xbf49d112,0xbf708066,0xbeaf713a,0xbf7a7302,0x3e541501,0xbf385216,0x3f31a81d
.long 0x3f800000,0,0x3f58b3a1,0xbf084b92,0x3eddbe79,0xbf66becc,0xbde7fa9a,0xbf7e5a38
.long 0xbf1ff6cb,0xbf47de65,0xbf71d19f,0xbea80b1f,0xbf796e4e,0x3e667c66,0xbf34768f,0x3f3592e7
.long 0x3f800000,0,0x3f584853,0xbf08f59b,0x3edae880,0xbf676bd8,0xbdfab273,0xbf7e1324
.long 0xbf226799,0xbf45e403,0xbf731447,0xbea09ae5,0xbf7853f8,0x3e78cfcc,0xbf3085bb,0x3f396842
.long 0x3f800000,0,0x3f57dc7f,0xbf099f4e,0x3ed8106b,0xbf6816a8,0xbe06b26e,0xbf7dc68c
.long 0xbf24d225,0xbf43e200,0xbf74484b,0xbe9920fe,0xbf772417,0x3e8586ce,0xbf2c800f,0x3f3d27b8
.long 0x3f800000,0,0x3f577026,0xbf0a48ad,0x3ed53641,0xbf68bf3c,0xbe1008b7,0xbf7d7474
.long 0xbf273656,0xbf41d870,0xbf756d97,0xbe919ddd,0xbf75dec6,0x3e8e9a22,0xbf286605,0x3f40d0da
.long 0x3f800000,0,0x3f570348,0xbf0af1b7,0x3ed25a09,0xbf696591,0xbe195be0,0xbf7d1cdd
.long 0xbf299415,0xbf3fc767,0xbf76841b,0xbe8a11f7,0xbf748422,0x3e97a117,0xbf24381a,0x3f446337
.long 0x3f800000,0,0x3f5695e5,0xbf0b9a6b,0x3ecf7bca,0xbf6a09a7,0xbe22abb6,0xbf7cbfc9
.long 0xbf2beb4a,0xbf3daef9,0xbf778bc5,0xbe827dc0,0xbf731447,0x3ea09ae5,0xbf1ff6cb,0x3f47de65
.long 0x3f800000,0,0x3f5627fe,0xbf0c42c9,0x3ecc9b8b,0xbf6aab7b,0xbe2bf804,0xbf7c5d3a
.long 0xbf2e3bde,0xbf3b8f3b,0xbf788486,0xbe75c35a,0xbf718f57,0x3ea986c4,0xbf1ba299,0x3f4b41fa
.long 0x3f800000,0,0x3f55b993,0xbf0cead0,0x3ec9b953,0xbf6b4b0c,0xbe354098,0xbf7bf531
.long 0xbf3085bb,0xbf396842,0xbf796e4e,0xbe667c66,0xbf6ff573,0x3eb263ef,0xbf173c07,0x3f4e8d90
.long 0x3f800000,0,0x3f554aa4,0xbf0d9281,0x3ec6d529,0xbf6be858,0xbe3e853e,0xbf7b87b2
.long 0xbf32c8c9,0xbf373a23,0xbf7a4910,0xbe57278f,0xbf6e46be,0x3ebb31a0,0xbf12c39a,0x3f51c0c2
.long 0x3f800000,0,0x3f54db31,0xbf0e39da,0x3ec3ef15,0xbf6c835e,0xbe47c5c2,0xbf7b14be
.long 0xbf3504f3,0xbf3504f3,0xbf7b14be,0xbe47c5c2,0xbf6c835e,0x3ec3ef15,0xbf0e39da,0x3f54db31
.long 0x3f800000,0,0x3f546b3b,0xbf0ee0db,0x3ec1071e,0xbf6d1c1d,0xbe5101f1,0xbf7a9c59
.long 0xbf373a23,0xbf32c8c9,0xbf7bd14d,0xbe3857ec,0xbf6aab7b,0x3ecc9b8b,0xbf099f4e,0x3f57dc7f
.long 0x3f800000,0,0x3f53fac3,0xbf0f8784,0x3ebe1d4a,0xbf6db293,0xbe5a3997,0xbf7a1e84
.long 0xbf396842,0xbf3085bb,0xbf7c7eb0,0xbe28defc,0xbf68bf3c,0x3ed53641,0xbf04f484,0x3f5ac450
.long 0x3f800000,0,0x3f5389c7,0xbf102dd5,0x3ebb31a0,0xbf6e46be,0xbe636c83,0xbf799b43
.long 0xbf3b8f3b,0xbf2e3bde,0xbf7d1cdd,0xbe195be0,0xbf66becc,0x3eddbe79,0xbf003a06,0x3f5d924d
.long 0x3f800000,0,0x3f531849,0xbf10d3cd,0x3eb8442a,0xbf6ed89e,0xbe6c9a7f,0xbf791298
.long 0xbf3daef9,0xbf2beb4a,0xbf7dabcc,0xbe09cf86,0xbf64aa59,0x3ee63375,0xbef6e0cb,0x3f604621
.long 0x3f800000,0,0x3f52a649,0xbf11796b,0x3eb554ec,0xbf6f6830,0xbe75c35a,0xbf788486
.long 0xbf3fc767,0xbf299415,0xbf7e2b72,0xbdf475c0,0xbf628210,0x3eee9479,0xbeed3063,0x3f62df7b
.long 0x3f800000,0,0x3f5233c6,0xbf121eb0,0x3eb263ef,0xbf6ff573,0xbe7ee6e1,0xbf77f110
.long 0xbf41d870,0xbf273656,0xbf7e9bc9,0xbdd53db9,0xbf604621,0x3ef6e0cb,0xbee363fa,0x3f655e0b
.long 0x3f800000,0,0x3f51c0c2,0xbf12c39a,0x3eaf713a,0xbf708066,0xbe840270,0xbf77583a
.long 0xbf43e200,0xbf24d225,0xbf7efcc9,0xbdb5f8da,0xbf5df6be,0x3eff17b2,0xbed97cb9,0x3f67c187
.long 0x3f800000,0,0x3f514d3d,0xbf13682a,0x3eac7cd4,0xbf710908,0xbe888e93,0xbf76ba07
.long 0xbf45e403,0xbf226799,0xbf7f4e6d,0xbd96a905,0xbf5b941a,0x3f039c3d,0xbecf7bca,0x3f6a09a7
.long 0x3f800000,0,0x3f50d937,0xbf140c5f,0x3ea986c4,0xbf718f57,0xbe8d17c0,0xbf76167a
.long 0xbf47de65,0xbf1ff6cb,0xbf7f90b1,0xbd6ea038,0xbf591e6a,0x3f07a136,0xbec5625c,0x3f6c3624
.long 0x3f800000,0,0x3f5064af,0xbf14b039,0x3ea68f12,0xbf721352,0xbe919ddd,0xbf756d97
.long 0xbf49d112,0xbf1d7fd1,0xbf7fc38f,0xbd2fe007,0xbf5695e5,0x3f0b9a6b,0xbebb31a0,0x3f6e46be
.long 0x3f800000,0,0x3f4fefa8,0xbf1553b7,0x3ea395c5,0xbf7294f8,0xbe9620d2,0xbf74bf62
.long 0xbf4bbbf8,0xbf1b02c6,0xbf7fe705,0xbce22a7a,0xbf53fac3,0x3f0f8784,0xbeb0eacb,0x3f703b37
.long 0x3f800000,0,0x3f4f7a1f,0xbf15f6d9,0x3ea09ae5,0xbf731447,0xbe9aa086,0xbf740bdd
.long 0xbf4d9f02,0xbf187fc0,0xbf7ffb11,0xbc490e90,0xbf514d3d,0x3f13682a,0xbea68f12,0x3f721352
.long 0x3f800000,0,0x3f4f0417,0xbf16999f,0x3e9d9e78,0xbf73913f,0xbe9f1cdf,0xbf73530e
.long 0xbf4f7a1f,0xbf15f6d9,0xbf7fffb1,0x3b490fc6,0xbf4e8d90,0x3f173c07,0xbe9c1faf,0x3f73ced9
.long 0x3f800000,0,0x3f4e8d90,0xbf173c07,0x3e9aa086,0xbf740bdd,0xbea395c5,0xbf7294f8
.long 0xbf514d3d,0xbf13682a,0xbf7ff4e6,0x3c96c9b6,0xbf4bbbf8,0x3f1b02c6,0xbe919ddd,0x3f756d97
.long 0x3f800000,0,0x3f4e1689,0xbf17de12,0x3e97a117,0xbf748422,0xbea80b1f,0xbf71d19f
.long 0xbf531849,0xbf10d3cd,0xbf7fdaaf,0x3d0a342f,0xbf48d8b3,0x3f1ebc12,0xbe870ada,0x3f76ef5b
.long 0x3f800000,0,0x3f4d9f02,0xbf187fc0,0x3e94a031,0xbf74fa0b,0xbeac7cd4,0xbf710908
.long 0xbf54db31,0xbf0e39da,0xbf7fb10f,0x3d48fb30,0xbf45e403,0x3f226799,0xbe78cfcc,0x3f7853f8
.long 0x3f800000,0,0x3f4d26fd,0xbf19210f,0x3e919ddd,0xbf756d97,0xbeb0eacb,0xbf703b37
.long 0xbf5695e5,0xbf0b9a6b,0xbf7f7808,0x3d83db0a,0xbf42de29,0x3f26050a,0xbe636c83,0x3f799b43
.long 0x3f800000,0,0x3f4cae79,0xbf19c200,0x3e8e9a22,0xbf75dec6,0xbeb554ec,0xbf6f6830
.long 0xbf584853,0xbf08f59b,0xbf7f2f9d,0x3da3308c,0xbf3fc767,0x3f299415,0xbe4dee60,0x3f7ac516
.long 0x3f800000,0,0x3f4c3578,0xbf1a6293,0x3e8b9507,0xbf764d97,0xbeb9bb1e,0xbf6e8ff8
.long 0xbf59f26a,0xbf064b82,0xbf7ed7d4,0x3dc27c39,0xbf3ca003,0x3f2d1469,0xbe3857ec,0x3f7bd14d
.long 0x3f800000,0,0x3f4bbbf8,0xbf1b02c6,0x3e888e93,0xbf76ba07,0xbebe1d4a,0xbf6db293
.long 0xbf5b941a,0xbf039c3d,0xbf7e70b0,0x3de1bc2e,0xbf396842,0x3f3085bb,0xbe22abb6,0x3f7cbfc9
.long 0x3f800000,0,0x3f4b41fa,0xbf1ba299,0x3e8586ce,0xbf772417,0xbec27b55,0xbf6cd007
.long 0xbf5d2d53,0xbf00e7e4,0xbf7dfa38,0x3e007745,0xbf36206c,0x3f33e7bc,0xbe0cec4a,0x3f7d906e
.long 0x3f800000,0,0x3f4ac77f,0xbf1c420c,0x3e827dc0,0xbf778bc5,0xbec6d529,0xbf6be858
.long 0xbf5ebe05,0xbefc5d27,0xbf7d7474,0x3e1008b7,0xbf32c8c9,0x3f373a23,0xbdee3876,0x3f7e4323
.long 0x3f800000,0,0x3f4a4c87,0xbf1ce11f,0x3e7ee6e1,0xbf77f110,0xbecb2aae,0xbf6afb8c
.long 0xbf604621,0xbef6e0cb,0xbf7cdf6c,0x3e1f917b,0xbf2f61a5,0x3f3a7ca4,0xbdc27c39,0x3f7ed7d4
.long 0x3f800000,0,0x3f49d112,0xbf1d7fd1,0x3e78cfcc,0xbf7853f8,0xbecf7bca,0xbf6a09a7
.long 0xbf61c598,0xbef15aea,0xbf7c3b28,0x3e2f10a2,0xbf2beb4a,0x3f3daef9,0xbd96a905,0x3f7f4e6d
.long 0x3f800000,0,0x3f495521,0xbf1e1e22,0x3e72b651,0xbf78b47b,0xbed3c867,0xbf6912ae
.long 0xbf633c5a,0xbeebcbbb,0xbf7b87b2,0x3e3e853e,0xbf286605,0x3f40d0da,0xbd55880e,0x3f7fa6e3
.long 0x3f800000,0,0x3f48d8b3,0xbf1ebc12,0x3e6c9a7f,0xbf791298,0xbed8106b,0xbf6816a8
.long 0xbf64aa59,0xbee63375,0xbf7ac516,0x3e4dee60,0xbf24d225,0x3f43e200,0xbcfb49ba,0x3f7fe129
.long 0x3f800000,0,0x3f485bca,0xbf1f599f,0x3e667c66,0xbf796e4e,0xbedc53c1,0xbf671599
.long 0xbf660f88,0xbee0924f,0xbf79f35e,0x3e5d4b1a,0xbf212ff9,0x3f46e22a,0xbc16cb58,0x3f7ffd39
.long 0x3f800000,0,0x3f47de65,0xbf1ff6cb,0x3e605c13,0xbf79c79d,0xbee0924f,0xbf660f88
.long 0xbf676bd8,0xbedae880,0xbf791298,0x3e6c9a7f,0xbf1d7fd1,0x3f49d112,0x3c490e90,0x3f7ffb11
.long 0x3f800000,0,0x3f476085,0xbf209393,0x3e5a3997,0xbf7a1e84,0xbee4cbfe,0xbf650479
.long 0xbf68bf3c,0xbed53641,0xbf7822d1,0x3e7bdba4,0xbf19c200,0x3f4cae79,0x3d0a342f,0x3f7fdaaf
.long 0x3f800000,0,0x3f46e22a,0xbf212ff9,0x3e541501,0xbf7a7302,0xbee900b7,0xbf63f473
.long 0xbf6a09a7,0xbecf7bca,0xbf772417,0x3e8586ce,0xbf15f6d9,0x3f4f7a1f,0x3d621469,0x3f7f9c18
.long 0x3f800000,0,0x3f466354,0xbf21cbfb,0x3e4dee60,0xbf7ac516,0xbeed3063,0xbf62df7b
.long 0xbf6b4b0c,0xbec9b953,0xbf76167a,0x3e8d17c0,0xbf121eb0,0x3f5233c6,0x3d9cecf9,0x3f7f3f54
.long 0x3f800000,0,0x3f45e403,0xbf226799,0x3e47c5c2,0xbf7b14be,0xbef15aea,0xbf61c598
.long 0xbf6c835e,0xbec3ef15,0xbf74fa0b,0x3e94a031,0xbf0e39da,0x3f54db31,0x3dc8bd36,0x3f7ec46d
.long 0x3f800000,0,0x3f456439,0xbf2302d3,0x3e419b37,0xbf7b61fc,0xbef58035,0xbf60a6cf
.long 0xbf6db293,0xbebe1d4a,0xbf73ced9,0x3e9c1faf,0xbf0a48ad,0x3f577026,0x3df475c0,0x3f7e2b72
.long 0x3f800000,0,0x3f44e3f5,0xbf239da9,0x3e3b6ecf,0xbf7baccd,0xbef9a02d,0xbf5f8327
.long 0xbf6ed89e,0xbeb8442a,0xbf7294f8,0x3ea395c5,0xbf064b82,0x3f59f26a,0x3e1008b7,0x3f7d7474
.long 0x3f800000,0,0x3f446337,0xbf24381a,0x3e354098,0xbf7bf531,0xbefdbabb,0xbf5e5aa6
.long 0xbf6ff573,0xbeb263ef,0xbf714c7a,0x3eab0201,0xbf0242b1,0x3f5c61c7,0x3e25c58c,0x3f7c9f8a
.long 0x3f800000,0,0x3f43e200,0xbf24d225,0x3e2f10a2,0xbf7c3b28,0xbf00e7e4,0xbf5d2d53
.long 0xbf710908,0xbeac7cd4,0xbf6ff573,0x3eb263ef,0xbefc5d27,0x3f5ebe05,0x3e3b6ecf,0x3f7baccd
.long 0x3f800000,0,0x3f436051,0xbf256bcb,0x3e28defc,0xbf7c7eb0,0xbf02ef9f,0xbf5bfb34
.long 0xbf721352,0xbea68f12,0xbf6e8ff8,0x3eb9bb1e,0xbef41f07,0x3f6106f2,0x3e5101f1,0x3f7a9c59
.long 0x3f800000,0,0x3f42de29,0xbf26050a,0x3e22abb6,0xbf7cbfc9,0xbf04f484,0xbf5ac450
.long 0xbf731447,0xbea09ae5,0xbf6d1c1d,0x3ec1071e,0xbeebcbbb,0x3f633c5a,0x3e667c66,0x3f796e4e
.long 0x3f800000,0,0x3f425b89,0xbf269de3,0x3e1c76de,0xbf7cfe73,0xbf06f686,0xbf5988ad
.long 0xbf740bdd,0xbe9aa086,0xbf6b99fb,0x3ec8477c,0xbee363fa,0x3f655e0b,0x3e7bdba4,0x3f7822d1
.long 0x3f800000,0,0x3f41d870,0xbf273656,0x3e164083,0xbf7d3aac,0xbf08f59b,0xbf584853
.long 0xbf74fa0b,0xbe94a031,0xbf6a09a7,0x3ecf7bca,0xbedae880,0x3f676bd8,0x3e888e93,0x3f76ba07
.long 0x3f800000,0,0x3f4154e1,0xbf27ce61,0x3e1008b7,0xbf7d7474,0xbf0af1b7,0xbf570348
.long 0xbf75dec6,0xbe8e9a22,0xbf686b39,0x3ed6a399,0xbed25a09,0x3f696591,0x3e931f35,0x3f75341d
.long 0x3f800000,0,0x3f40d0da,0xbf286605,0x3e09cf86,0xbf7dabcc,0xbf0cead0,0xbf55b993
.long 0xbf76ba07,0xbe888e93,0xbf66becc,0x3eddbe79,0xbec9b953,0x3f6b4b0c,0x3e9d9e78,0x3f73913f
.long 0x3f800000,0,0x3f404c5c,0xbf28fd41,0x3e039502,0xbf7de0b1,0xbf0ee0db,0xbf546b3b
.long 0xbf778bc5,0xbe827dc0,0xbf650479,0x3ee4cbfe,0xbec1071e,0x3f6d1c1d,0x3ea80b1f,0x3f71d19f
.long 0x3f800000,0,0x3f3fc767,0xbf299415,0x3dfab273,0xbf7e1324,0xbf10d3cd,0xbf531849
.long 0xbf7853f8,0xbe78cfcc,0xbf633c5a,0x3eebcbbb,0xbeb8442a,0x3f6ed89e,0x3eb263ef,0x3f6ff573
.long 0x3f800000,0,0x3f3f41fc,0xbf2a2a80,0x3dee3876,0xbf7e4323,0xbf12c39a,0xbf51c0c2
.long 0xbf791298,0xbe6c9a7f,0xbf61668a,0x3ef2bd43,0xbeaf713a,0x3f708066,0x3ebca7af,0x3f6dfcf2
.long 0x3f800000,0,0x3f3ebc1b,0xbf2ac082,0x3de1bc2e,0xbf7e70b0,0xbf14b039,0xbf5064af
.long 0xbf79c79d,0xbe605c13,0xbf5f8327,0x3ef9a02d,0xbea68f12,0x3f721352,0x3ec6d529,0x3f6be858
.long 0x3f800000,0,0x3f3e35c5,0xbf2b561b,0x3dd53db9,0xbf7e9bc9,0xbf16999f,0xbf4f0417
.long 0xbf7a7302,0xbe541501,0xbf5d924d,0x3f003a06,0xbe9d9e78,0x3f73913f,0x3ed0eb2a,0x3f69b7e4
.long 0x3f800000,0,0x3f3daef9,0xbf2beb4a,0x3dc8bd36,0xbf7ec46d,0xbf187fc0,0xbf4d9f02
.long 0xbf7b14be,0xbe47c5c2,0xbf5b941a,0x3f039c3d,0xbe94a031,0x3f74fa0b,0x3edae880,0x3f676bd8
.long 0x3f800000,0,0x3f3d27b8,0xbf2c800f,0x3dbc3ac3,0xbf7eea9d,0xbf1a6293,0xbf4c3578
.long 0xbf7baccd,0xbe3b6ecf,0xbf5988ad,0x3f06f686,0xbe8b9507,0x3f764d97,0x3ee4cbfe,0x3f650479
.long 0x3f800000,0,0x3f3ca003,0xbf2d1469,0x3dafb680,0xbf7f0e58,0xbf1c420c,0xbf4ac77f
.long 0xbf7c3b28,0xbe2f10a2,0xbf577026,0x3f0a48ad,0xbe827dc0,0x3f778bc5,0x3eee9479,0x3f628210
.long 0x3f800000,0,0x3f3c17d9,0xbf2da859,0x3da3308c,0xbf7f2f9d,0xbf1e1e22,0xbf495521
.long 0xbf7cbfc9,0xbe22abb6,0xbf554aa4,0x3f0d9281,0xbe72b651,0x3f78b47b,0x3ef840c8,0x3f5fe4e9
.long 0x3f800000,0,0x3f3b8f3b,0xbf2e3bde,0x3d96a905,0xbf7f4e6d,0xbf1ff6cb,0xbf47de65
.long 0xbf7d3aac,0xbe164083,0xbf531849,0x3f10d3cd,0xbe605c13,0x3f79c79d,0x3f00e7e4,0x3f5d2d53
.long 0x3f800000,0,0x3f3b0629,0xbf2ecef7,0x3d8a200a,0xbf7f6ac7,0xbf21cbfb,0xbf466354
.long 0xbf7dabcc,0xbe09cf86,0xbf50d937,0x3f140c5f,0xbe4dee60,0x3f7ac516,0x3f05a02c,0x3f5a5ba0
.long 0x3f800000,0,0x3f3a7ca4,0xbf2f61a5,0x3d7b2b74,0xbf7f84ab,0xbf239da9,0xbf44e3f5
.long 0xbf7e1324,0xbdfab273,0xbf4e8d90,0x3f173c07,0xbe3b6ecf,0x3f7baccd,0x3f0a48ad,0x3f577026
.long 0x3f800000,0,0x3f39f2ac,0xbf2ff3e6,0x3d621469,0xbf7f9c18,0xbf256bcb,0xbf436051
.long 0xbf7e70b0,0xbde1bc2e,0xbf4c3578,0x3f1a6293,0xbe28defc,0x3f7c7eb0,0x3f0ee0db,0x3f546b3b
.long 0x3f800000,0,0x3f396842,0xbf3085bb,0x3d48fb30,0xbf7fb10f,0xbf273656,0xbf41d870
.long 0xbf7ec46d,0xbdc8bd36,0xbf49d112,0x3f1d7fd1,0xbe164083,0x3f7d3aac,0x3f13682a,0x3f514d3d
.long 0x3f800000,0,0x3f38dd65,0xbf311722,0x3d2fe007,0xbf7fc38f,0xbf28fd41,0xbf404c5c
.long 0xbf7f0e58,0xbdafb680,0xbf476085,0x3f209393,0xbe039502,0x3f7de0b1,0x3f17de12,0x3f4e1689
.long 0x3f800000,0,0x3f385216,0xbf31a81d,0x3d16c32c,0xbf7fd397,0xbf2ac082,0xbf3ebc1b
.long 0xbf7f4e6d,0xbd96a905,0xbf44e3f5,0x3f239da9,0xbde1bc2e,0x3f7e70b0,0x3f1c420c,0x3f4ac77f
.long 0x3f800000,0,0x3f37c655,0xbf3238aa,0x3cfb49ba,0xbf7fe129,0xbf2c800f,0xbf3d27b8
.long 0xbf7f84ab,0xbd7b2b74,0xbf425b89,0x3f269de3,0xbdbc3ac3,0x3f7eea9d,0x3f209393,0x3f476085
.long 0x3f800000,0,0x3f373a23,0xbf32c8c9,0x3cc90ab0,0xbf7fec43,0xbf2e3bde,0xbf3b8f3b
.long 0xbf7fb10f,0xbd48fb30,0xbf3fc767,0x3f299415,0xbd96a905,0x3f7f4e6d,0x3f24d225,0x3f43e200
.long 0x3f800000,0,0x3f36ad7f,0xbf33587a,0x3c96c9b6,0xbf7ff4e6,0xbf2ff3e6,0xbf39f2ac
.long 0xbf7fd397,0xbd16c32c,0xbf3d27b8,0x3f2c800f,0xbd621469,0x3f7f9c18,0x3f28fd41,0x3f404c5c
.long 0x3f800000,0,0x3f36206c,0xbf33e7bc,0x3c490e90,0xbf7ffb11,0xbf31a81d,0xbf385216
.long 0xbf7fec43,0xbcc90ab0,0xbf3a7ca4,0x3f2f61a5,0xbd16c32c,0x3f7fd397,0x3f2d1469,0x3f3ca003
.long 0x3f800000,0,0x3f3592e7,0xbf34768f,0x3bc90f88,0xbf7ffec4,0xbf33587a,0xbf36ad7f
.long 0xbf7ffb11,0xbc490e90,0xbf37c655,0x3f3238aa,0xbc96c9b6,0x3f7ff4e6,0x3f311722,0x3f38dd65
```
